```python
import torch

def _softmax(x, axis=-1):
    return torch.softmax(x, dim=axis)
def _gelu(x):
    return torch.nn.functional.gelu(x, approximate="tanh")
def _silu(x):
    return torch.nn.functional.silu(x)
def _sigmoid(x):
    return torch.sigmoid(x)
def _layernorm(x, axis=-1, eps=1e-5):
    m = x.mean(dim=axis, keepdim=True)
    v = x.var(dim=axis, keepdim=True, unbiased=False)
    return (x - m) / torch.sqrt(v + eps)
def _scatter_add(tgt, idx, src, axis=0):
    return tgt.clone().index_add_(axis, idx, src)
def _segment_sum(src, seg, n):
    out = torch.zeros((n,) + src.shape[1:], dtype=src.dtype)
    return out.index_add_(0, seg, src)
def _pad(x, pw):
    flat = tuple(v for pair in reversed(pw) for v in pair)
    return torch.nn.functional.pad(x, flat)

kernel_name = 'standalone__mha_softmax__near_ridge'

def setup_inputs():

    _w = (lambda a: (lambda t: t.to(torch.bfloat16) if t.is_floating_point() else t)(torch.as_tensor(a)))
    B, H, Sq, Sk, D = 8, 32, 304, 2048, 128
    return {
        "q": _w((lambda *s: torch.randn(*s, dtype=torch.bfloat16) * 0.8)(B, H, Sq, D)),
        "k": _w((lambda *s: torch.randn(*s, dtype=torch.bfloat16) * 0.8)(B, H, Sk, D)),
        "v": _w((lambda *s: torch.randn(*s, dtype=torch.bfloat16) * 0.05)(B, H, Sk, D)),
    }

def reference(q, k, v):
    scale = q.shape[-1] ** -0.5
    scores = torch.einsum("bhqd,bhkd->bhqk", q, k) * scale
    p = _softmax(scores, axis=-1)
    return torch.einsum("bhqk,bhkd->bhqd", p, v)
```

```asm
; @launch grid=(256,1,1) block=(256,1,1) lds=163840
.amdgcn_target "amdgcn-amd-amdhsa--gfx950"
.text
.globl standalone__mha_softmax__near_ridge_kernel
.p2align 8
.type standalone__mha_softmax__near_ridge_kernel,@function
standalone__mha_softmax__near_ridge_kernel:
    s_cmp_ge_u32 s2, 256
    s_cbranch_scc1 L_end
    s_load_dwordx4 s[4:7], s[0:1], 0
    s_load_dwordx4 s[8:11], s[0:1], 16
    v_lshrrev_b32 v4, 6, v0
    v_and_b32 v1, 63, v0
    v_readfirstlane_b32 s28, v4
    s_getpc_b64 s[44:45]
L_pc:
    s_bfe_u32 s46, s2, 0x30003
    s_lshl_b32 s46, s46, 13
    v_lshl_add_u32 v8, v0, 5, s46
    v_min_u32 v8, L_code_end-L_pc-4, v8
    v_mov_b32 v9, s45
    v_add_co_u32 v8, vcc, s44, v8
    v_lshrrev_b32 v2, 4, v1
    v_and_b32 v3, 15, v1
    v_addc_co_u32 v9, vcc, 0, v9, vcc
    global_load_dword v0, v[8:9], off
    s_mov_b32 s31, 0
L_restart:
    v_xor_b32 v4, v2, v3
    v_lshlrev_b32 v4, 4, v4
    v_lshl_add_u32 v90, v2, 8, v4
    v_xor_b32 v91, 64, v90
    v_xor_b32 v92, 128, v90
    v_xor_b32 v93, 192, v90
    s_lshl_b32 s37, s28, 12
    s_lshl_b32 s35, s2, 19
    s_mov_b32 s18, 524288
    s_mov_b32 s19, 0x20000
    s_mul_i32 s29, s2, 77824
    s_mul_i32 s36, s28, 20480
    s_lshl_b32 s38, s28, 14
    s_add_u32 s38, s38, 98304
    s_cmp_eq_u32 s28, 0
    s_cselect_b32 s38, 49152, s38
    s_waitcnt lgkmcnt(0)
    s_add_u32 s16, s6, s35
    s_addc_u32 s17, s7, 0
    s_add_u32 m0, s37, 0
    s_add_u32 s30, s37, 0
    buffer_load_dwordx4 v90, s[16:19], s30 offen offset:0 nt lds
    buffer_load_dwordx4 v91, s[16:19], s30 offen offset:1024 nt lds
    buffer_load_dwordx4 v92, s[16:19], s30 offen offset:2048 nt lds
    buffer_load_dwordx4 v93, s[16:19], s30 offen offset:3072 nt lds
    s_add_u32 s12, s4, s29
    s_addc_u32 s13, s5, 0
    s_mov_b32 s14, 77824
    s_mov_b32 s15, 0x20000
    s_add_u32 m0, s38, 0
    s_add_u32 s34, s36, 0
    buffer_load_dwordx4 v90, s[12:15], s34 offen offset:0 nt lds
    buffer_load_dwordx4 v91, s[12:15], s34 offen offset:1024 nt lds
    buffer_load_dwordx4 v92, s[12:15], s34 offen offset:2048 nt lds
    buffer_load_dwordx4 v93, s[12:15], s34 offen offset:3072 nt lds
    s_add_u32 s20, s8, s35
    s_addc_u32 s21, s9, 0
    s_mov_b32 s22, 524288
    s_mov_b32 s23, 0x20000
    v_lshlrev_b32 v4, 1, v2
    v_xor_b32 v4, v4, v3
    v_lshlrev_b32 v4, 4, v4
    v_lshl_add_u32 v94, v2, 8, v4
    v_xor_b32 v95, 128, v94
    s_add_u32 m0, s37, 65536
    s_add_u32 s39, s37, 0
    buffer_load_dwordx4 v94, s[20:23], s39 offen offset:0 nt lds
    buffer_load_dwordx4 v95, s[20:23], s39 offen offset:1024 nt lds
    buffer_load_dwordx4 v94, s[20:23], s39 offen offset:2048 nt lds
    buffer_load_dwordx4 v95, s[20:23], s39 offen offset:3072 nt lds
    s_add_u32 s24, s10, s29
    s_addc_u32 s25, s11, 0
    s_mov_b32 s26, 77824
    s_mov_b32 s27, 0x20000
    s_mov_b32 s32, 1040356334
    s_mov_b32 s33, 1040356334
    v_xor_b32 v4, v2, v3
    v_lshlrev_b32 v4, 4, v4
    v_lshl_add_u32 v42, v3, 8, v4
    v_xor_b32 v43, 64, v42
    v_xor_b32 v44, 128, v42
    v_xor_b32 v45, 192, v42
    v_lshrrev_b32 v8, 2, v1
    v_and_b32 v9, 7, v8
    v_lshlrev_b32 v9, 1, v9
    v_bfe_u32 v10, v1, 1, 1
    v_and_b32 v11, 1, v1
    v_lshlrev_b32 v11, 3, v11
    v_lshl_add_u32 v11, v8, 8, v11
    v_add_u32 v11, 65536, v11
    v_xor_b32 v4, v10, v9
    v_lshl_add_u32 v46, v4, 4, v11
    v_xor_b32 v47, 32, v46
    v_xor_b32 v48, 64, v46
    v_xor_b32 v49, 96, v46
    v_xor_b32 v50, 128, v46
    v_xor_b32 v51, 160, v46
    v_xor_b32 v52, 192, v46
    v_xor_b32 v53, 224, v46
    v_and_b32 v4, 1, v1
    v_mov_b32 v8, 0xaaaaaaaa
    v_mul_lo_u32 v4, v4, v8
    v_add_u32 v41, 0x44444444, v4
    v_mov_b32 v4, 0x3f803f80
    v_accvgpr_write_b32 a208, v4
    v_accvgpr_write_b32 a209, v4
    v_accvgpr_write_b32 a210, v4
    v_accvgpr_write_b32 a211, v4
    v_mov_b32 v36, 0
    v_mov_b32 v37, 0
    v_mov_b32 v38, 0
    v_mov_b32 v39, 0
    v_mov_b32 v40, 0
    s_mov_b32 s29, 8
    s_mov_b64 s[44:45], 0
    s_mov_b32 s46, 1333788672
    s_lshl_b32 s34, s28, 13
    s_add_u32 s34, s34, 131072
    v_mov_b32 v7, s34
    v_lshl_add_u32 v86, v2, 10, v7
    v_lshl_add_u32 v70, v3, 3, v86
    v_xor_b32 v71, 32, v70
    v_add_u32 v71, 256, v71
    v_and_b32 v4, 3, v1
    v_lshl_add_u32 v86, v2, 8, v7
    v_lshl_add_u32 v86, v4, 6, v86
    v_bfe_u32 v4, v1, 2, 2
    v_lshl_add_u32 v86, v4, 3, v86
    v_and_b32 v4, 1, v2
    v_lshl_add_u32 v72, v4, 5, v86
    v_xor_b32 v73, 32, v72
    v_and_b32 v4, 3, v1
    v_lshlrev_b32 v6, 8, v2
    v_lshl_add_u32 v6, v4, 5, v6
    v_bfe_u32 v4, v1, 3, 1
    v_lshl_add_u32 v6, v4, 7, v6
    v_bfe_u32 v4, v1, 2, 1
    v_lshl_add_u32 v6, v4, 4, v6
    v_mov_b32 v74, 1.0
    v_mov_b32 v75, 0x3e800000
    s_waitcnt vmcnt(8)
    s_add_u32 m0, s38, 4096
    s_add_u32 s34, s36, 4096
    buffer_load_dwordx4 v90, s[12:15], s34 offen offset:0 nt lds
    buffer_load_dwordx4 v91, s[12:15], s34 offen offset:1024 nt lds
    buffer_load_dwordx4 v92, s[12:15], s34 offen offset:2048 nt lds
    buffer_load_dwordx4 v93, s[12:15], s34 offen offset:3072 nt lds
    s_barrier
    ds_read_b128 a[80:83], v42 offset:0
    ds_read_b128 a[84:87], v43 offset:0
    ds_read_b128 a[88:91], v44 offset:0
    ds_read_b128 a[92:95], v45 offset:0
    ds_read_b128 a[96:99], v42 offset:4096
    ds_read_b128 a[100:103], v43 offset:4096
    ds_read_b128 a[104:107], v44 offset:4096
    ds_read_b128 a[108:111], v45 offset:4096
    ds_read_b128 a[112:115], v42 offset:8192
    ds_read_b128 a[116:119], v43 offset:8192
    ds_read_b128 a[120:123], v44 offset:8192
    ds_read_b128 a[124:127], v45 offset:8192
    ds_read_b128 a[128:131], v42 offset:12288
    ds_read_b128 a[132:135], v43 offset:12288
    ds_read_b128 a[136:139], v44 offset:12288
    ds_read_b128 a[140:143], v45 offset:12288
    v_add_u32 v42, s38, v42
    v_add_u32 v43, s38, v43
    v_add_u32 v44, s38, v44
    v_add_u32 v45, s38, v45
    s_cmp_eq_u32 s28, 3
    s_cbranch_scc1 L_start_w4
L_start_w5:
    v_accvgpr_write_b32 a252, 0
    v_accvgpr_write_b32 a253, 0
    v_accvgpr_write_b32 a254, 0
    v_accvgpr_write_b32 a255, 0
    v_accvgpr_write_b32 a248, 0
    v_accvgpr_write_b32 a249, 0
    v_accvgpr_write_b32 a250, 0
    v_accvgpr_write_b32 a251, 0
    s_waitcnt vmcnt(8)
    ds_read_b128 v[224:227], v42 offset:0
    ds_read_b128 v[228:231], v43 offset:0
    ds_read_b128 v[232:235], v44 offset:0
    ds_read_b128 v[236:239], v45 offset:0
    s_add_u32 m0, s38, 8192
    s_add_u32 s34, s36, 8192
    buffer_load_dwordx4 v90, s[12:15], s34 offen offset:0 nt lds
    buffer_load_dwordx4 v91, s[12:15], s34 offen offset:1024 nt lds
    buffer_load_dwordx4 v92, s[12:15], s34 offen offset:2048 nt lds
    buffer_load_dwordx4 v93, s[12:15], s34 offen offset:3072 nt lds
    s_waitcnt lgkmcnt(2)
    v_lshlrev_b32 v240, 16, v224
    v_and_b32 v241, 0xffff0000, v224
    v_lshlrev_b32 v242, 16, v225
    v_and_b32 v243, 0xffff0000, v225
    v_lshlrev_b32 v244, 16, v226
    v_and_b32 v245, 0xffff0000, v226
    v_lshlrev_b32 v246, 16, v227
    v_and_b32 v247, 0xffff0000, v227
    v_lshlrev_b32 v248, 16, v228
    v_and_b32 v249, 0xffff0000, v228
    v_lshlrev_b32 v250, 16, v229
    v_and_b32 v251, 0xffff0000, v229
    v_lshlrev_b32 v252, 16, v230
    v_and_b32 v253, 0xffff0000, v230
    v_lshlrev_b32 v254, 16, v231
    v_and_b32 v255, 0xffff0000, v231
    v_pk_mul_f32 v[240:241], v[240:241], s[32:33]
    v_pk_mul_f32 v[242:243], v[242:243], s[32:33]
    v_pk_mul_f32 v[244:245], v[244:245], s[32:33]
    v_pk_mul_f32 v[246:247], v[246:247], s[32:33]
    v_pk_mul_f32 v[248:249], v[248:249], s[32:33]
    v_pk_mul_f32 v[250:251], v[250:251], s[32:33]
    v_pk_mul_f32 v[252:253], v[252:253], s[32:33]
    v_pk_mul_f32 v[254:255], v[254:255], s[32:33]
    v_cvt_pk_bf16_f32 v240, v240, v241
    v_cvt_pk_bf16_f32 v242, v242, v243
    v_cvt_pk_bf16_f32 v244, v244, v245
    v_cvt_pk_bf16_f32 v246, v246, v247
    v_cvt_pk_bf16_f32 v248, v248, v249
    v_cvt_pk_bf16_f32 v250, v250, v251
    v_cvt_pk_bf16_f32 v252, v252, v253
    v_cvt_pk_bf16_f32 v254, v254, v255
    v_accvgpr_write_b32 a0, v240
    v_accvgpr_write_b32 a1, v242
    v_accvgpr_write_b32 a2, v244
    v_accvgpr_write_b32 a3, v246
    v_accvgpr_write_b32 a4, v248
    v_accvgpr_write_b32 a5, v250
    v_accvgpr_write_b32 a6, v252
    v_accvgpr_write_b32 a7, v254
    s_waitcnt lgkmcnt(0)
    v_lshlrev_b32 v240, 16, v232
    v_and_b32 v241, 0xffff0000, v232
    v_lshlrev_b32 v242, 16, v233
    v_and_b32 v243, 0xffff0000, v233
    v_lshlrev_b32 v244, 16, v234
    v_and_b32 v245, 0xffff0000, v234
    v_lshlrev_b32 v246, 16, v235
    v_and_b32 v247, 0xffff0000, v235
    v_lshlrev_b32 v248, 16, v236
    v_and_b32 v249, 0xffff0000, v236
    v_lshlrev_b32 v250, 16, v237
    v_and_b32 v251, 0xffff0000, v237
    v_lshlrev_b32 v252, 16, v238
    v_and_b32 v253, 0xffff0000, v238
    v_lshlrev_b32 v254, 16, v239
    v_and_b32 v255, 0xffff0000, v239
    v_pk_mul_f32 v[240:241], v[240:241], s[32:33]
    v_pk_mul_f32 v[242:243], v[242:243], s[32:33]
    v_pk_mul_f32 v[244:245], v[244:245], s[32:33]
    v_pk_mul_f32 v[246:247], v[246:247], s[32:33]
    v_pk_mul_f32 v[248:249], v[248:249], s[32:33]
    v_pk_mul_f32 v[250:251], v[250:251], s[32:33]
    v_pk_mul_f32 v[252:253], v[252:253], s[32:33]
    v_pk_mul_f32 v[254:255], v[254:255], s[32:33]
    v_cvt_pk_bf16_f32 v240, v240, v241
    v_cvt_pk_bf16_f32 v242, v242, v243
    v_cvt_pk_bf16_f32 v244, v244, v245
    v_cvt_pk_bf16_f32 v246, v246, v247
    v_cvt_pk_bf16_f32 v248, v248, v249
    v_cvt_pk_bf16_f32 v250, v250, v251
    v_cvt_pk_bf16_f32 v252, v252, v253
    v_cvt_pk_bf16_f32 v254, v254, v255
    v_accvgpr_write_b32 a8, v240
    v_accvgpr_write_b32 a9, v242
    v_accvgpr_write_b32 a10, v244
    v_accvgpr_write_b32 a11, v246
    v_accvgpr_write_b32 a12, v248
    v_accvgpr_write_b32 a13, v250
    v_accvgpr_write_b32 a14, v252
    v_accvgpr_write_b32 a15, v254
    v_mfma_f32_16x16x32_bf16 v[8:11], a[80:83], a[0:3], 0
    v_mfma_f32_16x16x32_bf16 v[8:11], a[84:87], a[4:7], v[8:11]
    v_mfma_f32_16x16x32_bf16 v[8:11], a[88:91], a[8:11], v[8:11]
    v_mfma_f32_16x16x32_bf16 v[8:11], a[92:95], a[12:15], v[8:11]
    s_cmp_lg_u32 s31, 0
    s_nop 5
    s_cbranch_scc1 L_km0_w5
    v_max3_f32 v16, v8, v9, v10
    v_max_f32 v16, v16, v11
    v_mov_b32 v17, v16
    s_nop 1
    v_permlane16_swap_b32 v16, v17
    v_max_f32 v16, v16, v17
    v_mov_b32 v17, v16
    s_nop 1
    v_permlane32_swap_b32 v16, v17
    v_max_f32 v16, v16, v17
    v_sub_f32 v17, 0xc1300000, v16
    v_sub_f32 v18, 0xc1300000, v16
    v_sub_f32 v19, 0xc1300000, v16
    v_sub_f32 v16, 0xc1300000, v16
L_km0_w5:
    s_nop 1
    v_mfma_f32_16x16x32_bf16 v[12:15], a[108:111], a[12:15], v[16:19]
    v_add_f32 v8, v8, v16
    v_add_f32 v9, v9, v16
    v_mfma_f32_16x16x32_bf16 v[12:15], a[104:107], a[8:11], v[12:15]
    v_add_f32 v10, v10, v16
    v_mfma_f32_16x16x32_bf16 v[12:15], a[100:103], a[4:7], v[12:15]
    v_add_f32 v11, v11, v16
    v_mfma_f32_16x16x32_bf16 v[12:15], a[96:99], a[0:3], v[12:15]
    v_exp_f32 v8, v8
    v_mfma_f32_16x16x32_bf16 v[78:81], a[112:115], a[0:3], v[16:19]
    v_exp_f32 v9, v9
    v_exp_f32 v10, v10
    v_mfma_f32_16x16x32_bf16 v[78:81], a[116:119], a[4:7], v[78:81]
    v_exp_f32 v11, v11
    v_mfma_f32_16x16x32_bf16 v[78:81], a[120:123], a[8:11], v[78:81]
    v_cvt_pk_bf16_f32 v54, v8, v9
    v_mfma_f32_16x16x32_bf16 v[78:81], a[124:127], a[12:15], v[78:81]
    v_cvt_pk_bf16_f32 v55, v10, v11
    v_mfma_f32_16x16x32_bf16 v[82:85], a[140:143], a[12:15], v[16:19]
    v_exp_f32 v12, v12
    v_exp_f32 v13, v13
    v_mfma_f32_16x16x32_bf16 v[82:85], a[136:139], a[8:11], v[82:85]
    v_exp_f32 v14, v14
    v_mfma_f32_16x16x32_bf16 v[82:85], a[132:135], a[4:7], v[82:85]
    v_exp_f32 v15, v15
    v_cvt_pk_bf16_f32 v56, v12, v13
    v_mfma_f32_16x16x32_bf16 v[82:85], a[128:131], a[0:3], v[82:85]
    v_cvt_pk_bf16_f32 v57, v14, v15
    v_exp_f32 v78, v78
    v_exp_f32 v79, v79
    v_exp_f32 v80, v80
    v_exp_f32 v81, v81
    v_cvt_pk_bf16_f32 v58, v78, v79
    v_cvt_pk_bf16_f32 v59, v80, v81
    s_nop 0
    v_exp_f32 v82, v82
    v_exp_f32 v83, v83
    v_exp_f32 v84, v84
    v_exp_f32 v85, v85
    v_cvt_pk_bf16_f32 v60, v82, v83
    v_cvt_pk_bf16_f32 v61, v84, v85
    s_waitcnt vmcnt(8)
    s_add_u32 m0, s38, 12288
    s_add_u32 s34, s36, 12288
    buffer_load_dwordx4 v90, s[12:15], s34 offen offset:0 nt lds
    buffer_load_dwordx4 v91, s[12:15], s34 offen offset:1024 nt lds
    buffer_load_dwordx4 v92, s[12:15], s34 offen offset:2048 nt lds
    buffer_load_dwordx4 v93, s[12:15], s34 offen offset:3072 nt lds
    s_barrier
    ds_read_b64_tr_b16 a[144:145], v46 offset:0
    ds_read_b64_tr_b16 a[146:147], v46 offset:4096
    ds_read_b64_tr_b16 a[148:149], v47 offset:0
    ds_read_b64_tr_b16 a[150:151], v47 offset:4096
    ds_read_b64_tr_b16 a[152:153], v48 offset:0
    ds_read_b64_tr_b16 a[154:155], v48 offset:4096
    ds_read_b64_tr_b16 a[156:157], v49 offset:0
    ds_read_b64_tr_b16 a[158:159], v49 offset:4096
    ds_read_b64_tr_b16 a[160:161], v50 offset:0
    ds_read_b64_tr_b16 a[162:163], v50 offset:4096
    ds_read_b64_tr_b16 a[164:165], v51 offset:0
    ds_read_b64_tr_b16 a[166:167], v51 offset:4096
    ds_read_b64_tr_b16 a[168:169], v52 offset:0
    ds_read_b64_tr_b16 a[170:171], v52 offset:4096
    ds_read_b64_tr_b16 a[172:173], v53 offset:0
    ds_read_b64_tr_b16 a[174:175], v53 offset:4096
    ds_read_b64_tr_b16 a[176:177], v46 offset:8192
    ds_read_b64_tr_b16 a[178:179], v46 offset:12288
    ds_read_b64_tr_b16 a[180:181], v47 offset:8192
    ds_read_b64_tr_b16 a[182:183], v47 offset:12288
    ds_read_b64_tr_b16 a[184:185], v48 offset:8192
    ds_read_b64_tr_b16 a[186:187], v48 offset:12288
    ds_read_b64_tr_b16 a[188:189], v49 offset:8192
    ds_read_b64_tr_b16 a[190:191], v49 offset:12288
    ds_read_b64_tr_b16 a[192:193], v50 offset:8192
    ds_read_b64_tr_b16 a[194:195], v50 offset:12288
    ds_read_b64_tr_b16 a[196:197], v51 offset:8192
    ds_read_b64_tr_b16 a[198:199], v51 offset:12288
    ds_read_b64_tr_b16 a[200:201], v52 offset:8192
    ds_read_b64_tr_b16 a[202:203], v52 offset:12288
    ds_read_b64_tr_b16 a[204:205], v53 offset:8192
    ds_read_b64_tr_b16 a[206:207], v53 offset:12288
    s_waitcnt lgkmcnt(0)
    v_mfma_f32_16x16x32_bf16 v[96:99], v[54:57], a[144:147], 0
    v_mfma_f32_16x16x32_bf16 v[100:103], v[54:57], a[148:151], 0
    v_mfma_f32_16x16x32_bf16 v[104:107], v[54:57], a[152:155], 0
    v_mfma_f32_16x16x32_bf16 v[108:111], v[54:57], a[156:159], 0
    v_mfma_f32_16x16x32_bf16 v[112:115], v[54:57], a[160:163], 0
    v_mfma_f32_16x16x32_bf16 v[116:119], v[54:57], a[164:167], 0
    v_mfma_f32_16x16x32_bf16 v[120:123], v[54:57], a[168:171], 0
    v_mfma_f32_16x16x32_bf16 v[124:127], v[54:57], a[172:175], 0
    v_mfma_f32_16x16x32_bf16 v[96:99], v[58:61], a[176:179], v[96:99]
    v_mfma_f32_16x16x32_bf16 v[100:103], v[58:61], a[180:183], v[100:103]
    v_mfma_f32_16x16x32_bf16 v[104:107], v[58:61], a[184:187], v[104:107]
    v_mfma_f32_16x16x32_bf16 v[108:111], v[58:61], a[188:191], v[108:111]
    v_mfma_f32_16x16x32_bf16 v[112:115], v[58:61], a[192:195], v[112:115]
    v_mfma_f32_16x16x32_bf16 v[116:119], v[58:61], a[196:199], v[116:119]
    v_mfma_f32_16x16x32_bf16 v[120:123], v[58:61], a[200:203], v[120:123]
    v_mfma_f32_16x16x32_bf16 v[124:127], v[58:61], a[204:207], v[124:127]
    v_smfmac_f32_16x16x64_bf16 a[248:251], a[208:211], v[54:61], v41
    s_waitcnt vmcnt(8)
    ds_read_b128 v[224:227], v42 offset:4096
    ds_read_b128 v[228:231], v43 offset:4096
    ds_read_b128 v[232:235], v44 offset:4096
    ds_read_b128 v[236:239], v45 offset:4096
    s_add_u32 m0, s37, 16384
    s_add_u32 s30, s37, 16384
    buffer_load_dwordx4 v90, s[16:19], s30 offen offset:0 nt lds
    buffer_load_dwordx4 v91, s[16:19], s30 offen offset:1024 nt lds
    buffer_load_dwordx4 v92, s[16:19], s30 offen offset:2048 nt lds
    buffer_load_dwordx4 v93, s[16:19], s30 offen offset:3072 nt lds
    s_waitcnt lgkmcnt(2)
    v_lshlrev_b32 v240, 16, v224
    v_and_b32 v241, 0xffff0000, v224
    v_lshlrev_b32 v242, 16, v225
    v_and_b32 v243, 0xffff0000, v225
    v_lshlrev_b32 v244, 16, v226
    v_and_b32 v245, 0xffff0000, v226
    v_lshlrev_b32 v246, 16, v227
    v_and_b32 v247, 0xffff0000, v227
    v_lshlrev_b32 v248, 16, v228
    v_and_b32 v249, 0xffff0000, v228
    v_lshlrev_b32 v250, 16, v229
    v_and_b32 v251, 0xffff0000, v229
    v_lshlrev_b32 v252, 16, v230
    v_and_b32 v253, 0xffff0000, v230
    v_lshlrev_b32 v254, 16, v231
    v_and_b32 v255, 0xffff0000, v231
    v_pk_mul_f32 v[240:241], v[240:241], s[32:33]
    v_pk_mul_f32 v[242:243], v[242:243], s[32:33]
    v_pk_mul_f32 v[244:245], v[244:245], s[32:33]
    v_pk_mul_f32 v[246:247], v[246:247], s[32:33]
    v_pk_mul_f32 v[248:249], v[248:249], s[32:33]
    v_pk_mul_f32 v[250:251], v[250:251], s[32:33]
    v_pk_mul_f32 v[252:253], v[252:253], s[32:33]
    v_pk_mul_f32 v[254:255], v[254:255], s[32:33]
    v_cvt_pk_bf16_f32 v240, v240, v241
    v_cvt_pk_bf16_f32 v242, v242, v243
    v_cvt_pk_bf16_f32 v244, v244, v245
    v_cvt_pk_bf16_f32 v246, v246, v247
    v_cvt_pk_bf16_f32 v248, v248, v249
    v_cvt_pk_bf16_f32 v250, v250, v251
    v_cvt_pk_bf16_f32 v252, v252, v253
    v_cvt_pk_bf16_f32 v254, v254, v255
    v_accvgpr_write_b32 a16, v240
    v_accvgpr_write_b32 a17, v242
    v_accvgpr_write_b32 a18, v244
    v_accvgpr_write_b32 a19, v246
    v_accvgpr_write_b32 a20, v248
    v_accvgpr_write_b32 a21, v250
    v_accvgpr_write_b32 a22, v252
    v_accvgpr_write_b32 a23, v254
    s_waitcnt lgkmcnt(0)
    v_lshlrev_b32 v240, 16, v232
    v_and_b32 v241, 0xffff0000, v232
    v_lshlrev_b32 v242, 16, v233
    v_and_b32 v243, 0xffff0000, v233
    v_lshlrev_b32 v244, 16, v234
    v_and_b32 v245, 0xffff0000, v234
    v_lshlrev_b32 v246, 16, v235
    v_and_b32 v247, 0xffff0000, v235
    v_lshlrev_b32 v248, 16, v236
    v_and_b32 v249, 0xffff0000, v236
    v_lshlrev_b32 v250, 16, v237
    v_and_b32 v251, 0xffff0000, v237
    v_lshlrev_b32 v252, 16, v238
    v_and_b32 v253, 0xffff0000, v238
    v_lshlrev_b32 v254, 16, v239
    v_and_b32 v255, 0xffff0000, v239
    v_pk_mul_f32 v[240:241], v[240:241], s[32:33]
    v_pk_mul_f32 v[242:243], v[242:243], s[32:33]
    v_pk_mul_f32 v[244:245], v[244:245], s[32:33]
    v_pk_mul_f32 v[246:247], v[246:247], s[32:33]
    v_pk_mul_f32 v[248:249], v[248:249], s[32:33]
    v_pk_mul_f32 v[250:251], v[250:251], s[32:33]
    v_pk_mul_f32 v[252:253], v[252:253], s[32:33]
    v_pk_mul_f32 v[254:255], v[254:255], s[32:33]
    v_cvt_pk_bf16_f32 v240, v240, v241
    v_cvt_pk_bf16_f32 v242, v242, v243
    v_cvt_pk_bf16_f32 v244, v244, v245
    v_cvt_pk_bf16_f32 v246, v246, v247
    v_cvt_pk_bf16_f32 v248, v248, v249
    v_cvt_pk_bf16_f32 v250, v250, v251
    v_cvt_pk_bf16_f32 v252, v252, v253
    v_cvt_pk_bf16_f32 v254, v254, v255
    v_accvgpr_write_b32 a24, v240
    v_accvgpr_write_b32 a25, v242
    v_accvgpr_write_b32 a26, v244
    v_accvgpr_write_b32 a27, v246
    v_accvgpr_write_b32 a28, v248
    v_accvgpr_write_b32 a29, v250
    v_accvgpr_write_b32 a30, v252
    v_accvgpr_write_b32 a31, v254
    v_mfma_f32_16x16x32_bf16 v[8:11], a[80:83], a[16:19], 0
    v_mfma_f32_16x16x32_bf16 v[8:11], a[84:87], a[20:23], v[8:11]
    v_mfma_f32_16x16x32_bf16 v[8:11], a[88:91], a[24:27], v[8:11]
    v_mfma_f32_16x16x32_bf16 v[8:11], a[92:95], a[28:31], v[8:11]
    s_cmp_lg_u32 s31, 0
    s_nop 5
    s_cbranch_scc1 L_km1_w5
    v_max3_f32 v20, v8, v9, v10
    v_max_f32 v20, v20, v11
    v_mov_b32 v21, v20
    s_nop 1
    v_permlane16_swap_b32 v20, v21
    v_max_f32 v20, v20, v21
    v_mov_b32 v21, v20
    s_nop 1
    v_permlane32_swap_b32 v20, v21
    v_max_f32 v20, v20, v21
    v_sub_f32 v21, 0xc1300000, v20
    v_sub_f32 v22, 0xc1300000, v20
    v_sub_f32 v23, 0xc1300000, v20
    v_sub_f32 v20, 0xc1300000, v20
L_km1_w5:
    s_nop 1
    v_mfma_f32_16x16x32_bf16 v[12:15], a[108:111], a[28:31], v[20:23]
    v_add_f32 v8, v8, v20
    v_add_f32 v9, v9, v20
    v_mfma_f32_16x16x32_bf16 v[12:15], a[104:107], a[24:27], v[12:15]
    v_add_f32 v10, v10, v20
    v_add_f32 v11, v11, v20
    v_mfma_f32_16x16x32_bf16 v[12:15], a[100:103], a[20:23], v[12:15]
    v_exp_f32 v8, v8
    v_exp_f32 v9, v9
    v_mfma_f32_16x16x32_bf16 v[12:15], a[96:99], a[16:19], v[12:15]
    v_exp_f32 v10, v10
    v_mfma_f32_16x16x32_bf16 v[78:81], a[112:115], a[16:19], v[20:23]
    v_exp_f32 v11, v11
    v_add_f32 v37, v37, v8
    v_mfma_f32_16x16x32_bf16 v[78:81], a[116:119], a[20:23], v[78:81]
    v_add_f32 v37, v37, v9
    v_add_f32 v37, v37, v10
    v_mfma_f32_16x16x32_bf16 v[78:81], a[120:123], a[24:27], v[78:81]
    v_add_f32 v37, v37, v11
    v_cvt_pk_bf16_f32 v62, v8, v9
    v_mfma_f32_16x16x32_bf16 v[78:81], a[124:127], a[28:31], v[78:81]
    v_cvt_pk_bf16_f32 v63, v10, v11
    v_mfma_f32_16x16x32_bf16 v[82:85], a[140:143], a[28:31], v[20:23]
    v_exp_f32 v12, v12
    v_exp_f32 v13, v13
    v_exp_f32 v14, v14
    v_mfma_f32_16x16x32_bf16 v[82:85], a[136:139], a[24:27], v[82:85]
    v_exp_f32 v15, v15
    v_add_f32 v37, v37, v12
    v_mfma_f32_16x16x32_bf16 v[82:85], a[132:135], a[20:23], v[82:85]
    v_add_f32 v37, v37, v13
    v_add_f32 v37, v37, v14
    v_add_f32 v37, v37, v15
    v_mfma_f32_16x16x32_bf16 v[82:85], a[128:131], a[16:19], v[82:85]
    v_cvt_pk_bf16_f32 v64, v12, v13
    v_cvt_pk_bf16_f32 v65, v14, v15
    v_exp_f32 v78, v78
    v_exp_f32 v79, v79
    v_mfma_f32_16x16x32_bf16 v[128:131], v[62:65], a[144:147], 0
    v_exp_f32 v80, v80
    v_exp_f32 v81, v81
    v_add_f32 v37, v37, v78
    v_mfma_f32_16x16x32_bf16 v[132:135], v[62:65], a[148:151], 0
    v_add_f32 v37, v37, v79
    v_add_f32 v37, v37, v80
    v_mfma_f32_16x16x32_bf16 v[136:139], v[62:65], a[152:155], 0
    v_add_f32 v37, v37, v81
    v_cvt_pk_bf16_f32 v66, v78, v79
    v_mfma_f32_16x16x32_bf16 v[140:143], v[62:65], a[156:159], 0
    v_cvt_pk_bf16_f32 v67, v80, v81
    v_exp_f32 v82, v82
    v_mfma_f32_16x16x32_bf16 v[144:147], v[62:65], a[160:163], 0
    v_exp_f32 v83, v83
    v_exp_f32 v84, v84
    v_exp_f32 v85, v85
    v_mfma_f32_16x16x32_bf16 v[148:151], v[62:65], a[164:167], 0
    v_add_f32 v37, v37, v82
    v_add_f32 v37, v37, v83
    v_mfma_f32_16x16x32_bf16 v[152:155], v[62:65], a[168:171], 0
    v_add_f32 v37, v37, v84
    v_add_f32 v37, v37, v85
    v_mfma_f32_16x16x32_bf16 v[156:159], v[62:65], a[172:175], 0
    v_cvt_pk_bf16_f32 v68, v82, v83
    v_cvt_pk_bf16_f32 v69, v84, v85
    s_nop 1
    v_mfma_f32_16x16x32_bf16 v[128:131], v[66:69], a[176:179], v[128:131]
    v_mfma_f32_16x16x32_bf16 v[132:135], v[66:69], a[180:183], v[132:135]
    v_mfma_f32_16x16x32_bf16 v[136:139], v[66:69], a[184:187], v[136:139]
    v_mfma_f32_16x16x32_bf16 v[140:143], v[66:69], a[188:191], v[140:143]
    v_mfma_f32_16x16x32_bf16 v[144:147], v[66:69], a[192:195], v[144:147]
    v_mfma_f32_16x16x32_bf16 v[148:151], v[66:69], a[196:199], v[148:151]
    v_mfma_f32_16x16x32_bf16 v[152:155], v[66:69], a[200:203], v[152:155]
    v_mfma_f32_16x16x32_bf16 v[156:159], v[66:69], a[204:207], v[156:159]
    s_waitcnt vmcnt(8)
    ds_read_b128 v[224:227], v42 offset:8192
    ds_read_b128 v[228:231], v43 offset:8192
    ds_read_b128 v[232:235], v44 offset:8192
    ds_read_b128 v[236:239], v45 offset:8192
    s_add_u32 m0, s38, 0
    s_add_u32 s34, s36, 16384
    buffer_load_dwordx4 v90, s[12:15], s34 offen offset:0 nt lds
    buffer_load_dwordx4 v91, s[12:15], s34 offen offset:1024 nt lds
    buffer_load_dwordx4 v92, s[12:15], s34 offen offset:2048 nt lds
    buffer_load_dwordx4 v93, s[12:15], s34 offen offset:3072 nt lds
    s_waitcnt lgkmcnt(2)
    v_lshlrev_b32 v240, 16, v224
    v_and_b32 v241, 0xffff0000, v224
    v_lshlrev_b32 v242, 16, v225
    v_and_b32 v243, 0xffff0000, v225
    v_lshlrev_b32 v244, 16, v226
    v_and_b32 v245, 0xffff0000, v226
    v_lshlrev_b32 v246, 16, v227
    v_and_b32 v247, 0xffff0000, v227
    v_lshlrev_b32 v248, 16, v228
    v_and_b32 v249, 0xffff0000, v228
    v_lshlrev_b32 v250, 16, v229
    v_and_b32 v251, 0xffff0000, v229
    v_lshlrev_b32 v252, 16, v230
    v_and_b32 v253, 0xffff0000, v230
    v_lshlrev_b32 v254, 16, v231
    v_and_b32 v255, 0xffff0000, v231
    v_pk_mul_f32 v[240:241], v[240:241], s[32:33]
    v_pk_mul_f32 v[242:243], v[242:243], s[32:33]
    v_pk_mul_f32 v[244:245], v[244:245], s[32:33]
    v_pk_mul_f32 v[246:247], v[246:247], s[32:33]
    v_pk_mul_f32 v[248:249], v[248:249], s[32:33]
    v_pk_mul_f32 v[250:251], v[250:251], s[32:33]
    v_pk_mul_f32 v[252:253], v[252:253], s[32:33]
    v_pk_mul_f32 v[254:255], v[254:255], s[32:33]
    v_cvt_pk_bf16_f32 v240, v240, v241
    v_cvt_pk_bf16_f32 v242, v242, v243
    v_cvt_pk_bf16_f32 v244, v244, v245
    v_cvt_pk_bf16_f32 v246, v246, v247
    v_cvt_pk_bf16_f32 v248, v248, v249
    v_cvt_pk_bf16_f32 v250, v250, v251
    v_cvt_pk_bf16_f32 v252, v252, v253
    v_cvt_pk_bf16_f32 v254, v254, v255
    v_accvgpr_write_b32 a32, v240
    v_accvgpr_write_b32 a33, v242
    v_accvgpr_write_b32 a34, v244
    v_accvgpr_write_b32 a35, v246
    v_accvgpr_write_b32 a36, v248
    v_accvgpr_write_b32 a37, v250
    v_accvgpr_write_b32 a38, v252
    v_accvgpr_write_b32 a39, v254
    s_waitcnt lgkmcnt(0)
    v_lshlrev_b32 v240, 16, v232
    v_and_b32 v241, 0xffff0000, v232
    v_lshlrev_b32 v242, 16, v233
    v_and_b32 v243, 0xffff0000, v233
    v_lshlrev_b32 v244, 16, v234
    v_and_b32 v245, 0xffff0000, v234
    v_lshlrev_b32 v246, 16, v235
    v_and_b32 v247, 0xffff0000, v235
    v_lshlrev_b32 v248, 16, v236
    v_and_b32 v249, 0xffff0000, v236
    v_lshlrev_b32 v250, 16, v237
    v_and_b32 v251, 0xffff0000, v237
    v_lshlrev_b32 v252, 16, v238
    v_and_b32 v253, 0xffff0000, v238
    v_lshlrev_b32 v254, 16, v239
    v_and_b32 v255, 0xffff0000, v239
    v_pk_mul_f32 v[240:241], v[240:241], s[32:33]
    v_pk_mul_f32 v[242:243], v[242:243], s[32:33]
    v_pk_mul_f32 v[244:245], v[244:245], s[32:33]
    v_pk_mul_f32 v[246:247], v[246:247], s[32:33]
    v_pk_mul_f32 v[248:249], v[248:249], s[32:33]
    v_pk_mul_f32 v[250:251], v[250:251], s[32:33]
    v_pk_mul_f32 v[252:253], v[252:253], s[32:33]
    v_pk_mul_f32 v[254:255], v[254:255], s[32:33]
    v_cvt_pk_bf16_f32 v240, v240, v241
    v_cvt_pk_bf16_f32 v242, v242, v243
    v_cvt_pk_bf16_f32 v244, v244, v245
    v_cvt_pk_bf16_f32 v246, v246, v247
    v_cvt_pk_bf16_f32 v248, v248, v249
    v_cvt_pk_bf16_f32 v250, v250, v251
    v_cvt_pk_bf16_f32 v252, v252, v253
    v_cvt_pk_bf16_f32 v254, v254, v255
    v_accvgpr_write_b32 a40, v240
    v_accvgpr_write_b32 a41, v242
    v_accvgpr_write_b32 a42, v244
    v_accvgpr_write_b32 a43, v246
    v_accvgpr_write_b32 a44, v248
    v_accvgpr_write_b32 a45, v250
    v_accvgpr_write_b32 a46, v252
    v_accvgpr_write_b32 a47, v254
    v_mfma_f32_16x16x32_bf16 v[8:11], a[80:83], a[32:35], 0
    v_mfma_f32_16x16x32_bf16 v[8:11], a[84:87], a[36:39], v[8:11]
    v_mfma_f32_16x16x32_bf16 v[8:11], a[88:91], a[40:43], v[8:11]
    v_mfma_f32_16x16x32_bf16 v[8:11], a[92:95], a[44:47], v[8:11]
    s_cmp_lg_u32 s31, 0
    s_nop 5
    s_cbranch_scc1 L_km2_w5
    v_max3_f32 v24, v8, v9, v10
    v_max_f32 v24, v24, v11
    v_mov_b32 v25, v24
    s_nop 1
    v_permlane16_swap_b32 v24, v25
    v_max_f32 v24, v24, v25
    v_mov_b32 v25, v24
    s_nop 1
    v_permlane32_swap_b32 v24, v25
    v_max_f32 v24, v24, v25
    v_sub_f32 v25, 0xc1300000, v24
    v_sub_f32 v26, 0xc1300000, v24
    v_sub_f32 v27, 0xc1300000, v24
    v_sub_f32 v24, 0xc1300000, v24
L_km2_w5:
    s_nop 1
    v_mfma_f32_16x16x32_bf16 v[12:15], a[108:111], a[44:47], v[24:27]
    v_add_f32 v8, v8, v24
    v_add_f32 v9, v9, v24
    v_mfma_f32_16x16x32_bf16 v[12:15], a[104:107], a[40:43], v[12:15]
    v_add_f32 v10, v10, v24
    v_add_f32 v11, v11, v24
    v_mfma_f32_16x16x32_bf16 v[12:15], a[100:103], a[36:39], v[12:15]
    v_exp_f32 v8, v8
    v_exp_f32 v9, v9
    v_mfma_f32_16x16x32_bf16 v[12:15], a[96:99], a[32:35], v[12:15]
    v_exp_f32 v10, v10
    v_mfma_f32_16x16x32_bf16 v[78:81], a[112:115], a[32:35], v[24:27]
    v_exp_f32 v11, v11
    v_add_f32 v38, v38, v8
    v_mfma_f32_16x16x32_bf16 v[78:81], a[116:119], a[36:39], v[78:81]
    v_add_f32 v38, v38, v9
    v_add_f32 v38, v38, v10
    v_mfma_f32_16x16x32_bf16 v[78:81], a[120:123], a[40:43], v[78:81]
    v_add_f32 v38, v38, v11
    v_cvt_pk_bf16_f32 v54, v8, v9
    v_mfma_f32_16x16x32_bf16 v[78:81], a[124:127], a[44:47], v[78:81]
    v_cvt_pk_bf16_f32 v55, v10, v11
    v_mfma_f32_16x16x32_bf16 v[82:85], a[140:143], a[44:47], v[24:27]
    v_exp_f32 v12, v12
    v_exp_f32 v13, v13
    v_exp_f32 v14, v14
    v_mfma_f32_16x16x32_bf16 v[82:85], a[136:139], a[40:43], v[82:85]
    v_exp_f32 v15, v15
    v_add_f32 v38, v38, v12
    v_mfma_f32_16x16x32_bf16 v[82:85], a[132:135], a[36:39], v[82:85]
    v_add_f32 v38, v38, v13
    v_add_f32 v38, v38, v14
    v_add_f32 v38, v38, v15
    v_mfma_f32_16x16x32_bf16 v[82:85], a[128:131], a[32:35], v[82:85]
    v_cvt_pk_bf16_f32 v56, v12, v13
    v_cvt_pk_bf16_f32 v57, v14, v15
    v_exp_f32 v78, v78
    v_exp_f32 v79, v79
    v_mfma_f32_16x16x32_bf16 v[160:163], v[54:57], a[144:147], 0
    v_exp_f32 v80, v80
    v_exp_f32 v81, v81
    v_add_f32 v38, v38, v78
    v_mfma_f32_16x16x32_bf16 v[164:167], v[54:57], a[148:151], 0
    v_add_f32 v38, v38, v79
    v_add_f32 v38, v38, v80
    v_mfma_f32_16x16x32_bf16 v[168:171], v[54:57], a[152:155], 0
    v_add_f32 v38, v38, v81
    v_cvt_pk_bf16_f32 v58, v78, v79
    v_mfma_f32_16x16x32_bf16 v[172:175], v[54:57], a[156:159], 0
    v_cvt_pk_bf16_f32 v59, v80, v81
    v_exp_f32 v82, v82
    v_mfma_f32_16x16x32_bf16 v[176:179], v[54:57], a[160:163], 0
    v_exp_f32 v83, v83
    v_exp_f32 v84, v84
    v_exp_f32 v85, v85
    v_mfma_f32_16x16x32_bf16 v[180:183], v[54:57], a[164:167], 0
    v_add_f32 v38, v38, v82
    v_add_f32 v38, v38, v83
    v_mfma_f32_16x16x32_bf16 v[184:187], v[54:57], a[168:171], 0
    v_add_f32 v38, v38, v84
    v_add_f32 v38, v38, v85
    v_mfma_f32_16x16x32_bf16 v[188:191], v[54:57], a[172:175], 0
    v_cvt_pk_bf16_f32 v60, v82, v83
    v_cvt_pk_bf16_f32 v61, v84, v85
    s_nop 1
    v_mfma_f32_16x16x32_bf16 v[160:163], v[58:61], a[176:179], v[160:163]
    v_mfma_f32_16x16x32_bf16 v[164:167], v[58:61], a[180:183], v[164:167]
    v_mfma_f32_16x16x32_bf16 v[168:171], v[58:61], a[184:187], v[168:171]
    v_mfma_f32_16x16x32_bf16 v[172:175], v[58:61], a[188:191], v[172:175]
    v_mfma_f32_16x16x32_bf16 v[176:179], v[58:61], a[192:195], v[176:179]
    v_mfma_f32_16x16x32_bf16 v[180:183], v[58:61], a[196:199], v[180:183]
    v_mfma_f32_16x16x32_bf16 v[184:187], v[58:61], a[200:203], v[184:187]
    v_mfma_f32_16x16x32_bf16 v[188:191], v[58:61], a[204:207], v[188:191]
    s_waitcnt vmcnt(8)
    ds_read_b128 v[224:227], v42 offset:12288
    ds_read_b128 v[228:231], v43 offset:12288
    ds_read_b128 v[232:235], v44 offset:12288
    ds_read_b128 v[236:239], v45 offset:12288
    s_add_u32 m0, s37, 81920
    s_add_u32 s39, s37, 16384
    buffer_load_dwordx4 v94, s[20:23], s39 offen offset:0 nt lds
    buffer_load_dwordx4 v95, s[20:23], s39 offen offset:1024 nt lds
    buffer_load_dwordx4 v94, s[20:23], s39 offen offset:2048 nt lds
    buffer_load_dwordx4 v95, s[20:23], s39 offen offset:3072 nt lds
    s_waitcnt lgkmcnt(2)
    v_lshlrev_b32 v240, 16, v224
    v_and_b32 v241, 0xffff0000, v224
    v_lshlrev_b32 v242, 16, v225
    v_and_b32 v243, 0xffff0000, v225
    v_lshlrev_b32 v244, 16, v226
    v_and_b32 v245, 0xffff0000, v226
    v_lshlrev_b32 v246, 16, v227
    v_and_b32 v247, 0xffff0000, v227
    v_lshlrev_b32 v248, 16, v228
    v_and_b32 v249, 0xffff0000, v228
    v_lshlrev_b32 v250, 16, v229
    v_and_b32 v251, 0xffff0000, v229
    v_lshlrev_b32 v252, 16, v230
    v_and_b32 v253, 0xffff0000, v230
    v_lshlrev_b32 v254, 16, v231
    v_and_b32 v255, 0xffff0000, v231
    v_pk_mul_f32 v[240:241], v[240:241], s[32:33]
    v_pk_mul_f32 v[242:243], v[242:243], s[32:33]
    v_pk_mul_f32 v[244:245], v[244:245], s[32:33]
    v_pk_mul_f32 v[246:247], v[246:247], s[32:33]
    v_pk_mul_f32 v[248:249], v[248:249], s[32:33]
    v_pk_mul_f32 v[250:251], v[250:251], s[32:33]
    v_pk_mul_f32 v[252:253], v[252:253], s[32:33]
    v_pk_mul_f32 v[254:255], v[254:255], s[32:33]
    v_cvt_pk_bf16_f32 v240, v240, v241
    v_cvt_pk_bf16_f32 v242, v242, v243
    v_cvt_pk_bf16_f32 v244, v244, v245
    v_cvt_pk_bf16_f32 v246, v246, v247
    v_cvt_pk_bf16_f32 v248, v248, v249
    v_cvt_pk_bf16_f32 v250, v250, v251
    v_cvt_pk_bf16_f32 v252, v252, v253
    v_cvt_pk_bf16_f32 v254, v254, v255
    v_accvgpr_write_b32 a48, v240
    v_accvgpr_write_b32 a49, v242
    v_accvgpr_write_b32 a50, v244
    v_accvgpr_write_b32 a51, v246
    v_accvgpr_write_b32 a52, v248
    v_accvgpr_write_b32 a53, v250
    v_accvgpr_write_b32 a54, v252
    v_accvgpr_write_b32 a55, v254
    s_waitcnt lgkmcnt(0)
    v_lshlrev_b32 v240, 16, v232
    v_and_b32 v241, 0xffff0000, v232
    v_lshlrev_b32 v242, 16, v233
    v_and_b32 v243, 0xffff0000, v233
    v_lshlrev_b32 v244, 16, v234
    v_and_b32 v245, 0xffff0000, v234
    v_lshlrev_b32 v246, 16, v235
    v_and_b32 v247, 0xffff0000, v235
    v_lshlrev_b32 v248, 16, v236
    v_and_b32 v249, 0xffff0000, v236
    v_lshlrev_b32 v250, 16, v237
    v_and_b32 v251, 0xffff0000, v237
    v_lshlrev_b32 v252, 16, v238
    v_and_b32 v253, 0xffff0000, v238
    v_lshlrev_b32 v254, 16, v239
    v_and_b32 v255, 0xffff0000, v239
    v_pk_mul_f32 v[240:241], v[240:241], s[32:33]
    v_pk_mul_f32 v[242:243], v[242:243], s[32:33]
    v_pk_mul_f32 v[244:245], v[244:245], s[32:33]
    v_pk_mul_f32 v[246:247], v[246:247], s[32:33]
    v_pk_mul_f32 v[248:249], v[248:249], s[32:33]
    v_pk_mul_f32 v[250:251], v[250:251], s[32:33]
    v_pk_mul_f32 v[252:253], v[252:253], s[32:33]
    v_pk_mul_f32 v[254:255], v[254:255], s[32:33]
    v_cvt_pk_bf16_f32 v240, v240, v241
    v_cvt_pk_bf16_f32 v242, v242, v243
    v_cvt_pk_bf16_f32 v244, v244, v245
    v_cvt_pk_bf16_f32 v246, v246, v247
    v_cvt_pk_bf16_f32 v248, v248, v249
    v_cvt_pk_bf16_f32 v250, v250, v251
    v_cvt_pk_bf16_f32 v252, v252, v253
    v_cvt_pk_bf16_f32 v254, v254, v255
    v_accvgpr_write_b32 a56, v240
    v_accvgpr_write_b32 a57, v242
    v_accvgpr_write_b32 a58, v244
    v_accvgpr_write_b32 a59, v246
    v_accvgpr_write_b32 a60, v248
    v_accvgpr_write_b32 a61, v250
    v_accvgpr_write_b32 a62, v252
    v_accvgpr_write_b32 a63, v254
    v_mfma_f32_16x16x32_bf16 v[8:11], a[80:83], a[48:51], 0
    v_mfma_f32_16x16x32_bf16 v[8:11], a[84:87], a[52:55], v[8:11]
    v_mfma_f32_16x16x32_bf16 v[8:11], a[88:91], a[56:59], v[8:11]
    v_mfma_f32_16x16x32_bf16 v[8:11], a[92:95], a[60:63], v[8:11]
    s_cmp_lg_u32 s31, 0
    s_nop 5
    s_cbranch_scc1 L_km3_w5
    v_max3_f32 v28, v8, v9, v10
    v_max_f32 v28, v28, v11
    v_mov_b32 v29, v28
    s_nop 1
    v_permlane16_swap_b32 v28, v29
    v_max_f32 v28, v28, v29
    v_mov_b32 v29, v28
    s_nop 1
    v_permlane32_swap_b32 v28, v29
    v_max_f32 v28, v28, v29
    v_sub_f32 v29, 0xc1300000, v28
    v_sub_f32 v30, 0xc1300000, v28
    v_sub_f32 v31, 0xc1300000, v28
    v_sub_f32 v28, 0xc1300000, v28
L_km3_w5:
    s_nop 1
    v_mfma_f32_16x16x32_bf16 v[12:15], a[108:111], a[60:63], v[28:31]
    v_add_f32 v8, v8, v28
    v_add_f32 v9, v9, v28
    v_mfma_f32_16x16x32_bf16 v[12:15], a[104:107], a[56:59], v[12:15]
    v_add_f32 v10, v10, v28
    v_add_f32 v11, v11, v28
    v_mfma_f32_16x16x32_bf16 v[12:15], a[100:103], a[52:55], v[12:15]
    v_exp_f32 v8, v8
    v_exp_f32 v9, v9
    v_mfma_f32_16x16x32_bf16 v[12:15], a[96:99], a[48:51], v[12:15]
    v_exp_f32 v10, v10
    v_mfma_f32_16x16x32_bf16 v[78:81], a[112:115], a[48:51], v[28:31]
    v_exp_f32 v11, v11
    v_add_f32 v39, v39, v8
    v_mfma_f32_16x16x32_bf16 v[78:81], a[116:119], a[52:55], v[78:81]
    v_add_f32 v39, v39, v9
    v_add_f32 v39, v39, v10
    v_mfma_f32_16x16x32_bf16 v[78:81], a[120:123], a[56:59], v[78:81]
    v_add_f32 v39, v39, v11
    v_cvt_pk_bf16_f32 v62, v8, v9
    v_mfma_f32_16x16x32_bf16 v[78:81], a[124:127], a[60:63], v[78:81]
    v_cvt_pk_bf16_f32 v63, v10, v11
    v_mfma_f32_16x16x32_bf16 v[82:85], a[140:143], a[60:63], v[28:31]
    v_exp_f32 v12, v12
    v_exp_f32 v13, v13
    v_exp_f32 v14, v14
    v_mfma_f32_16x16x32_bf16 v[82:85], a[136:139], a[56:59], v[82:85]
    v_exp_f32 v15, v15
    v_add_f32 v39, v39, v12
    v_mfma_f32_16x16x32_bf16 v[82:85], a[132:135], a[52:55], v[82:85]
    v_add_f32 v39, v39, v13
    v_add_f32 v39, v39, v14
    v_add_f32 v39, v39, v15
    v_mfma_f32_16x16x32_bf16 v[82:85], a[128:131], a[48:51], v[82:85]
    v_cvt_pk_bf16_f32 v64, v12, v13
    v_cvt_pk_bf16_f32 v65, v14, v15
    v_exp_f32 v78, v78
    v_exp_f32 v79, v79
    v_mfma_f32_16x16x32_bf16 v[192:195], v[62:65], a[144:147], 0
    v_exp_f32 v80, v80
    v_exp_f32 v81, v81
    v_add_f32 v39, v39, v78
    v_mfma_f32_16x16x32_bf16 v[196:199], v[62:65], a[148:151], 0
    v_add_f32 v39, v39, v79
    v_add_f32 v39, v39, v80
    v_mfma_f32_16x16x32_bf16 v[200:203], v[62:65], a[152:155], 0
    v_add_f32 v39, v39, v81
    v_cvt_pk_bf16_f32 v66, v78, v79
    v_mfma_f32_16x16x32_bf16 v[204:207], v[62:65], a[156:159], 0
    v_cvt_pk_bf16_f32 v67, v80, v81
    v_exp_f32 v82, v82
    v_mfma_f32_16x16x32_bf16 v[208:211], v[62:65], a[160:163], 0
    v_exp_f32 v83, v83
    v_exp_f32 v84, v84
    v_exp_f32 v85, v85
    v_mfma_f32_16x16x32_bf16 v[212:215], v[62:65], a[164:167], 0
    v_add_f32 v39, v39, v82
    v_add_f32 v39, v39, v83
    v_mfma_f32_16x16x32_bf16 v[216:219], v[62:65], a[168:171], 0
    v_add_f32 v39, v39, v84
    v_add_f32 v39, v39, v85
    v_mfma_f32_16x16x32_bf16 v[220:223], v[62:65], a[172:175], 0
    v_cvt_pk_bf16_f32 v68, v82, v83
    v_cvt_pk_bf16_f32 v69, v84, v85
    s_nop 1
    v_mfma_f32_16x16x32_bf16 v[192:195], v[66:69], a[176:179], v[192:195]
    v_mfma_f32_16x16x32_bf16 v[196:199], v[66:69], a[180:183], v[196:199]
    v_mfma_f32_16x16x32_bf16 v[200:203], v[66:69], a[184:187], v[200:203]
    v_mfma_f32_16x16x32_bf16 v[204:207], v[66:69], a[188:191], v[204:207]
    v_mfma_f32_16x16x32_bf16 v[208:211], v[66:69], a[192:195], v[208:211]
    v_mfma_f32_16x16x32_bf16 v[212:215], v[66:69], a[196:199], v[212:215]
    v_mfma_f32_16x16x32_bf16 v[216:219], v[66:69], a[200:203], v[216:219]
    v_mfma_f32_16x16x32_bf16 v[220:223], v[66:69], a[204:207], v[220:223]
    s_waitcnt vmcnt(8)
    s_waitcnt vmcnt(4)
    ds_read_b128 v[224:227], v42 offset:0
    ds_read_b128 v[228:231], v43 offset:0
    ds_read_b128 v[232:235], v44 offset:0
    ds_read_b128 v[236:239], v45 offset:0
    v_subrev_u32 v42, s38, v42
    v_subrev_u32 v43, s38, v43
    v_subrev_u32 v44, s38, v44
    v_subrev_u32 v45, s38, v45
    s_waitcnt lgkmcnt(2)
    v_lshlrev_b32 v240, 16, v224
    v_and_b32 v241, 0xffff0000, v224
    v_lshlrev_b32 v242, 16, v225
    v_and_b32 v243, 0xffff0000, v225
    v_lshlrev_b32 v244, 16, v226
    v_and_b32 v245, 0xffff0000, v226
    v_lshlrev_b32 v246, 16, v227
    v_and_b32 v247, 0xffff0000, v227
    v_lshlrev_b32 v248, 16, v228
    v_and_b32 v249, 0xffff0000, v228
    v_lshlrev_b32 v250, 16, v229
    v_and_b32 v251, 0xffff0000, v229
    v_lshlrev_b32 v252, 16, v230
    v_and_b32 v253, 0xffff0000, v230
    v_lshlrev_b32 v254, 16, v231
    v_and_b32 v255, 0xffff0000, v231
    v_pk_mul_f32 v[240:241], v[240:241], s[32:33]
    v_pk_mul_f32 v[242:243], v[242:243], s[32:33]
    v_pk_mul_f32 v[244:245], v[244:245], s[32:33]
    v_pk_mul_f32 v[246:247], v[246:247], s[32:33]
    v_pk_mul_f32 v[248:249], v[248:249], s[32:33]
    v_pk_mul_f32 v[250:251], v[250:251], s[32:33]
    v_pk_mul_f32 v[252:253], v[252:253], s[32:33]
    v_pk_mul_f32 v[254:255], v[254:255], s[32:33]
    v_cvt_pk_bf16_f32 v240, v240, v241
    v_cvt_pk_bf16_f32 v242, v242, v243
    v_cvt_pk_bf16_f32 v244, v244, v245
    v_cvt_pk_bf16_f32 v246, v246, v247
    v_cvt_pk_bf16_f32 v248, v248, v249
    v_cvt_pk_bf16_f32 v250, v250, v251
    v_cvt_pk_bf16_f32 v252, v252, v253
    v_cvt_pk_bf16_f32 v254, v254, v255
    v_accvgpr_write_b32 a64, v240
    v_accvgpr_write_b32 a65, v242
    v_accvgpr_write_b32 a66, v244
    v_accvgpr_write_b32 a67, v246
    v_accvgpr_write_b32 a68, v248
    v_accvgpr_write_b32 a69, v250
    v_accvgpr_write_b32 a70, v252
    v_accvgpr_write_b32 a71, v254
    s_waitcnt lgkmcnt(0)
    v_lshlrev_b32 v240, 16, v232
    v_and_b32 v241, 0xffff0000, v232
    v_lshlrev_b32 v242, 16, v233
    v_and_b32 v243, 0xffff0000, v233
    v_lshlrev_b32 v244, 16, v234
    v_and_b32 v245, 0xffff0000, v234
    v_lshlrev_b32 v246, 16, v235
    v_and_b32 v247, 0xffff0000, v235
    v_lshlrev_b32 v248, 16, v236
    v_and_b32 v249, 0xffff0000, v236
    v_lshlrev_b32 v250, 16, v237
    v_and_b32 v251, 0xffff0000, v237
    v_lshlrev_b32 v252, 16, v238
    v_and_b32 v253, 0xffff0000, v238
    v_lshlrev_b32 v254, 16, v239
    v_and_b32 v255, 0xffff0000, v239
    v_pk_mul_f32 v[240:241], v[240:241], s[32:33]
    v_pk_mul_f32 v[242:243], v[242:243], s[32:33]
    v_pk_mul_f32 v[244:245], v[244:245], s[32:33]
    v_pk_mul_f32 v[246:247], v[246:247], s[32:33]
    v_pk_mul_f32 v[248:249], v[248:249], s[32:33]
    v_pk_mul_f32 v[250:251], v[250:251], s[32:33]
    v_pk_mul_f32 v[252:253], v[252:253], s[32:33]
    v_pk_mul_f32 v[254:255], v[254:255], s[32:33]
    v_cvt_pk_bf16_f32 v240, v240, v241
    v_cvt_pk_bf16_f32 v242, v242, v243
    v_cvt_pk_bf16_f32 v244, v244, v245
    v_cvt_pk_bf16_f32 v246, v246, v247
    v_cvt_pk_bf16_f32 v248, v248, v249
    v_cvt_pk_bf16_f32 v250, v250, v251
    v_cvt_pk_bf16_f32 v252, v252, v253
    v_cvt_pk_bf16_f32 v254, v254, v255
    v_accvgpr_write_b32 a72, v240
    v_accvgpr_write_b32 a73, v242
    v_accvgpr_write_b32 a74, v244
    v_accvgpr_write_b32 a75, v246
    v_accvgpr_write_b32 a76, v248
    v_accvgpr_write_b32 a77, v250
    v_accvgpr_write_b32 a78, v252
    v_accvgpr_write_b32 a79, v254
    v_mov_b32 v224, 0x0
    v_mov_b32 v225, 0x0
    v_mov_b32 v226, 0x0
    v_mov_b32 v227, 0x0
    v_mov_b32 v228, 0x0
    v_mov_b32 v229, 0x0
    v_mov_b32 v230, 0x0
    v_mov_b32 v231, 0x0
    v_mov_b32 v232, 0x0
    v_mov_b32 v233, 0x0
    v_mov_b32 v234, 0x0
    v_mov_b32 v235, 0x0
    v_mov_b32 v236, 0x0
    v_mov_b32 v237, 0x0
    v_mov_b32 v238, 0x0
    v_mov_b32 v239, 0x0
    v_mov_b32 v240, 0x0
    v_mov_b32 v241, 0x0
    v_mov_b32 v242, 0x0
    v_mov_b32 v243, 0x0
    v_mov_b32 v244, 0x0
    v_mov_b32 v245, 0x0
    v_mov_b32 v246, 0x0
    v_mov_b32 v247, 0x0
    v_mov_b32 v248, 0x0
    v_mov_b32 v249, 0x0
    v_mov_b32 v250, 0x0
    v_mov_b32 v251, 0x0
    v_mov_b32 v252, 0x0
    v_mov_b32 v253, 0x0
    v_mov_b32 v254, 0x0
    v_mov_b32 v255, 0x0
    v_mfma_f32_16x16x32_bf16 v[8:11], a[80:83], a[64:67], 0
    v_mfma_f32_16x16x32_bf16 v[8:11], a[84:87], a[68:71], v[8:11]
    v_mfma_f32_16x16x32_bf16 v[8:11], a[88:91], a[72:75], v[8:11]
    v_mfma_f32_16x16x32_bf16 v[8:11], a[92:95], a[76:79], v[8:11]
    s_cmp_lg_u32 s31, 0
    s_nop 5
    s_cbranch_scc1 L_km4_w5
    v_max3_f32 v32, v8, v9, v10
    v_max_f32 v32, v32, v11
    v_mov_b32 v33, v32
    s_nop 1
    v_permlane16_swap_b32 v32, v33
    v_max_f32 v32, v32, v33
    v_mov_b32 v33, v32
    s_nop 1
    v_permlane32_swap_b32 v32, v33
    v_max_f32 v32, v32, v33
    v_sub_f32 v33, 0xc1300000, v32
    v_sub_f32 v34, 0xc1300000, v32
    v_sub_f32 v35, 0xc1300000, v32
    v_sub_f32 v32, 0xc1300000, v32
L_km4_w5:
    s_nop 1
    v_mfma_f32_16x16x32_bf16 v[12:15], a[108:111], a[76:79], v[32:35]
    v_add_f32 v8, v8, v32
    v_add_f32 v9, v9, v32
    v_mfma_f32_16x16x32_bf16 v[12:15], a[104:107], a[72:75], v[12:15]
    v_add_f32 v10, v10, v32
    v_mfma_f32_16x16x32_bf16 v[12:15], a[100:103], a[68:71], v[12:15]
    v_add_f32 v11, v11, v32
    v_mfma_f32_16x16x32_bf16 v[12:15], a[96:99], a[64:67], v[12:15]
    v_exp_f32 v8, v8
    v_mfma_f32_16x16x32_bf16 v[78:81], a[112:115], a[64:67], v[32:35]
    v_exp_f32 v9, v9
    v_exp_f32 v10, v10
    v_mfma_f32_16x16x32_bf16 v[78:81], a[116:119], a[68:71], v[78:81]
    v_exp_f32 v11, v11
    v_mfma_f32_16x16x32_bf16 v[78:81], a[120:123], a[72:75], v[78:81]
    v_cvt_pk_bf16_f32 v54, v8, v9
    v_mfma_f32_16x16x32_bf16 v[78:81], a[124:127], a[76:79], v[78:81]
    v_cvt_pk_bf16_f32 v55, v10, v11
    v_mfma_f32_16x16x32_bf16 v[82:85], a[140:143], a[76:79], v[32:35]
    v_exp_f32 v12, v12
    v_exp_f32 v13, v13
    v_mfma_f32_16x16x32_bf16 v[82:85], a[136:139], a[72:75], v[82:85]
    v_exp_f32 v14, v14
    v_mfma_f32_16x16x32_bf16 v[82:85], a[132:135], a[68:71], v[82:85]
    v_exp_f32 v15, v15
    v_cvt_pk_bf16_f32 v56, v12, v13
    v_mfma_f32_16x16x32_bf16 v[82:85], a[128:131], a[64:67], v[82:85]
    v_cvt_pk_bf16_f32 v57, v14, v15
    v_exp_f32 v78, v78
    v_exp_f32 v79, v79
    v_exp_f32 v80, v80
    v_exp_f32 v81, v81
    v_cvt_pk_bf16_f32 v58, v78, v79
    v_cvt_pk_bf16_f32 v59, v80, v81
    s_waitcnt vmcnt(0)
    s_barrier
    ds_read_b128 a[80:83], v42 offset:16384
    ds_read_b128 a[84:87], v43 offset:16384
    ds_read_b128 a[88:91], v44 offset:16384
    ds_read_b128 a[92:95], v45 offset:16384
    ds_read_b128 a[108:111], v45 offset:20480
    ds_read_b128 a[104:107], v44 offset:20480
    ds_read_b128 a[100:103], v43 offset:20480
    ds_read_b128 a[96:99], v42 offset:20480
    ds_read_b128 a[112:115], v42 offset:24576
    ds_read_b128 a[116:119], v43 offset:24576
    ds_read_b128 a[120:123], v44 offset:24576
    ds_read_b128 a[124:127], v45 offset:24576
    ds_read_b128 a[140:143], v45 offset:28672
    ds_read_b128 a[136:139], v44 offset:28672
    ds_read_b128 a[132:135], v43 offset:28672
    ds_read_b128 a[128:131], v42 offset:28672
    ds_read_b64_tr_b16 a[212:213], v46 offset:16384
    ds_read_b64_tr_b16 a[214:215], v46 offset:20480
    ds_read_b64_tr_b16 a[216:217], v46 offset:24576
    ds_read_b64_tr_b16 a[218:219], v46 offset:28672
    ds_read_b64_tr_b16 a[220:221], v47 offset:16384
    ds_read_b64_tr_b16 a[222:223], v47 offset:20480
    ds_read_b64_tr_b16 a[224:225], v47 offset:24576
    ds_read_b64_tr_b16 a[226:227], v47 offset:28672
    ds_read_b64_tr_b16 a[228:229], v50 offset:16384
    s_waitcnt lgkmcnt(0)
    s_branch L_entry_w5
L_start_w4:
    v_accvgpr_write_b32 a64, 0
    v_accvgpr_write_b32 a65, 0
    v_accvgpr_write_b32 a66, 0
    v_accvgpr_write_b32 a67, 0
    v_accvgpr_write_b32 a68, 0
    v_accvgpr_write_b32 a69, 0
    v_accvgpr_write_b32 a70, 0
    v_accvgpr_write_b32 a71, 0
    v_accvgpr_write_b32 a72, 0
    v_accvgpr_write_b32 a73, 0
    v_accvgpr_write_b32 a74, 0
    v_accvgpr_write_b32 a75, 0
    v_accvgpr_write_b32 a76, 0
    v_accvgpr_write_b32 a77, 0
    v_accvgpr_write_b32 a78, 0
    v_accvgpr_write_b32 a79, 0
    s_waitcnt vmcnt(8)
    ds_read_b128 v[192:195], v42 offset:0
    ds_read_b128 v[196:199], v43 offset:0
    ds_read_b128 v[200:203], v44 offset:0
    ds_read_b128 v[204:207], v45 offset:0
    s_add_u32 m0, s38, 8192
    s_add_u32 s34, s36, 8192
    buffer_load_dwordx4 v90, s[12:15], s34 offen offset:0 nt lds
    buffer_load_dwordx4 v91, s[12:15], s34 offen offset:1024 nt lds
    buffer_load_dwordx4 v92, s[12:15], s34 offen offset:2048 nt lds
    buffer_load_dwordx4 v93, s[12:15], s34 offen offset:3072 nt lds
    s_waitcnt lgkmcnt(2)
    v_lshlrev_b32 v208, 16, v192
    v_and_b32 v209, 0xffff0000, v192
    v_lshlrev_b32 v210, 16, v193
    v_and_b32 v211, 0xffff0000, v193
    v_lshlrev_b32 v212, 16, v194
    v_and_b32 v213, 0xffff0000, v194
    v_lshlrev_b32 v214, 16, v195
    v_and_b32 v215, 0xffff0000, v195
    v_lshlrev_b32 v216, 16, v196
    v_and_b32 v217, 0xffff0000, v196
    v_lshlrev_b32 v218, 16, v197
    v_and_b32 v219, 0xffff0000, v197
    v_lshlrev_b32 v220, 16, v198
    v_and_b32 v221, 0xffff0000, v198
    v_lshlrev_b32 v222, 16, v199
    v_and_b32 v223, 0xffff0000, v199
    v_pk_mul_f32 v[208:209], v[208:209], s[32:33]
    v_pk_mul_f32 v[210:211], v[210:211], s[32:33]
    v_pk_mul_f32 v[212:213], v[212:213], s[32:33]
    v_pk_mul_f32 v[214:215], v[214:215], s[32:33]
    v_pk_mul_f32 v[216:217], v[216:217], s[32:33]
    v_pk_mul_f32 v[218:219], v[218:219], s[32:33]
    v_pk_mul_f32 v[220:221], v[220:221], s[32:33]
    v_pk_mul_f32 v[222:223], v[222:223], s[32:33]
    v_cvt_pk_bf16_f32 v208, v208, v209
    v_cvt_pk_bf16_f32 v210, v210, v211
    v_cvt_pk_bf16_f32 v212, v212, v213
    v_cvt_pk_bf16_f32 v214, v214, v215
    v_cvt_pk_bf16_f32 v216, v216, v217
    v_cvt_pk_bf16_f32 v218, v218, v219
    v_cvt_pk_bf16_f32 v220, v220, v221
    v_cvt_pk_bf16_f32 v222, v222, v223
    v_accvgpr_write_b32 a0, v208
    v_accvgpr_write_b32 a1, v210
    v_accvgpr_write_b32 a2, v212
    v_accvgpr_write_b32 a3, v214
    v_accvgpr_write_b32 a4, v216
    v_accvgpr_write_b32 a5, v218
    v_accvgpr_write_b32 a6, v220
    v_accvgpr_write_b32 a7, v222
    s_waitcnt lgkmcnt(0)
    v_lshlrev_b32 v208, 16, v200
    v_and_b32 v209, 0xffff0000, v200
    v_lshlrev_b32 v210, 16, v201
    v_and_b32 v211, 0xffff0000, v201
    v_lshlrev_b32 v212, 16, v202
    v_and_b32 v213, 0xffff0000, v202
    v_lshlrev_b32 v214, 16, v203
    v_and_b32 v215, 0xffff0000, v203
    v_lshlrev_b32 v216, 16, v204
    v_and_b32 v217, 0xffff0000, v204
    v_lshlrev_b32 v218, 16, v205
    v_and_b32 v219, 0xffff0000, v205
    v_lshlrev_b32 v220, 16, v206
    v_and_b32 v221, 0xffff0000, v206
    v_lshlrev_b32 v222, 16, v207
    v_and_b32 v223, 0xffff0000, v207
    v_pk_mul_f32 v[208:209], v[208:209], s[32:33]
    v_pk_mul_f32 v[210:211], v[210:211], s[32:33]
    v_pk_mul_f32 v[212:213], v[212:213], s[32:33]
    v_pk_mul_f32 v[214:215], v[214:215], s[32:33]
    v_pk_mul_f32 v[216:217], v[216:217], s[32:33]
    v_pk_mul_f32 v[218:219], v[218:219], s[32:33]
    v_pk_mul_f32 v[220:221], v[220:221], s[32:33]
    v_pk_mul_f32 v[222:223], v[222:223], s[32:33]
    v_cvt_pk_bf16_f32 v208, v208, v209
    v_cvt_pk_bf16_f32 v210, v210, v211
    v_cvt_pk_bf16_f32 v212, v212, v213
    v_cvt_pk_bf16_f32 v214, v214, v215
    v_cvt_pk_bf16_f32 v216, v216, v217
    v_cvt_pk_bf16_f32 v218, v218, v219
    v_cvt_pk_bf16_f32 v220, v220, v221
    v_cvt_pk_bf16_f32 v222, v222, v223
    v_accvgpr_write_b32 a8, v208
    v_accvgpr_write_b32 a9, v210
    v_accvgpr_write_b32 a10, v212
    v_accvgpr_write_b32 a11, v214
    v_accvgpr_write_b32 a12, v216
    v_accvgpr_write_b32 a13, v218
    v_accvgpr_write_b32 a14, v220
    v_accvgpr_write_b32 a15, v222
    v_mfma_f32_16x16x32_bf16 v[8:11], a[80:83], a[0:3], 0
    v_mfma_f32_16x16x32_bf16 v[8:11], a[84:87], a[4:7], v[8:11]
    v_mfma_f32_16x16x32_bf16 v[8:11], a[88:91], a[8:11], v[8:11]
    v_mfma_f32_16x16x32_bf16 v[8:11], a[92:95], a[12:15], v[8:11]
    s_cmp_lg_u32 s31, 0
    s_nop 5
    s_cbranch_scc1 L_km0_w4
    v_max3_f32 v16, v8, v9, v10
    v_max_f32 v16, v16, v11
    v_mov_b32 v17, v16
    s_nop 1
    v_permlane16_swap_b32 v16, v17
    v_max_f32 v16, v16, v17
    v_mov_b32 v17, v16
    s_nop 1
    v_permlane32_swap_b32 v16, v17
    v_max_f32 v16, v16, v17
    v_sub_f32 v17, 0xc1300000, v16
    v_sub_f32 v18, 0xc1300000, v16
    v_sub_f32 v19, 0xc1300000, v16
    v_sub_f32 v16, 0xc1300000, v16
L_km0_w4:
    s_nop 1
    v_mfma_f32_16x16x32_bf16 v[12:15], a[108:111], a[12:15], v[16:19]
    v_add_f32 v8, v8, v16
    v_add_f32 v9, v9, v16
    v_mfma_f32_16x16x32_bf16 v[12:15], a[104:107], a[8:11], v[12:15]
    v_add_f32 v10, v10, v16
    v_mfma_f32_16x16x32_bf16 v[12:15], a[100:103], a[4:7], v[12:15]
    v_add_f32 v11, v11, v16
    v_mfma_f32_16x16x32_bf16 v[12:15], a[96:99], a[0:3], v[12:15]
    v_exp_f32 v8, v8
    v_mfma_f32_16x16x32_bf16 v[78:81], a[112:115], a[0:3], v[16:19]
    v_exp_f32 v9, v9
    v_exp_f32 v10, v10
    v_mfma_f32_16x16x32_bf16 v[78:81], a[116:119], a[4:7], v[78:81]
    v_exp_f32 v11, v11
    v_mfma_f32_16x16x32_bf16 v[78:81], a[120:123], a[8:11], v[78:81]
    v_cvt_pk_bf16_f32 v54, v8, v9
    v_mfma_f32_16x16x32_bf16 v[78:81], a[124:127], a[12:15], v[78:81]
    v_cvt_pk_bf16_f32 v55, v10, v11
    v_mfma_f32_16x16x32_bf16 v[82:85], a[140:143], a[12:15], v[16:19]
    v_exp_f32 v12, v12
    v_exp_f32 v13, v13
    v_mfma_f32_16x16x32_bf16 v[82:85], a[136:139], a[8:11], v[82:85]
    v_exp_f32 v14, v14
    v_mfma_f32_16x16x32_bf16 v[82:85], a[132:135], a[4:7], v[82:85]
    v_exp_f32 v15, v15
    v_cvt_pk_bf16_f32 v56, v12, v13
    v_mfma_f32_16x16x32_bf16 v[82:85], a[128:131], a[0:3], v[82:85]
    v_cvt_pk_bf16_f32 v57, v14, v15
    v_exp_f32 v78, v78
    v_exp_f32 v79, v79
    v_exp_f32 v80, v80
    v_exp_f32 v81, v81
    v_cvt_pk_bf16_f32 v58, v78, v79
    v_cvt_pk_bf16_f32 v59, v80, v81
    s_nop 0
    v_exp_f32 v82, v82
    v_exp_f32 v83, v83
    v_exp_f32 v84, v84
    v_exp_f32 v85, v85
    v_cvt_pk_bf16_f32 v60, v82, v83
    v_cvt_pk_bf16_f32 v61, v84, v85
    s_waitcnt vmcnt(8)
    s_add_u32 m0, s37, 16384
    s_add_u32 s30, s37, 16384
    buffer_load_dwordx4 v90, s[16:19], s30 offen offset:0 nt lds
    buffer_load_dwordx4 v91, s[16:19], s30 offen offset:1024 nt lds
    buffer_load_dwordx4 v92, s[16:19], s30 offen offset:2048 nt lds
    buffer_load_dwordx4 v93, s[16:19], s30 offen offset:3072 nt lds
    s_barrier
    ds_read_b64_tr_b16 a[144:145], v46 offset:0
    ds_read_b64_tr_b16 a[146:147], v46 offset:4096
    ds_read_b64_tr_b16 a[148:149], v47 offset:0
    ds_read_b64_tr_b16 a[150:151], v47 offset:4096
    ds_read_b64_tr_b16 a[152:153], v48 offset:0
    ds_read_b64_tr_b16 a[154:155], v48 offset:4096
    ds_read_b64_tr_b16 a[156:157], v49 offset:0
    ds_read_b64_tr_b16 a[158:159], v49 offset:4096
    ds_read_b64_tr_b16 a[160:161], v50 offset:0
    ds_read_b64_tr_b16 a[162:163], v50 offset:4096
    ds_read_b64_tr_b16 a[164:165], v51 offset:0
    ds_read_b64_tr_b16 a[166:167], v51 offset:4096
    ds_read_b64_tr_b16 a[168:169], v52 offset:0
    ds_read_b64_tr_b16 a[170:171], v52 offset:4096
    ds_read_b64_tr_b16 a[172:173], v53 offset:0
    ds_read_b64_tr_b16 a[174:175], v53 offset:4096
    ds_read_b64_tr_b16 a[176:177], v46 offset:8192
    ds_read_b64_tr_b16 a[178:179], v46 offset:12288
    ds_read_b64_tr_b16 a[180:181], v47 offset:8192
    ds_read_b64_tr_b16 a[182:183], v47 offset:12288
    ds_read_b64_tr_b16 a[184:185], v48 offset:8192
    ds_read_b64_tr_b16 a[186:187], v48 offset:12288
    ds_read_b64_tr_b16 a[188:189], v49 offset:8192
    ds_read_b64_tr_b16 a[190:191], v49 offset:12288
    ds_read_b64_tr_b16 a[192:193], v50 offset:8192
    ds_read_b64_tr_b16 a[194:195], v50 offset:12288
    ds_read_b64_tr_b16 a[196:197], v51 offset:8192
    ds_read_b64_tr_b16 a[198:199], v51 offset:12288
    ds_read_b64_tr_b16 a[200:201], v52 offset:8192
    ds_read_b64_tr_b16 a[202:203], v52 offset:12288
    ds_read_b64_tr_b16 a[204:205], v53 offset:8192
    ds_read_b64_tr_b16 a[206:207], v53 offset:12288
    s_waitcnt lgkmcnt(0)
    v_mfma_f32_16x16x32_bf16 v[96:99], v[54:57], a[144:147], 0
    v_mfma_f32_16x16x32_bf16 v[100:103], v[54:57], a[148:151], 0
    v_mfma_f32_16x16x32_bf16 v[104:107], v[54:57], a[152:155], 0
    v_mfma_f32_16x16x32_bf16 v[108:111], v[54:57], a[156:159], 0
    v_mfma_f32_16x16x32_bf16 v[112:115], v[54:57], a[160:163], 0
    v_mfma_f32_16x16x32_bf16 v[116:119], v[54:57], a[164:167], 0
    v_mfma_f32_16x16x32_bf16 v[120:123], v[54:57], a[168:171], 0
    v_mfma_f32_16x16x32_bf16 v[124:127], v[54:57], a[172:175], 0
    v_mfma_f32_16x16x32_bf16 v[96:99], v[58:61], a[176:179], v[96:99]
    v_mfma_f32_16x16x32_bf16 v[100:103], v[58:61], a[180:183], v[100:103]
    v_mfma_f32_16x16x32_bf16 v[104:107], v[58:61], a[184:187], v[104:107]
    v_mfma_f32_16x16x32_bf16 v[108:111], v[58:61], a[188:191], v[108:111]
    v_mfma_f32_16x16x32_bf16 v[112:115], v[58:61], a[192:195], v[112:115]
    v_mfma_f32_16x16x32_bf16 v[116:119], v[58:61], a[196:199], v[116:119]
    v_mfma_f32_16x16x32_bf16 v[120:123], v[58:61], a[200:203], v[120:123]
    v_mfma_f32_16x16x32_bf16 v[124:127], v[58:61], a[204:207], v[124:127]
    v_smfmac_f32_16x16x64_bf16 a[64:67], a[208:211], v[54:61], v41
    s_waitcnt vmcnt(8)
    ds_read_b128 v[192:195], v42 offset:4096
    ds_read_b128 v[196:199], v43 offset:4096
    ds_read_b128 v[200:203], v44 offset:4096
    ds_read_b128 v[204:207], v45 offset:4096
    s_add_u32 m0, s38, 12288
    s_add_u32 s34, s36, 12288
    buffer_load_dwordx4 v90, s[12:15], s34 offen offset:0 nt lds
    buffer_load_dwordx4 v91, s[12:15], s34 offen offset:1024 nt lds
    buffer_load_dwordx4 v92, s[12:15], s34 offen offset:2048 nt lds
    buffer_load_dwordx4 v93, s[12:15], s34 offen offset:3072 nt lds
    s_waitcnt lgkmcnt(2)
    v_lshlrev_b32 v208, 16, v192
    v_and_b32 v209, 0xffff0000, v192
    v_lshlrev_b32 v210, 16, v193
    v_and_b32 v211, 0xffff0000, v193
    v_lshlrev_b32 v212, 16, v194
    v_and_b32 v213, 0xffff0000, v194
    v_lshlrev_b32 v214, 16, v195
    v_and_b32 v215, 0xffff0000, v195
    v_lshlrev_b32 v216, 16, v196
    v_and_b32 v217, 0xffff0000, v196
    v_lshlrev_b32 v218, 16, v197
    v_and_b32 v219, 0xffff0000, v197
    v_lshlrev_b32 v220, 16, v198
    v_and_b32 v221, 0xffff0000, v198
    v_lshlrev_b32 v222, 16, v199
    v_and_b32 v223, 0xffff0000, v199
    v_pk_mul_f32 v[208:209], v[208:209], s[32:33]
    v_pk_mul_f32 v[210:211], v[210:211], s[32:33]
    v_pk_mul_f32 v[212:213], v[212:213], s[32:33]
    v_pk_mul_f32 v[214:215], v[214:215], s[32:33]
    v_pk_mul_f32 v[216:217], v[216:217], s[32:33]
    v_pk_mul_f32 v[218:219], v[218:219], s[32:33]
    v_pk_mul_f32 v[220:221], v[220:221], s[32:33]
    v_pk_mul_f32 v[222:223], v[222:223], s[32:33]
    v_cvt_pk_bf16_f32 v208, v208, v209
    v_cvt_pk_bf16_f32 v210, v210, v211
    v_cvt_pk_bf16_f32 v212, v212, v213
    v_cvt_pk_bf16_f32 v214, v214, v215
    v_cvt_pk_bf16_f32 v216, v216, v217
    v_cvt_pk_bf16_f32 v218, v218, v219
    v_cvt_pk_bf16_f32 v220, v220, v221
    v_cvt_pk_bf16_f32 v222, v222, v223
    v_accvgpr_write_b32 a16, v208
    v_accvgpr_write_b32 a17, v210
    v_accvgpr_write_b32 a18, v212
    v_accvgpr_write_b32 a19, v214
    v_accvgpr_write_b32 a20, v216
    v_accvgpr_write_b32 a21, v218
    v_accvgpr_write_b32 a22, v220
    v_accvgpr_write_b32 a23, v222
    s_waitcnt lgkmcnt(0)
    v_lshlrev_b32 v208, 16, v200
    v_and_b32 v209, 0xffff0000, v200
    v_lshlrev_b32 v210, 16, v201
    v_and_b32 v211, 0xffff0000, v201
    v_lshlrev_b32 v212, 16, v202
    v_and_b32 v213, 0xffff0000, v202
    v_lshlrev_b32 v214, 16, v203
    v_and_b32 v215, 0xffff0000, v203
    v_lshlrev_b32 v216, 16, v204
    v_and_b32 v217, 0xffff0000, v204
    v_lshlrev_b32 v218, 16, v205
    v_and_b32 v219, 0xffff0000, v205
    v_lshlrev_b32 v220, 16, v206
    v_and_b32 v221, 0xffff0000, v206
    v_lshlrev_b32 v222, 16, v207
    v_and_b32 v223, 0xffff0000, v207
    v_pk_mul_f32 v[208:209], v[208:209], s[32:33]
    v_pk_mul_f32 v[210:211], v[210:211], s[32:33]
    v_pk_mul_f32 v[212:213], v[212:213], s[32:33]
    v_pk_mul_f32 v[214:215], v[214:215], s[32:33]
    v_pk_mul_f32 v[216:217], v[216:217], s[32:33]
    v_pk_mul_f32 v[218:219], v[218:219], s[32:33]
    v_pk_mul_f32 v[220:221], v[220:221], s[32:33]
    v_pk_mul_f32 v[222:223], v[222:223], s[32:33]
    v_cvt_pk_bf16_f32 v208, v208, v209
    v_cvt_pk_bf16_f32 v210, v210, v211
    v_cvt_pk_bf16_f32 v212, v212, v213
    v_cvt_pk_bf16_f32 v214, v214, v215
    v_cvt_pk_bf16_f32 v216, v216, v217
    v_cvt_pk_bf16_f32 v218, v218, v219
    v_cvt_pk_bf16_f32 v220, v220, v221
    v_cvt_pk_bf16_f32 v222, v222, v223
    v_accvgpr_write_b32 a24, v208
    v_accvgpr_write_b32 a25, v210
    v_accvgpr_write_b32 a26, v212
    v_accvgpr_write_b32 a27, v214
    v_accvgpr_write_b32 a28, v216
    v_accvgpr_write_b32 a29, v218
    v_accvgpr_write_b32 a30, v220
    v_accvgpr_write_b32 a31, v222
    v_mfma_f32_16x16x32_bf16 v[8:11], a[80:83], a[16:19], 0
    v_mfma_f32_16x16x32_bf16 v[8:11], a[84:87], a[20:23], v[8:11]
    v_mfma_f32_16x16x32_bf16 v[8:11], a[88:91], a[24:27], v[8:11]
    v_mfma_f32_16x16x32_bf16 v[8:11], a[92:95], a[28:31], v[8:11]
    s_cmp_lg_u32 s31, 0
    s_nop 5
    s_cbranch_scc1 L_km1_w4
    v_max3_f32 v20, v8, v9, v10
    v_max_f32 v20, v20, v11
    v_mov_b32 v21, v20
    s_nop 1
    v_permlane16_swap_b32 v20, v21
    v_max_f32 v20, v20, v21
    v_mov_b32 v21, v20
    s_nop 1
    v_permlane32_swap_b32 v20, v21
    v_max_f32 v20, v20, v21
    v_sub_f32 v21, 0xc1300000, v20
    v_sub_f32 v22, 0xc1300000, v20
    v_sub_f32 v23, 0xc1300000, v20
    v_sub_f32 v20, 0xc1300000, v20
L_km1_w4:
    s_nop 1
    v_mfma_f32_16x16x32_bf16 v[12:15], a[108:111], a[28:31], v[20:23]
    v_add_f32 v8, v8, v20
    v_add_f32 v9, v9, v20
    v_mfma_f32_16x16x32_bf16 v[12:15], a[104:107], a[24:27], v[12:15]
    v_add_f32 v10, v10, v20
    v_mfma_f32_16x16x32_bf16 v[12:15], a[100:103], a[20:23], v[12:15]
    v_add_f32 v11, v11, v20
    v_mfma_f32_16x16x32_bf16 v[12:15], a[96:99], a[16:19], v[12:15]
    v_exp_f32 v8, v8
    v_mfma_f32_16x16x32_bf16 v[78:81], a[112:115], a[16:19], v[20:23]
    v_exp_f32 v9, v9
    v_exp_f32 v10, v10
    v_mfma_f32_16x16x32_bf16 v[78:81], a[116:119], a[20:23], v[78:81]
    v_exp_f32 v11, v11
    v_mfma_f32_16x16x32_bf16 v[78:81], a[120:123], a[24:27], v[78:81]
    v_cvt_pk_bf16_f32 v62, v8, v9
    v_mfma_f32_16x16x32_bf16 v[78:81], a[124:127], a[28:31], v[78:81]
    v_cvt_pk_bf16_f32 v63, v10, v11
    v_mfma_f32_16x16x32_bf16 v[82:85], a[140:143], a[28:31], v[20:23]
    v_exp_f32 v12, v12
    v_exp_f32 v13, v13
    v_mfma_f32_16x16x32_bf16 v[82:85], a[136:139], a[24:27], v[82:85]
    v_exp_f32 v14, v14
    v_mfma_f32_16x16x32_bf16 v[82:85], a[132:135], a[20:23], v[82:85]
    v_exp_f32 v15, v15
    v_cvt_pk_bf16_f32 v64, v12, v13
    v_mfma_f32_16x16x32_bf16 v[82:85], a[128:131], a[16:19], v[82:85]
    v_cvt_pk_bf16_f32 v65, v14, v15
    v_exp_f32 v78, v78
    v_exp_f32 v79, v79
    v_mfma_f32_16x16x32_bf16 v[128:131], v[62:65], a[144:147], 0
    v_exp_f32 v80, v80
    v_exp_f32 v81, v81
    v_mfma_f32_16x16x32_bf16 v[132:135], v[62:65], a[148:151], 0
    v_cvt_pk_bf16_f32 v66, v78, v79
    v_mfma_f32_16x16x32_bf16 v[136:139], v[62:65], a[152:155], 0
    v_cvt_pk_bf16_f32 v67, v80, v81
    v_mfma_f32_16x16x32_bf16 v[140:143], v[62:65], a[156:159], 0
    v_exp_f32 v82, v82
    v_mfma_f32_16x16x32_bf16 v[144:147], v[62:65], a[160:163], 0
    v_exp_f32 v83, v83
    v_exp_f32 v84, v84
    v_mfma_f32_16x16x32_bf16 v[148:151], v[62:65], a[164:167], 0
    v_exp_f32 v85, v85
    v_mfma_f32_16x16x32_bf16 v[152:155], v[62:65], a[168:171], 0
    v_cvt_pk_bf16_f32 v68, v82, v83
    v_mfma_f32_16x16x32_bf16 v[156:159], v[62:65], a[172:175], 0
    v_cvt_pk_bf16_f32 v69, v84, v85
    s_nop 1
    v_mfma_f32_16x16x32_bf16 v[128:131], v[66:69], a[176:179], v[128:131]
    v_mfma_f32_16x16x32_bf16 v[132:135], v[66:69], a[180:183], v[132:135]
    v_mfma_f32_16x16x32_bf16 v[136:139], v[66:69], a[184:187], v[136:139]
    v_mfma_f32_16x16x32_bf16 v[140:143], v[66:69], a[188:191], v[140:143]
    v_mfma_f32_16x16x32_bf16 v[144:147], v[66:69], a[192:195], v[144:147]
    v_mfma_f32_16x16x32_bf16 v[148:151], v[66:69], a[196:199], v[148:151]
    v_mfma_f32_16x16x32_bf16 v[152:155], v[66:69], a[200:203], v[152:155]
    v_mfma_f32_16x16x32_bf16 v[156:159], v[66:69], a[204:207], v[156:159]
    v_smfmac_f32_16x16x64_bf16 a[68:71], a[208:211], v[62:69], v41
    s_waitcnt vmcnt(8)
    ds_read_b128 v[192:195], v42 offset:8192
    ds_read_b128 v[196:199], v43 offset:8192
    ds_read_b128 v[200:203], v44 offset:8192
    ds_read_b128 v[204:207], v45 offset:8192
    s_add_u32 m0, s37, 81920
    s_add_u32 s39, s37, 16384
    buffer_load_dwordx4 v94, s[20:23], s39 offen offset:0 nt lds
    buffer_load_dwordx4 v95, s[20:23], s39 offen offset:1024 nt lds
    buffer_load_dwordx4 v94, s[20:23], s39 offen offset:2048 nt lds
    buffer_load_dwordx4 v95, s[20:23], s39 offen offset:3072 nt lds
    s_waitcnt lgkmcnt(2)
    v_lshlrev_b32 v208, 16, v192
    v_and_b32 v209, 0xffff0000, v192
    v_lshlrev_b32 v210, 16, v193
    v_and_b32 v211, 0xffff0000, v193
    v_lshlrev_b32 v212, 16, v194
    v_and_b32 v213, 0xffff0000, v194
    v_lshlrev_b32 v214, 16, v195
    v_and_b32 v215, 0xffff0000, v195
    v_lshlrev_b32 v216, 16, v196
    v_and_b32 v217, 0xffff0000, v196
    v_lshlrev_b32 v218, 16, v197
    v_and_b32 v219, 0xffff0000, v197
    v_lshlrev_b32 v220, 16, v198
    v_and_b32 v221, 0xffff0000, v198
    v_lshlrev_b32 v222, 16, v199
    v_and_b32 v223, 0xffff0000, v199
    v_pk_mul_f32 v[208:209], v[208:209], s[32:33]
    v_pk_mul_f32 v[210:211], v[210:211], s[32:33]
    v_pk_mul_f32 v[212:213], v[212:213], s[32:33]
    v_pk_mul_f32 v[214:215], v[214:215], s[32:33]
    v_pk_mul_f32 v[216:217], v[216:217], s[32:33]
    v_pk_mul_f32 v[218:219], v[218:219], s[32:33]
    v_pk_mul_f32 v[220:221], v[220:221], s[32:33]
    v_pk_mul_f32 v[222:223], v[222:223], s[32:33]
    v_cvt_pk_bf16_f32 v208, v208, v209
    v_cvt_pk_bf16_f32 v210, v210, v211
    v_cvt_pk_bf16_f32 v212, v212, v213
    v_cvt_pk_bf16_f32 v214, v214, v215
    v_cvt_pk_bf16_f32 v216, v216, v217
    v_cvt_pk_bf16_f32 v218, v218, v219
    v_cvt_pk_bf16_f32 v220, v220, v221
    v_cvt_pk_bf16_f32 v222, v222, v223
    v_accvgpr_write_b32 a32, v208
    v_accvgpr_write_b32 a33, v210
    v_accvgpr_write_b32 a34, v212
    v_accvgpr_write_b32 a35, v214
    v_accvgpr_write_b32 a36, v216
    v_accvgpr_write_b32 a37, v218
    v_accvgpr_write_b32 a38, v220
    v_accvgpr_write_b32 a39, v222
    s_waitcnt lgkmcnt(0)
    v_lshlrev_b32 v208, 16, v200
    v_and_b32 v209, 0xffff0000, v200
    v_lshlrev_b32 v210, 16, v201
    v_and_b32 v211, 0xffff0000, v201
    v_lshlrev_b32 v212, 16, v202
    v_and_b32 v213, 0xffff0000, v202
    v_lshlrev_b32 v214, 16, v203
    v_and_b32 v215, 0xffff0000, v203
    v_lshlrev_b32 v216, 16, v204
    v_and_b32 v217, 0xffff0000, v204
    v_lshlrev_b32 v218, 16, v205
    v_and_b32 v219, 0xffff0000, v205
    v_lshlrev_b32 v220, 16, v206
    v_and_b32 v221, 0xffff0000, v206
    v_lshlrev_b32 v222, 16, v207
    v_and_b32 v223, 0xffff0000, v207
    v_pk_mul_f32 v[208:209], v[208:209], s[32:33]
    v_pk_mul_f32 v[210:211], v[210:211], s[32:33]
    v_pk_mul_f32 v[212:213], v[212:213], s[32:33]
    v_pk_mul_f32 v[214:215], v[214:215], s[32:33]
    v_pk_mul_f32 v[216:217], v[216:217], s[32:33]
    v_pk_mul_f32 v[218:219], v[218:219], s[32:33]
    v_pk_mul_f32 v[220:221], v[220:221], s[32:33]
    v_pk_mul_f32 v[222:223], v[222:223], s[32:33]
    v_cvt_pk_bf16_f32 v208, v208, v209
    v_cvt_pk_bf16_f32 v210, v210, v211
    v_cvt_pk_bf16_f32 v212, v212, v213
    v_cvt_pk_bf16_f32 v214, v214, v215
    v_cvt_pk_bf16_f32 v216, v216, v217
    v_cvt_pk_bf16_f32 v218, v218, v219
    v_cvt_pk_bf16_f32 v220, v220, v221
    v_cvt_pk_bf16_f32 v222, v222, v223
    v_accvgpr_write_b32 a40, v208
    v_accvgpr_write_b32 a41, v210
    v_accvgpr_write_b32 a42, v212
    v_accvgpr_write_b32 a43, v214
    v_accvgpr_write_b32 a44, v216
    v_accvgpr_write_b32 a45, v218
    v_accvgpr_write_b32 a46, v220
    v_accvgpr_write_b32 a47, v222
    v_mfma_f32_16x16x32_bf16 v[8:11], a[80:83], a[32:35], 0
    v_mfma_f32_16x16x32_bf16 v[8:11], a[84:87], a[36:39], v[8:11]
    v_mfma_f32_16x16x32_bf16 v[8:11], a[88:91], a[40:43], v[8:11]
    v_mfma_f32_16x16x32_bf16 v[8:11], a[92:95], a[44:47], v[8:11]
    s_cmp_lg_u32 s31, 0
    s_nop 5
    s_cbranch_scc1 L_km2_w4
    v_max3_f32 v24, v8, v9, v10
    v_max_f32 v24, v24, v11
    v_mov_b32 v25, v24
    s_nop 1
    v_permlane16_swap_b32 v24, v25
    v_max_f32 v24, v24, v25
    v_mov_b32 v25, v24
    s_nop 1
    v_permlane32_swap_b32 v24, v25
    v_max_f32 v24, v24, v25
    v_sub_f32 v25, 0xc1300000, v24
    v_sub_f32 v26, 0xc1300000, v24
    v_sub_f32 v27, 0xc1300000, v24
    v_sub_f32 v24, 0xc1300000, v24
L_km2_w4:
    s_nop 1
    v_mfma_f32_16x16x32_bf16 v[12:15], a[108:111], a[44:47], v[24:27]
    v_add_f32 v8, v8, v24
    v_add_f32 v9, v9, v24
    v_mfma_f32_16x16x32_bf16 v[12:15], a[104:107], a[40:43], v[12:15]
    v_add_f32 v10, v10, v24
    v_mfma_f32_16x16x32_bf16 v[12:15], a[100:103], a[36:39], v[12:15]
    v_add_f32 v11, v11, v24
    v_mfma_f32_16x16x32_bf16 v[12:15], a[96:99], a[32:35], v[12:15]
    v_exp_f32 v8, v8
    v_mfma_f32_16x16x32_bf16 v[78:81], a[112:115], a[32:35], v[24:27]
    v_exp_f32 v9, v9
    v_exp_f32 v10, v10
    v_mfma_f32_16x16x32_bf16 v[78:81], a[116:119], a[36:39], v[78:81]
    v_exp_f32 v11, v11
    v_mfma_f32_16x16x32_bf16 v[78:81], a[120:123], a[40:43], v[78:81]
    v_cvt_pk_bf16_f32 v54, v8, v9
    v_mfma_f32_16x16x32_bf16 v[78:81], a[124:127], a[44:47], v[78:81]
    v_cvt_pk_bf16_f32 v55, v10, v11
    v_mfma_f32_16x16x32_bf16 v[82:85], a[140:143], a[44:47], v[24:27]
    v_exp_f32 v12, v12
    v_exp_f32 v13, v13
    v_mfma_f32_16x16x32_bf16 v[82:85], a[136:139], a[40:43], v[82:85]
    v_exp_f32 v14, v14
    v_mfma_f32_16x16x32_bf16 v[82:85], a[132:135], a[36:39], v[82:85]
    v_exp_f32 v15, v15
    v_cvt_pk_bf16_f32 v56, v12, v13
    v_mfma_f32_16x16x32_bf16 v[82:85], a[128:131], a[32:35], v[82:85]
    v_cvt_pk_bf16_f32 v57, v14, v15
    v_exp_f32 v78, v78
    v_exp_f32 v79, v79
    v_mfma_f32_16x16x32_bf16 v[160:163], v[54:57], a[144:147], 0
    v_exp_f32 v80, v80
    v_exp_f32 v81, v81
    v_mfma_f32_16x16x32_bf16 v[164:167], v[54:57], a[148:151], 0
    v_cvt_pk_bf16_f32 v58, v78, v79
    v_mfma_f32_16x16x32_bf16 v[168:171], v[54:57], a[152:155], 0
    v_cvt_pk_bf16_f32 v59, v80, v81
    v_mfma_f32_16x16x32_bf16 v[172:175], v[54:57], a[156:159], 0
    v_exp_f32 v82, v82
    v_mfma_f32_16x16x32_bf16 v[176:179], v[54:57], a[160:163], 0
    v_exp_f32 v83, v83
    v_exp_f32 v84, v84
    v_mfma_f32_16x16x32_bf16 v[180:183], v[54:57], a[164:167], 0
    v_exp_f32 v85, v85
    v_mfma_f32_16x16x32_bf16 v[184:187], v[54:57], a[168:171], 0
    v_cvt_pk_bf16_f32 v60, v82, v83
    v_mfma_f32_16x16x32_bf16 v[188:191], v[54:57], a[172:175], 0
    v_cvt_pk_bf16_f32 v61, v84, v85
    s_nop 1
    v_mfma_f32_16x16x32_bf16 v[160:163], v[58:61], a[176:179], v[160:163]
    v_mfma_f32_16x16x32_bf16 v[164:167], v[58:61], a[180:183], v[164:167]
    v_mfma_f32_16x16x32_bf16 v[168:171], v[58:61], a[184:187], v[168:171]
    v_mfma_f32_16x16x32_bf16 v[172:175], v[58:61], a[188:191], v[172:175]
    v_mfma_f32_16x16x32_bf16 v[176:179], v[58:61], a[192:195], v[176:179]
    v_mfma_f32_16x16x32_bf16 v[180:183], v[58:61], a[196:199], v[180:183]
    v_mfma_f32_16x16x32_bf16 v[184:187], v[58:61], a[200:203], v[184:187]
    v_mfma_f32_16x16x32_bf16 v[188:191], v[58:61], a[204:207], v[188:191]
    v_smfmac_f32_16x16x64_bf16 a[72:75], a[208:211], v[54:61], v41
    s_waitcnt vmcnt(8)
    s_waitcnt vmcnt(4)
    ds_read_b128 v[192:195], v42 offset:12288
    ds_read_b128 v[196:199], v43 offset:12288
    ds_read_b128 v[200:203], v44 offset:12288
    ds_read_b128 v[204:207], v45 offset:12288
    v_subrev_u32 v42, s38, v42
    v_subrev_u32 v43, s38, v43
    v_subrev_u32 v44, s38, v44
    v_subrev_u32 v45, s38, v45
    s_waitcnt lgkmcnt(2)
    v_lshlrev_b32 v208, 16, v192
    v_and_b32 v209, 0xffff0000, v192
    v_lshlrev_b32 v210, 16, v193
    v_and_b32 v211, 0xffff0000, v193
    v_lshlrev_b32 v212, 16, v194
    v_and_b32 v213, 0xffff0000, v194
    v_lshlrev_b32 v214, 16, v195
    v_and_b32 v215, 0xffff0000, v195
    v_lshlrev_b32 v216, 16, v196
    v_and_b32 v217, 0xffff0000, v196
    v_lshlrev_b32 v218, 16, v197
    v_and_b32 v219, 0xffff0000, v197
    v_lshlrev_b32 v220, 16, v198
    v_and_b32 v221, 0xffff0000, v198
    v_lshlrev_b32 v222, 16, v199
    v_and_b32 v223, 0xffff0000, v199
    v_pk_mul_f32 v[208:209], v[208:209], s[32:33]
    v_pk_mul_f32 v[210:211], v[210:211], s[32:33]
    v_pk_mul_f32 v[212:213], v[212:213], s[32:33]
    v_pk_mul_f32 v[214:215], v[214:215], s[32:33]
    v_pk_mul_f32 v[216:217], v[216:217], s[32:33]
    v_pk_mul_f32 v[218:219], v[218:219], s[32:33]
    v_pk_mul_f32 v[220:221], v[220:221], s[32:33]
    v_pk_mul_f32 v[222:223], v[222:223], s[32:33]
    v_cvt_pk_bf16_f32 v208, v208, v209
    v_cvt_pk_bf16_f32 v210, v210, v211
    v_cvt_pk_bf16_f32 v212, v212, v213
    v_cvt_pk_bf16_f32 v214, v214, v215
    v_cvt_pk_bf16_f32 v216, v216, v217
    v_cvt_pk_bf16_f32 v218, v218, v219
    v_cvt_pk_bf16_f32 v220, v220, v221
    v_cvt_pk_bf16_f32 v222, v222, v223
    v_accvgpr_write_b32 a48, v208
    v_accvgpr_write_b32 a49, v210
    v_accvgpr_write_b32 a50, v212
    v_accvgpr_write_b32 a51, v214
    v_accvgpr_write_b32 a52, v216
    v_accvgpr_write_b32 a53, v218
    v_accvgpr_write_b32 a54, v220
    v_accvgpr_write_b32 a55, v222
    s_waitcnt lgkmcnt(0)
    v_lshlrev_b32 v208, 16, v200
    v_and_b32 v209, 0xffff0000, v200
    v_lshlrev_b32 v210, 16, v201
    v_and_b32 v211, 0xffff0000, v201
    v_lshlrev_b32 v212, 16, v202
    v_and_b32 v213, 0xffff0000, v202
    v_lshlrev_b32 v214, 16, v203
    v_and_b32 v215, 0xffff0000, v203
    v_lshlrev_b32 v216, 16, v204
    v_and_b32 v217, 0xffff0000, v204
    v_lshlrev_b32 v218, 16, v205
    v_and_b32 v219, 0xffff0000, v205
    v_lshlrev_b32 v220, 16, v206
    v_and_b32 v221, 0xffff0000, v206
    v_lshlrev_b32 v222, 16, v207
    v_and_b32 v223, 0xffff0000, v207
    v_pk_mul_f32 v[208:209], v[208:209], s[32:33]
    v_pk_mul_f32 v[210:211], v[210:211], s[32:33]
    v_pk_mul_f32 v[212:213], v[212:213], s[32:33]
    v_pk_mul_f32 v[214:215], v[214:215], s[32:33]
    v_pk_mul_f32 v[216:217], v[216:217], s[32:33]
    v_pk_mul_f32 v[218:219], v[218:219], s[32:33]
    v_pk_mul_f32 v[220:221], v[220:221], s[32:33]
    v_pk_mul_f32 v[222:223], v[222:223], s[32:33]
    v_cvt_pk_bf16_f32 v208, v208, v209
    v_cvt_pk_bf16_f32 v210, v210, v211
    v_cvt_pk_bf16_f32 v212, v212, v213
    v_cvt_pk_bf16_f32 v214, v214, v215
    v_cvt_pk_bf16_f32 v216, v216, v217
    v_cvt_pk_bf16_f32 v218, v218, v219
    v_cvt_pk_bf16_f32 v220, v220, v221
    v_cvt_pk_bf16_f32 v222, v222, v223
    v_accvgpr_write_b32 a56, v208
    v_accvgpr_write_b32 a57, v210
    v_accvgpr_write_b32 a58, v212
    v_accvgpr_write_b32 a59, v214
    v_accvgpr_write_b32 a60, v216
    v_accvgpr_write_b32 a61, v218
    v_accvgpr_write_b32 a62, v220
    v_accvgpr_write_b32 a63, v222
    v_mov_b32 v192, 0x0
    v_mov_b32 v193, 0x0
    v_mov_b32 v194, 0x0
    v_mov_b32 v195, 0x0
    v_mov_b32 v196, 0x0
    v_mov_b32 v197, 0x0
    v_mov_b32 v198, 0x0
    v_mov_b32 v199, 0x0
    v_mov_b32 v200, 0x0
    v_mov_b32 v201, 0x0
    v_mov_b32 v202, 0x0
    v_mov_b32 v203, 0x0
    v_mov_b32 v204, 0x0
    v_mov_b32 v205, 0x0
    v_mov_b32 v206, 0x0
    v_mov_b32 v207, 0x0
    v_mov_b32 v208, 0x0
    v_mov_b32 v209, 0x0
    v_mov_b32 v210, 0x0
    v_mov_b32 v211, 0x0
    v_mov_b32 v212, 0x0
    v_mov_b32 v213, 0x0
    v_mov_b32 v214, 0x0
    v_mov_b32 v215, 0x0
    v_mov_b32 v216, 0x0
    v_mov_b32 v217, 0x0
    v_mov_b32 v218, 0x0
    v_mov_b32 v219, 0x0
    v_mov_b32 v220, 0x0
    v_mov_b32 v221, 0x0
    v_mov_b32 v222, 0x0
    v_mov_b32 v223, 0x0
    v_mfma_f32_16x16x32_bf16 v[8:11], a[80:83], a[48:51], 0
    v_mfma_f32_16x16x32_bf16 v[8:11], a[84:87], a[52:55], v[8:11]
    v_mfma_f32_16x16x32_bf16 v[8:11], a[88:91], a[56:59], v[8:11]
    v_mfma_f32_16x16x32_bf16 v[8:11], a[92:95], a[60:63], v[8:11]
    s_cmp_lg_u32 s31, 0
    s_nop 5
    s_cbranch_scc1 L_km3_w4
    v_max3_f32 v28, v8, v9, v10
    v_max_f32 v28, v28, v11
    v_mov_b32 v29, v28
    s_nop 1
    v_permlane16_swap_b32 v28, v29
    v_max_f32 v28, v28, v29
    v_mov_b32 v29, v28
    s_nop 1
    v_permlane32_swap_b32 v28, v29
    v_max_f32 v28, v28, v29
    v_sub_f32 v29, 0xc1300000, v28
    v_sub_f32 v30, 0xc1300000, v28
    v_sub_f32 v31, 0xc1300000, v28
    v_sub_f32 v28, 0xc1300000, v28
L_km3_w4:
    s_nop 1
    v_mfma_f32_16x16x32_bf16 v[12:15], a[108:111], a[60:63], v[28:31]
    v_add_f32 v8, v8, v28
    v_add_f32 v9, v9, v28
    v_mfma_f32_16x16x32_bf16 v[12:15], a[104:107], a[56:59], v[12:15]
    v_add_f32 v10, v10, v28
    v_mfma_f32_16x16x32_bf16 v[12:15], a[100:103], a[52:55], v[12:15]
    v_add_f32 v11, v11, v28
    v_mfma_f32_16x16x32_bf16 v[12:15], a[96:99], a[48:51], v[12:15]
    v_exp_f32 v8, v8
    v_mfma_f32_16x16x32_bf16 v[78:81], a[112:115], a[48:51], v[28:31]
    v_exp_f32 v9, v9
    v_exp_f32 v10, v10
    v_mfma_f32_16x16x32_bf16 v[78:81], a[116:119], a[52:55], v[78:81]
    v_exp_f32 v11, v11
    v_mfma_f32_16x16x32_bf16 v[78:81], a[120:123], a[56:59], v[78:81]
    v_cvt_pk_bf16_f32 v62, v8, v9
    v_mfma_f32_16x16x32_bf16 v[78:81], a[124:127], a[60:63], v[78:81]
    v_cvt_pk_bf16_f32 v63, v10, v11
    v_mfma_f32_16x16x32_bf16 v[82:85], a[140:143], a[60:63], v[28:31]
    v_exp_f32 v12, v12
    v_exp_f32 v13, v13
    v_mfma_f32_16x16x32_bf16 v[82:85], a[136:139], a[56:59], v[82:85]
    v_exp_f32 v14, v14
    v_mfma_f32_16x16x32_bf16 v[82:85], a[132:135], a[52:55], v[82:85]
    v_exp_f32 v15, v15
    v_cvt_pk_bf16_f32 v64, v12, v13
    v_mfma_f32_16x16x32_bf16 v[82:85], a[128:131], a[48:51], v[82:85]
    v_cvt_pk_bf16_f32 v65, v14, v15
    v_exp_f32 v78, v78
    v_exp_f32 v79, v79
    v_exp_f32 v80, v80
    v_exp_f32 v81, v81
    v_cvt_pk_bf16_f32 v66, v78, v79
    v_cvt_pk_bf16_f32 v67, v80, v81
    s_mov_b32 s30, 32768
    s_mov_b32 s47, 0
    s_mov_b32 s88, 4
    s_mov_b32 s89, 132
    s_mov_b32 s90, 4
    s_mov_b32 s91, 194
    s_and_b32 m0, s30, 0xffff
    s_nop 0
    buffer_load_dwordx4 v90, s[16:19], s30 offen offset:0 nt lds
    buffer_load_dwordx4 v91, s[16:19], s30 offen offset:1024 nt lds
    buffer_load_dwordx4 v92, s[16:19], s30 offen offset:2048 nt lds
    buffer_load_dwordx4 v93, s[16:19], s30 offen offset:3072 nt lds
    s_bitset1_b32 m0, 16
    s_nop 0
    buffer_load_dwordx4 v94, s[20:23], s30 offen offset:0 nt lds
    buffer_load_dwordx4 v95, s[20:23], s30 offen offset:1024 nt lds
    buffer_load_dwordx4 v94, s[20:23], s30 offen offset:2048 nt lds
    buffer_load_dwordx4 v95, s[20:23], s30 offen offset:3072 nt lds
    s_add_u32 s30, s30, 4096
    s_and_b32 m0, s30, 0xffff
    s_nop 0
    buffer_load_dwordx4 v90, s[16:19], s30 offen offset:0 nt lds
    buffer_load_dwordx4 v91, s[16:19], s30 offen offset:1024 nt lds
    buffer_load_dwordx4 v92, s[16:19], s30 offen offset:2048 nt lds
    buffer_load_dwordx4 v93, s[16:19], s30 offen offset:3072 nt lds
    s_bitset1_b32 m0, 16
    s_nop 0
    buffer_load_dwordx4 v94, s[20:23], s30 offen offset:0 nt lds
    buffer_load_dwordx4 v95, s[20:23], s30 offen offset:1024 nt lds
    buffer_load_dwordx4 v94, s[20:23], s30 offen offset:2048 nt lds
    s_waitcnt vmcnt(15)
    s_barrier
    ds_read_b128 a[80:83], v42 offset:16384
    ds_read_b128 a[84:87], v43 offset:16384
    ds_read_b128 a[88:91], v44 offset:16384
    ds_read_b128 a[92:95], v45 offset:16384
    ds_read_b128 a[108:111], v45 offset:20480
    ds_read_b128 a[104:107], v44 offset:20480
    ds_read_b128 a[100:103], v43 offset:20480
    ds_read_b128 a[96:99], v42 offset:20480
    ds_read_b128 a[112:115], v42 offset:24576
    ds_read_b128 a[116:119], v43 offset:24576
    ds_read_b128 a[120:123], v44 offset:24576
    ds_read_b128 a[124:127], v45 offset:24576
    ds_read_b128 a[140:143], v45 offset:28672
    ds_read_b128 a[136:139], v44 offset:28672
    ds_read_b128 a[132:135], v43 offset:28672
    ds_read_b128 a[128:131], v42 offset:28672
    ds_read_b64_tr_b16 a[212:213], v46 offset:16384
    ds_read_b64_tr_b16 a[214:215], v46 offset:20480
    ds_read_b64_tr_b16 a[216:217], v46 offset:24576
    ds_read_b64_tr_b16 a[218:219], v46 offset:28672
    s_waitcnt lgkmcnt(0)
    s_branch L_entry_w4
.p2align 6
L_loop_w5:
    v_mfma_f32_16x16x32_bf16 v[8:11], a[80:83], a[0:3], v[16:19]
    v_exp_f32 v82, v82
    v_mfma_f32_16x16x32_bf16 v[8:11], a[84:87], a[4:7], v[8:11]
    ds_read_b64_tr_b16 a[162:163], v50 offset:4096
    ds_read_b64_tr_b16 a[192:193], v50 offset:8192
    v_mfma_f32_16x16x32_bf16 v[8:11], a[88:91], a[8:11], v[8:11]
    v_exp_f32 v83, v83
    v_mfma_f32_16x16x32_bf16 v[8:11], a[92:95], a[12:15], v[8:11]
    ds_read_b64_tr_b16 a[194:195], v50 offset:12288
    v_cvt_pk_bf16_f32 v68, v82, v83
    v_mfma_f32_16x16x32_bf16 v[12:15], a[108:111], a[12:15], v[16:19]
    v_exp_f32 v84, v84
    v_mfma_f32_16x16x32_bf16 v[12:15], a[104:107], a[8:11], v[12:15]
    ds_read_b64_tr_b16 a[164:165], v51 offset:0
    ds_read_b64_tr_b16 a[166:167], v51 offset:4096
    v_mfma_f32_16x16x32_bf16 v[12:15], a[100:103], a[4:7], v[12:15]
    v_exp_f32 v85, v85
    v_mfma_f32_16x16x32_bf16 v[12:15], a[96:99], a[0:3], v[12:15]
    ds_read_b64_tr_b16 a[196:197], v51 offset:8192
    v_cvt_pk_bf16_f32 v69, v84, v85
    v_mfma_f32_16x16x32_bf16 v[78:81], a[112:115], a[0:3], v[16:19]
    v_exp_f32 v8, v8
    v_mfma_f32_16x16x32_bf16 v[78:81], a[116:119], a[4:7], v[78:81]
    ds_read_b64_tr_b16 a[198:199], v51 offset:12288
    v_mfma_f32_16x16x32_bf16 v[78:81], a[120:123], a[8:11], v[78:81]
    s_waitcnt lgkmcnt(7)
    v_exp_f32 v9, v9
    v_mfma_f32_16x16x32_bf16 v[78:81], a[124:127], a[12:15], v[78:81]
    v_cvt_pk_bf16_f32 v54, v8, v9
    v_mfma_f32_16x16x32_bf16 v[82:85], a[140:143], a[12:15], v[16:19]
    v_exp_f32 v10, v10
    v_mfma_f32_16x16x32_bf16 v[82:85], a[136:139], a[8:11], v[82:85]
    v_mfma_f32_16x16x32_bf16 v[82:85], a[132:135], a[4:7], v[82:85]
    v_exp_f32 v11, v11
    v_mfma_f32_16x16x32_bf16 v[82:85], a[128:131], a[0:3], v[82:85]
    v_cvt_pk_bf16_f32 v55, v10, v11
    v_smfmac_f32_16x16x64_bf16 a[252:255], a[208:211], v[62:69], v41
    v_mfma_f32_16x16x32_bf16 v[224:227], v[62:65], a[212:215], v[224:227]
    v_exp_f32 v12, v12
    v_mfma_f32_16x16x32_bf16 v[224:227], v[66:69], a[216:219], v[224:227]
    v_mfma_f32_16x16x32_bf16 v[228:231], v[62:65], a[220:223], v[228:231]
    v_exp_f32 v13, v13
    v_mfma_f32_16x16x32_bf16 v[228:231], v[66:69], a[224:227], v[228:231]
    v_cvt_pk_bf16_f32 v56, v12, v13
    v_mfma_f32_16x16x32_bf16 v[232:235], v[62:65], a[152:155], v[232:235]
    v_exp_f32 v14, v14
    v_mfma_f32_16x16x32_bf16 v[232:235], v[66:69], a[184:187], v[232:235]
    ds_read_b64_tr_b16 a[152:153], v48 offset:0
    ds_read_b64_tr_b16 a[154:155], v48 offset:4096
    v_mfma_f32_16x16x32_bf16 v[236:239], v[62:65], a[156:159], v[236:239]
    v_exp_f32 v15, v15
    v_mfma_f32_16x16x32_bf16 v[236:239], v[66:69], a[188:191], v[236:239]
    ds_read_b64_tr_b16 a[184:185], v48 offset:8192
    v_cvt_pk_bf16_f32 v57, v14, v15
    v_mfma_f32_16x16x32_bf16 v[240:243], v[62:65], a[228:231], v[240:243]
    v_exp_f32 v78, v78
    v_mfma_f32_16x16x32_bf16 v[240:243], v[66:69], a[232:235], v[240:243]
    ds_read_b64_tr_b16 a[186:187], v48 offset:12288
    ds_read_b64_tr_b16 a[156:157], v49 offset:0
    v_mfma_f32_16x16x32_bf16 v[244:247], v[62:65], a[236:239], v[244:247]
    v_exp_f32 v79, v79
    v_mfma_f32_16x16x32_bf16 v[244:247], v[66:69], a[240:243], v[244:247]
    ds_read_b64_tr_b16 a[158:159], v49 offset:4096
    v_cvt_pk_bf16_f32 v58, v78, v79
    v_mfma_f32_16x16x32_bf16 v[248:251], v[62:65], a[168:171], v[248:251]
    v_exp_f32 v80, v80
    v_mfma_f32_16x16x32_bf16 v[248:251], v[66:69], a[200:203], v[248:251]
    ds_read_b64_tr_b16 a[188:189], v49 offset:8192
    ds_read_b64_tr_b16 a[190:191], v49 offset:12288
    v_mfma_f32_16x16x32_bf16 v[252:255], v[62:65], a[172:175], v[252:255]
    v_exp_f32 v81, v81
    v_mfma_f32_16x16x32_bf16 v[252:255], v[66:69], a[204:207], v[252:255]
    ds_read_b64_tr_b16 a[168:169], v52 offset:0
    v_cvt_pk_bf16_f32 v59, v80, v81
    v_mfma_f32_16x16x32_bf16 v[8:11], a[80:83], a[16:19], v[20:23]
    v_exp_f32 v82, v82
    v_mfma_f32_16x16x32_bf16 v[8:11], a[84:87], a[20:23], v[8:11]
    ds_read_b64_tr_b16 a[170:171], v52 offset:4096
    ds_read_b64_tr_b16 a[200:201], v52 offset:8192
    v_mfma_f32_16x16x32_bf16 v[8:11], a[88:91], a[24:27], v[8:11]
    v_exp_f32 v83, v83
    v_mfma_f32_16x16x32_bf16 v[8:11], a[92:95], a[28:31], v[8:11]
    ds_read_b64_tr_b16 a[202:203], v52 offset:12288
    v_cvt_pk_bf16_f32 v60, v82, v83
    v_mfma_f32_16x16x32_bf16 v[12:15], a[108:111], a[28:31], v[20:23]
    v_exp_f32 v84, v84
    v_mfma_f32_16x16x32_bf16 v[12:15], a[104:107], a[24:27], v[12:15]
    ds_read_b64_tr_b16 a[172:173], v53 offset:0
    ds_read_b64_tr_b16 a[174:175], v53 offset:4096
    v_mfma_f32_16x16x32_bf16 v[12:15], a[100:103], a[20:23], v[12:15]
    v_exp_f32 v85, v85
    v_mfma_f32_16x16x32_bf16 v[12:15], a[96:99], a[16:19], v[12:15]
    ds_read_b64_tr_b16 a[204:205], v53 offset:8192
    v_cvt_pk_bf16_f32 v61, v84, v85
    v_mfma_f32_16x16x32_bf16 v[78:81], a[112:115], a[16:19], v[20:23]
    v_exp_f32 v8, v8
    v_mfma_f32_16x16x32_bf16 v[78:81], a[116:119], a[20:23], v[78:81]
    ds_read_b64_tr_b16 a[206:207], v53 offset:12288
    v_add_f32 v37, v37, v8
    v_mfma_f32_16x16x32_bf16 v[78:81], a[120:123], a[24:27], v[78:81]
    v_exp_f32 v9, v9
    v_mfma_f32_16x16x32_bf16 v[78:81], a[124:127], a[28:31], v[78:81]
    v_cvt_pk_bf16_f32 v62, v8, v9
    v_add_f32 v37, v37, v9
    v_mfma_f32_16x16x32_bf16 v[82:85], a[140:143], a[28:31], v[20:23]
    v_exp_f32 v10, v10
    v_mfma_f32_16x16x32_bf16 v[82:85], a[136:139], a[24:27], v[82:85]
    v_add_f32 v37, v37, v10
    v_mfma_f32_16x16x32_bf16 v[82:85], a[132:135], a[20:23], v[82:85]
    v_exp_f32 v11, v11
    v_mfma_f32_16x16x32_bf16 v[82:85], a[128:131], a[16:19], v[82:85]
    v_cvt_pk_bf16_f32 v63, v10, v11
    v_add_f32 v37, v37, v11
    v_smfmac_f32_16x16x64_bf16 a[248:251], a[208:211], v[54:61], v41
    v_mfma_f32_16x16x32_bf16 v[96:99], v[54:57], a[144:147], v[96:99]
    v_exp_f32 v12, v12
    v_mfma_f32_16x16x32_bf16 v[96:99], v[58:61], a[176:179], v[96:99]
    v_add_f32 v37, v37, v12
    v_mfma_f32_16x16x32_bf16 v[100:103], v[54:57], a[148:151], v[100:103]
    v_exp_f32 v13, v13
    v_mfma_f32_16x16x32_bf16 v[100:103], v[58:61], a[180:183], v[100:103]
    s_waitcnt lgkmcnt(0)
    v_cvt_pk_bf16_f32 v64, v12, v13
    v_add_f32 v37, v37, v13
    v_mfma_f32_16x16x32_bf16 v[104:107], v[54:57], a[152:155], v[104:107]
    v_exp_f32 v14, v14
    v_mfma_f32_16x16x32_bf16 v[104:107], v[58:61], a[184:187], v[104:107]
    v_add_f32 v37, v37, v14
    v_mfma_f32_16x16x32_bf16 v[108:111], v[54:57], a[156:159], v[108:111]
    v_exp_f32 v15, v15
    v_mfma_f32_16x16x32_bf16 v[108:111], v[58:61], a[188:191], v[108:111]
    v_cvt_pk_bf16_f32 v65, v14, v15
    v_add_f32 v37, v37, v15
    v_mfma_f32_16x16x32_bf16 v[112:115], v[54:57], a[160:163], v[112:115]
    v_exp_f32 v78, v78
    v_mfma_f32_16x16x32_bf16 v[112:115], v[58:61], a[192:195], v[112:115]
    v_add_f32 v37, v37, v78
    v_mfma_f32_16x16x32_bf16 v[116:119], v[54:57], a[164:167], v[116:119]
    v_exp_f32 v79, v79
    v_mfma_f32_16x16x32_bf16 v[116:119], v[58:61], a[196:199], v[116:119]
    v_cvt_pk_bf16_f32 v66, v78, v79
    v_add_f32 v37, v37, v79
    v_mfma_f32_16x16x32_bf16 v[120:123], v[54:57], a[168:171], v[120:123]
    v_exp_f32 v80, v80
    v_mfma_f32_16x16x32_bf16 v[120:123], v[58:61], a[200:203], v[120:123]
    v_add_f32 v37, v37, v80
    v_mfma_f32_16x16x32_bf16 v[124:127], v[54:57], a[172:175], v[124:127]
    v_exp_f32 v81, v81
    v_mfma_f32_16x16x32_bf16 v[124:127], v[58:61], a[204:207], v[124:127]
    v_cvt_pk_bf16_f32 v67, v80, v81
    v_add_f32 v37, v37, v81
    v_mfma_f32_16x16x32_bf16 v[8:11], a[80:83], a[32:35], v[24:27]
    v_exp_f32 v82, v82
    v_mfma_f32_16x16x32_bf16 v[8:11], a[84:87], a[36:39], v[8:11]
    v_add_f32 v37, v37, v82
    v_mfma_f32_16x16x32_bf16 v[8:11], a[88:91], a[40:43], v[8:11]
    v_exp_f32 v83, v83
    v_mfma_f32_16x16x32_bf16 v[8:11], a[92:95], a[44:47], v[8:11]
    v_cvt_pk_bf16_f32 v68, v82, v83
    v_add_f32 v37, v37, v83
    v_mfma_f32_16x16x32_bf16 v[12:15], a[108:111], a[44:47], v[24:27]
    v_exp_f32 v84, v84
    v_mfma_f32_16x16x32_bf16 v[12:15], a[104:107], a[40:43], v[12:15]
    v_add_f32 v37, v37, v84
    v_mfma_f32_16x16x32_bf16 v[12:15], a[100:103], a[36:39], v[12:15]
    v_exp_f32 v85, v85
    v_mfma_f32_16x16x32_bf16 v[12:15], a[96:99], a[32:35], v[12:15]
    v_cvt_pk_bf16_f32 v69, v84, v85
    v_add_f32 v37, v37, v85
    v_mfma_f32_16x16x32_bf16 v[78:81], a[112:115], a[32:35], v[24:27]
    v_exp_f32 v8, v8
    v_mfma_f32_16x16x32_bf16 v[78:81], a[116:119], a[36:39], v[78:81]
    v_add_f32 v38, v38, v8
    v_mfma_f32_16x16x32_bf16 v[78:81], a[120:123], a[40:43], v[78:81]
    v_exp_f32 v9, v9
    v_mfma_f32_16x16x32_bf16 v[78:81], a[124:127], a[44:47], v[78:81]
    v_cvt_pk_bf16_f32 v54, v8, v9
    v_add_f32 v38, v38, v9
    v_mfma_f32_16x16x32_bf16 v[82:85], a[140:143], a[44:47], v[24:27]
    v_exp_f32 v10, v10
    v_mfma_f32_16x16x32_bf16 v[82:85], a[136:139], a[40:43], v[82:85]
    v_add_f32 v38, v38, v10
    v_mfma_f32_16x16x32_bf16 v[82:85], a[132:135], a[36:39], v[82:85]
    v_exp_f32 v11, v11
    v_mfma_f32_16x16x32_bf16 v[82:85], a[128:131], a[32:35], v[82:85]
    v_cvt_pk_bf16_f32 v55, v10, v11
    v_add_f32 v38, v38, v11
    v_mfma_f32_16x16x32_bf16 v[128:131], v[62:65], a[144:147], v[128:131]
    v_exp_f32 v12, v12
    v_mfma_f32_16x16x32_bf16 v[128:131], v[66:69], a[176:179], v[128:131]
    v_add_f32 v38, v38, v12
    v_mfma_f32_16x16x32_bf16 v[132:135], v[62:65], a[148:151], v[132:135]
    v_exp_f32 v13, v13
    v_mfma_f32_16x16x32_bf16 v[132:135], v[66:69], a[180:183], v[132:135]
    v_cvt_pk_bf16_f32 v56, v12, v13
    v_add_f32 v38, v38, v13
    v_mfma_f32_16x16x32_bf16 v[136:139], v[62:65], a[152:155], v[136:139]
    v_exp_f32 v14, v14
    v_mfma_f32_16x16x32_bf16 v[136:139], v[66:69], a[184:187], v[136:139]
    v_add_f32 v38, v38, v14
    v_mfma_f32_16x16x32_bf16 v[140:143], v[62:65], a[156:159], v[140:143]
    v_exp_f32 v15, v15
    v_mfma_f32_16x16x32_bf16 v[140:143], v[66:69], a[188:191], v[140:143]
    v_cvt_pk_bf16_f32 v57, v14, v15
    v_add_f32 v38, v38, v15
    v_mfma_f32_16x16x32_bf16 v[144:147], v[62:65], a[160:163], v[144:147]
    v_exp_f32 v78, v78
    v_mfma_f32_16x16x32_bf16 v[144:147], v[66:69], a[192:195], v[144:147]
    v_add_f32 v38, v38, v78
    v_mfma_f32_16x16x32_bf16 v[148:151], v[62:65], a[164:167], v[148:151]
    v_exp_f32 v79, v79
    v_mfma_f32_16x16x32_bf16 v[148:151], v[66:69], a[196:199], v[148:151]
    v_cvt_pk_bf16_f32 v58, v78, v79
    v_add_f32 v38, v38, v79
    v_mfma_f32_16x16x32_bf16 v[152:155], v[62:65], a[168:171], v[152:155]
    v_exp_f32 v80, v80
    v_mfma_f32_16x16x32_bf16 v[152:155], v[66:69], a[200:203], v[152:155]
    v_add_f32 v38, v38, v80
    v_mfma_f32_16x16x32_bf16 v[156:159], v[62:65], a[172:175], v[156:159]
    v_exp_f32 v81, v81
    v_mfma_f32_16x16x32_bf16 v[156:159], v[66:69], a[204:207], v[156:159]
    v_cvt_pk_bf16_f32 v59, v80, v81
    v_add_f32 v38, v38, v81
    v_mfma_f32_16x16x32_bf16 v[8:11], a[80:83], a[48:51], v[28:31]
    v_exp_f32 v82, v82
    v_mfma_f32_16x16x32_bf16 v[8:11], a[84:87], a[52:55], v[8:11]
    v_add_f32 v38, v38, v82
    v_mfma_f32_16x16x32_bf16 v[8:11], a[88:91], a[56:59], v[8:11]
    v_exp_f32 v83, v83
    v_mfma_f32_16x16x32_bf16 v[8:11], a[92:95], a[60:63], v[8:11]
    v_cvt_pk_bf16_f32 v60, v82, v83
    v_add_f32 v38, v38, v83
    v_mfma_f32_16x16x32_bf16 v[12:15], a[108:111], a[60:63], v[28:31]
    v_exp_f32 v84, v84
    v_mfma_f32_16x16x32_bf16 v[12:15], a[104:107], a[56:59], v[12:15]
    v_add_f32 v38, v38, v84
    v_mfma_f32_16x16x32_bf16 v[12:15], a[100:103], a[52:55], v[12:15]
    v_exp_f32 v85, v85
    v_mfma_f32_16x16x32_bf16 v[12:15], a[96:99], a[48:51], v[12:15]
    v_cvt_pk_bf16_f32 v61, v84, v85
    v_add_f32 v38, v38, v85
    v_mfma_f32_16x16x32_bf16 v[78:81], a[112:115], a[48:51], v[28:31]
    v_exp_f32 v8, v8
    v_mfma_f32_16x16x32_bf16 v[78:81], a[116:119], a[52:55], v[78:81]
    s_barrier
    v_add_f32 v39, v39, v8
    v_mfma_f32_16x16x32_bf16 v[78:81], a[120:123], a[56:59], v[78:81]
    v_exp_f32 v9, v9
    v_mfma_f32_16x16x32_bf16 v[78:81], a[124:127], a[60:63], v[78:81]
    v_cvt_pk_bf16_f32 v62, v8, v9
    v_add_f32 v39, v39, v9
    v_mfma_f32_16x16x32_bf16 v[82:85], a[140:143], a[60:63], v[28:31]
    v_exp_f32 v10, v10
    v_mfma_f32_16x16x32_bf16 v[82:85], a[136:139], a[56:59], v[82:85]
    ds_read_b64_tr_b16 a[212:213], v46 offset:16384
    v_add_f32 v39, v39, v10
    v_mfma_f32_16x16x32_bf16 v[82:85], a[132:135], a[52:55], v[82:85]
    v_exp_f32 v11, v11
    v_mfma_f32_16x16x32_bf16 v[82:85], a[128:131], a[48:51], v[82:85]
    v_cvt_pk_bf16_f32 v63, v10, v11
    v_add_f32 v39, v39, v11
    v_mfma_f32_16x16x32_bf16 v[160:163], v[54:57], a[144:147], v[160:163]
    v_exp_f32 v12, v12
    v_mfma_f32_16x16x32_bf16 v[160:163], v[58:61], a[176:179], v[160:163]
    ds_read_b64_tr_b16 a[214:215], v46 offset:20480
    v_add_f32 v39, v39, v12
    v_mfma_f32_16x16x32_bf16 v[164:167], v[54:57], a[148:151], v[164:167]
    v_exp_f32 v13, v13
    v_mfma_f32_16x16x32_bf16 v[164:167], v[58:61], a[180:183], v[164:167]
    v_cvt_pk_bf16_f32 v64, v12, v13
    v_add_f32 v39, v39, v13
    v_mfma_f32_16x16x32_bf16 v[168:171], v[54:57], a[152:155], v[168:171]
    v_exp_f32 v14, v14
    v_mfma_f32_16x16x32_bf16 v[168:171], v[58:61], a[184:187], v[168:171]
    ds_read_b64_tr_b16 a[216:217], v46 offset:24576
    v_add_f32 v39, v39, v14
    v_mfma_f32_16x16x32_bf16 v[172:175], v[54:57], a[156:159], v[172:175]
    v_exp_f32 v15, v15
    v_mfma_f32_16x16x32_bf16 v[172:175], v[58:61], a[188:191], v[172:175]
    v_cvt_pk_bf16_f32 v65, v14, v15
    v_add_f32 v39, v39, v15
    v_mfma_f32_16x16x32_bf16 v[176:179], v[54:57], a[160:163], v[176:179]
    v_exp_f32 v78, v78
    v_mfma_f32_16x16x32_bf16 v[176:179], v[58:61], a[192:195], v[176:179]
    ds_read_b64_tr_b16 a[218:219], v46 offset:28672
    v_add_f32 v39, v39, v78
    v_mfma_f32_16x16x32_bf16 v[180:183], v[54:57], a[164:167], v[180:183]
    v_exp_f32 v79, v79
    v_mfma_f32_16x16x32_bf16 v[180:183], v[58:61], a[196:199], v[180:183]
    v_cvt_pk_bf16_f32 v66, v78, v79
    v_add_f32 v39, v39, v79
    v_mfma_f32_16x16x32_bf16 v[184:187], v[54:57], a[168:171], v[184:187]
    v_exp_f32 v80, v80
    v_mfma_f32_16x16x32_bf16 v[184:187], v[58:61], a[200:203], v[184:187]
    ds_read_b64_tr_b16 a[220:221], v47 offset:16384
    v_add_f32 v39, v39, v80
    v_mfma_f32_16x16x32_bf16 v[188:191], v[54:57], a[172:175], v[188:191]
    v_exp_f32 v81, v81
    v_mfma_f32_16x16x32_bf16 v[188:191], v[58:61], a[204:207], v[188:191]
    v_cvt_pk_bf16_f32 v67, v80, v81
    v_add_f32 v39, v39, v81
    v_mfma_f32_16x16x32_bf16 v[8:11], a[80:83], a[64:67], v[32:35]
    v_exp_f32 v82, v82
    v_mfma_f32_16x16x32_bf16 v[8:11], a[84:87], a[68:71], v[8:11]
    ds_read_b128 a[80:83], v42 offset:16384
    v_add_f32 v39, v39, v82
    v_mfma_f32_16x16x32_bf16 v[8:11], a[88:91], a[72:75], v[8:11]
    v_exp_f32 v83, v83
    v_mfma_f32_16x16x32_bf16 v[8:11], a[92:95], a[76:79], v[8:11]
    v_cvt_pk_bf16_f32 v68, v82, v83
    v_add_f32 v39, v39, v83
    v_mfma_f32_16x16x32_bf16 v[12:15], a[108:111], a[76:79], v[32:35]
    v_exp_f32 v84, v84
    v_mfma_f32_16x16x32_bf16 v[12:15], a[104:107], a[72:75], v[12:15]
    ds_read_b128 a[84:87], v43 offset:16384
    v_add_f32 v39, v39, v84
    v_mfma_f32_16x16x32_bf16 v[12:15], a[100:103], a[68:71], v[12:15]
    v_exp_f32 v85, v85
    v_mfma_f32_16x16x32_bf16 v[12:15], a[96:99], a[64:67], v[12:15]
    v_cvt_pk_bf16_f32 v69, v84, v85
    v_add_f32 v39, v39, v85
    v_mfma_f32_16x16x32_bf16 v[78:81], a[112:115], a[64:67], v[32:35]
    v_exp_f32 v8, v8
    v_mfma_f32_16x16x32_bf16 v[78:81], a[116:119], a[68:71], v[78:81]
    ds_read_b128 a[88:91], v44 offset:16384
    ds_read_b128 a[92:95], v45 offset:16384
    v_mfma_f32_16x16x32_bf16 v[78:81], a[120:123], a[72:75], v[78:81]
    v_exp_f32 v9, v9
    v_mfma_f32_16x16x32_bf16 v[78:81], a[124:127], a[76:79], v[78:81]
    ds_read_b128 a[108:111], v45 offset:20480
    v_cvt_pk_bf16_f32 v54, v8, v9
    v_mfma_f32_16x16x32_bf16 v[82:85], a[140:143], a[76:79], v[32:35]
    v_exp_f32 v10, v10
    v_mfma_f32_16x16x32_bf16 v[82:85], a[136:139], a[72:75], v[82:85]
    ds_read_b128 a[104:107], v44 offset:20480
    ds_read_b128 a[100:103], v43 offset:20480
    v_mfma_f32_16x16x32_bf16 v[82:85], a[132:135], a[68:71], v[82:85]
    v_exp_f32 v11, v11
    v_mfma_f32_16x16x32_bf16 v[82:85], a[128:131], a[64:67], v[82:85]
    ds_read_b128 a[96:99], v42 offset:20480
    v_cvt_pk_bf16_f32 v55, v10, v11
    v_mfma_f32_16x16x32_bf16 v[192:195], v[62:65], a[144:147], v[192:195]
    v_exp_f32 v12, v12
    v_mfma_f32_16x16x32_bf16 v[192:195], v[66:69], a[176:179], v[192:195]
    ds_read_b128 a[112:115], v42 offset:24576
    ds_read_b128 a[116:119], v43 offset:24576
    v_mfma_f32_16x16x32_bf16 v[196:199], v[62:65], a[148:151], v[196:199]
    v_exp_f32 v13, v13
    v_mfma_f32_16x16x32_bf16 v[196:199], v[66:69], a[180:183], v[196:199]
    ds_read_b128 a[120:123], v44 offset:24576
    v_cvt_pk_bf16_f32 v56, v12, v13
    v_mfma_f32_16x16x32_bf16 v[200:203], v[62:65], a[152:155], v[200:203]
    v_exp_f32 v14, v14
    v_mfma_f32_16x16x32_bf16 v[200:203], v[66:69], a[184:187], v[200:203]
    ds_read_b128 a[124:127], v45 offset:24576
    ds_read_b128 a[140:143], v45 offset:28672
    v_mfma_f32_16x16x32_bf16 v[204:207], v[62:65], a[156:159], v[204:207]
    v_exp_f32 v15, v15
    v_mfma_f32_16x16x32_bf16 v[204:207], v[66:69], a[188:191], v[204:207]
    ds_read_b128 a[136:139], v44 offset:28672
    v_cvt_pk_bf16_f32 v57, v14, v15
    v_mfma_f32_16x16x32_bf16 v[208:211], v[62:65], a[160:163], v[208:211]
    v_exp_f32 v78, v78
    v_mfma_f32_16x16x32_bf16 v[208:211], v[66:69], a[192:195], v[208:211]
    ds_read_b128 a[132:135], v43 offset:28672
    ds_read_b128 a[128:131], v42 offset:28672
    v_mfma_f32_16x16x32_bf16 v[212:215], v[62:65], a[164:167], v[212:215]
    v_exp_f32 v79, v79
    v_mfma_f32_16x16x32_bf16 v[212:215], v[66:69], a[196:199], v[212:215]
    ds_read_b64_tr_b16 a[222:223], v47 offset:20480
    v_cvt_pk_bf16_f32 v58, v78, v79
    v_mfma_f32_16x16x32_bf16 v[216:219], v[62:65], a[168:171], v[216:219]
    v_exp_f32 v80, v80
    v_mfma_f32_16x16x32_bf16 v[216:219], v[66:69], a[200:203], v[216:219]
    ds_read_b64_tr_b16 a[224:225], v47 offset:24576
    ds_read_b64_tr_b16 a[226:227], v47 offset:28672
    v_mfma_f32_16x16x32_bf16 v[220:223], v[62:65], a[172:175], v[220:223]
    v_exp_f32 v81, v81
    v_mfma_f32_16x16x32_bf16 v[220:223], v[66:69], a[204:207], v[220:223]
    s_waitcnt lgkmcnt(8)
    ds_read_b64_tr_b16 a[228:229], v50 offset:16384
    v_cvt_pk_bf16_f32 v59, v80, v81
L_entry_w5:
    v_mfma_f32_16x16x32_bf16 v[8:11], a[80:83], a[0:3], v[16:19]
    v_exp_f32 v82, v82
    v_mfma_f32_16x16x32_bf16 v[8:11], a[84:87], a[4:7], v[8:11]
    ds_read_b64_tr_b16 a[230:231], v50 offset:20480
    ds_read_b64_tr_b16 a[232:233], v50 offset:24576
    v_mfma_f32_16x16x32_bf16 v[8:11], a[88:91], a[8:11], v[8:11]
    v_exp_f32 v83, v83
    v_mfma_f32_16x16x32_bf16 v[8:11], a[92:95], a[12:15], v[8:11]
    ds_read_b64_tr_b16 a[234:235], v50 offset:28672
    v_cvt_pk_bf16_f32 v60, v82, v83
    v_mfma_f32_16x16x32_bf16 v[12:15], a[108:111], a[12:15], v[16:19]
    v_exp_f32 v84, v84
    v_mfma_f32_16x16x32_bf16 v[12:15], a[104:107], a[8:11], v[12:15]
    ds_read_b64_tr_b16 a[236:237], v51 offset:16384
    ds_read_b64_tr_b16 a[238:239], v51 offset:20480
    v_mfma_f32_16x16x32_bf16 v[12:15], a[100:103], a[4:7], v[12:15]
    v_exp_f32 v85, v85
    v_mfma_f32_16x16x32_bf16 v[12:15], a[96:99], a[0:3], v[12:15]
    ds_read_b64_tr_b16 a[240:241], v51 offset:24576
    v_cvt_pk_bf16_f32 v61, v84, v85
    v_mfma_f32_16x16x32_bf16 v[78:81], a[112:115], a[0:3], v[16:19]
    v_exp_f32 v8, v8
    v_mfma_f32_16x16x32_bf16 v[78:81], a[116:119], a[4:7], v[78:81]
    ds_read_b64_tr_b16 a[242:243], v51 offset:28672
    v_mfma_f32_16x16x32_bf16 v[78:81], a[120:123], a[8:11], v[78:81]
    s_waitcnt lgkmcnt(7)
    v_exp_f32 v9, v9
    v_mfma_f32_16x16x32_bf16 v[78:81], a[124:127], a[12:15], v[78:81]
    v_cvt_pk_bf16_f32 v62, v8, v9
    v_mfma_f32_16x16x32_bf16 v[82:85], a[140:143], a[12:15], v[16:19]
    v_exp_f32 v10, v10
    v_mfma_f32_16x16x32_bf16 v[82:85], a[136:139], a[8:11], v[82:85]
    v_mfma_f32_16x16x32_bf16 v[82:85], a[132:135], a[4:7], v[82:85]
    v_exp_f32 v11, v11
    v_mfma_f32_16x16x32_bf16 v[82:85], a[128:131], a[0:3], v[82:85]
    v_cvt_pk_bf16_f32 v63, v10, v11
    v_smfmac_f32_16x16x64_bf16 a[252:255], a[208:211], v[54:61], v41
    v_mfma_f32_16x16x32_bf16 v[224:227], v[54:57], a[144:147], v[224:227]
    v_exp_f32 v12, v12
    v_mfma_f32_16x16x32_bf16 v[224:227], v[58:61], a[176:179], v[224:227]
    v_mfma_f32_16x16x32_bf16 v[228:231], v[54:57], a[148:151], v[228:231]
    v_exp_f32 v13, v13
    v_mfma_f32_16x16x32_bf16 v[228:231], v[58:61], a[180:183], v[228:231]
    v_cvt_pk_bf16_f32 v64, v12, v13
    v_mfma_f32_16x16x32_bf16 v[232:235], v[54:57], a[152:155], v[232:235]
    v_exp_f32 v14, v14
    v_mfma_f32_16x16x32_bf16 v[232:235], v[58:61], a[184:187], v[232:235]
    ds_read_b64_tr_b16 a[152:153], v48 offset:16384
    ds_read_b64_tr_b16 a[154:155], v48 offset:20480
    v_mfma_f32_16x16x32_bf16 v[236:239], v[54:57], a[156:159], v[236:239]
    v_exp_f32 v15, v15
    v_mfma_f32_16x16x32_bf16 v[236:239], v[58:61], a[188:191], v[236:239]
    ds_read_b64_tr_b16 a[184:185], v48 offset:24576
    v_cvt_pk_bf16_f32 v65, v14, v15
    v_mfma_f32_16x16x32_bf16 v[240:243], v[54:57], a[160:163], v[240:243]
    v_exp_f32 v78, v78
    v_mfma_f32_16x16x32_bf16 v[240:243], v[58:61], a[192:195], v[240:243]
    ds_read_b64_tr_b16 a[186:187], v48 offset:28672
    ds_read_b64_tr_b16 a[156:157], v49 offset:16384
    v_mfma_f32_16x16x32_bf16 v[244:247], v[54:57], a[164:167], v[244:247]
    v_exp_f32 v79, v79
    v_mfma_f32_16x16x32_bf16 v[244:247], v[58:61], a[196:199], v[244:247]
    ds_read_b64_tr_b16 a[158:159], v49 offset:20480
    v_cvt_pk_bf16_f32 v66, v78, v79
    v_mfma_f32_16x16x32_bf16 v[248:251], v[54:57], a[168:171], v[248:251]
    v_exp_f32 v80, v80
    v_mfma_f32_16x16x32_bf16 v[248:251], v[58:61], a[200:203], v[248:251]
    ds_read_b64_tr_b16 a[188:189], v49 offset:24576
    ds_read_b64_tr_b16 a[190:191], v49 offset:28672
    v_mfma_f32_16x16x32_bf16 v[252:255], v[54:57], a[172:175], v[252:255]
    v_exp_f32 v81, v81
    v_mfma_f32_16x16x32_bf16 v[252:255], v[58:61], a[204:207], v[252:255]
    ds_read_b64_tr_b16 a[168:169], v52 offset:16384
    v_cvt_pk_bf16_f32 v67, v80, v81
    v_mfma_f32_16x16x32_bf16 v[8:11], a[80:83], a[16:19], v[20:23]
    v_exp_f32 v82, v82
    v_mfma_f32_16x16x32_bf16 v[8:11], a[84:87], a[20:23], v[8:11]
    ds_read_b64_tr_b16 a[170:171], v52 offset:20480
    ds_read_b64_tr_b16 a[200:201], v52 offset:24576
    v_mfma_f32_16x16x32_bf16 v[8:11], a[88:91], a[24:27], v[8:11]
    v_exp_f32 v83, v83
    v_mfma_f32_16x16x32_bf16 v[8:11], a[92:95], a[28:31], v[8:11]
    ds_read_b64_tr_b16 a[202:203], v52 offset:28672
    v_cvt_pk_bf16_f32 v68, v82, v83
    v_mfma_f32_16x16x32_bf16 v[12:15], a[108:111], a[28:31], v[20:23]
    v_exp_f32 v84, v84
    v_mfma_f32_16x16x32_bf16 v[12:15], a[104:107], a[24:27], v[12:15]
    ds_read_b64_tr_b16 a[172:173], v53 offset:16384
    ds_read_b64_tr_b16 a[174:175], v53 offset:20480
    v_mfma_f32_16x16x32_bf16 v[12:15], a[100:103], a[20:23], v[12:15]
    v_exp_f32 v85, v85
    v_mfma_f32_16x16x32_bf16 v[12:15], a[96:99], a[16:19], v[12:15]
    ds_read_b64_tr_b16 a[204:205], v53 offset:24576
    v_cvt_pk_bf16_f32 v69, v84, v85
    v_mfma_f32_16x16x32_bf16 v[78:81], a[112:115], a[16:19], v[20:23]
    v_exp_f32 v8, v8
    v_mfma_f32_16x16x32_bf16 v[78:81], a[116:119], a[20:23], v[78:81]
    ds_read_b64_tr_b16 a[206:207], v53 offset:28672
    v_add_f32 v37, v37, v8
    v_mfma_f32_16x16x32_bf16 v[78:81], a[120:123], a[24:27], v[78:81]
    v_exp_f32 v9, v9
    v_mfma_f32_16x16x32_bf16 v[78:81], a[124:127], a[28:31], v[78:81]
    v_cvt_pk_bf16_f32 v54, v8, v9
    v_add_f32 v37, v37, v9
    v_mfma_f32_16x16x32_bf16 v[82:85], a[140:143], a[28:31], v[20:23]
    v_exp_f32 v10, v10
    v_mfma_f32_16x16x32_bf16 v[82:85], a[136:139], a[24:27], v[82:85]
    v_add_f32 v37, v37, v10
    v_mfma_f32_16x16x32_bf16 v[82:85], a[132:135], a[20:23], v[82:85]
    v_exp_f32 v11, v11
    v_mfma_f32_16x16x32_bf16 v[82:85], a[128:131], a[16:19], v[82:85]
    v_cvt_pk_bf16_f32 v55, v10, v11
    v_add_f32 v37, v37, v11
    v_smfmac_f32_16x16x64_bf16 a[248:251], a[208:211], v[62:69], v41
    v_mfma_f32_16x16x32_bf16 v[96:99], v[62:65], a[212:215], v[96:99]
    v_exp_f32 v12, v12
    v_mfma_f32_16x16x32_bf16 v[96:99], v[66:69], a[216:219], v[96:99]
    v_add_f32 v37, v37, v12
    v_mfma_f32_16x16x32_bf16 v[100:103], v[62:65], a[220:223], v[100:103]
    v_exp_f32 v13, v13
    v_mfma_f32_16x16x32_bf16 v[100:103], v[66:69], a[224:227], v[100:103]
    s_waitcnt lgkmcnt(0)
    v_cvt_pk_bf16_f32 v56, v12, v13
    v_add_f32 v37, v37, v13
    v_mfma_f32_16x16x32_bf16 v[104:107], v[62:65], a[152:155], v[104:107]
    v_exp_f32 v14, v14
    v_mfma_f32_16x16x32_bf16 v[104:107], v[66:69], a[184:187], v[104:107]
    v_add_f32 v37, v37, v14
    v_mfma_f32_16x16x32_bf16 v[108:111], v[62:65], a[156:159], v[108:111]
    v_exp_f32 v15, v15
    v_mfma_f32_16x16x32_bf16 v[108:111], v[66:69], a[188:191], v[108:111]
    v_cvt_pk_bf16_f32 v57, v14, v15
    v_add_f32 v37, v37, v15
    v_mfma_f32_16x16x32_bf16 v[112:115], v[62:65], a[228:231], v[112:115]
    v_exp_f32 v78, v78
    v_mfma_f32_16x16x32_bf16 v[112:115], v[66:69], a[232:235], v[112:115]
    v_add_f32 v37, v37, v78
    v_mfma_f32_16x16x32_bf16 v[116:119], v[62:65], a[236:239], v[116:119]
    v_exp_f32 v79, v79
    v_mfma_f32_16x16x32_bf16 v[116:119], v[66:69], a[240:243], v[116:119]
    v_cvt_pk_bf16_f32 v58, v78, v79
    v_add_f32 v37, v37, v79
    v_mfma_f32_16x16x32_bf16 v[120:123], v[62:65], a[168:171], v[120:123]
    v_exp_f32 v80, v80
    v_mfma_f32_16x16x32_bf16 v[120:123], v[66:69], a[200:203], v[120:123]
    v_add_f32 v37, v37, v80
    v_mfma_f32_16x16x32_bf16 v[124:127], v[62:65], a[172:175], v[124:127]
    v_exp_f32 v81, v81
    v_mfma_f32_16x16x32_bf16 v[124:127], v[66:69], a[204:207], v[124:127]
    v_cvt_pk_bf16_f32 v59, v80, v81
    v_add_f32 v37, v37, v81
    v_mfma_f32_16x16x32_bf16 v[8:11], a[80:83], a[32:35], v[24:27]
    v_exp_f32 v82, v82
    v_mfma_f32_16x16x32_bf16 v[8:11], a[84:87], a[36:39], v[8:11]
    v_add_f32 v37, v37, v82
    v_mfma_f32_16x16x32_bf16 v[8:11], a[88:91], a[40:43], v[8:11]
    v_exp_f32 v83, v83
    v_mfma_f32_16x16x32_bf16 v[8:11], a[92:95], a[44:47], v[8:11]
    v_cvt_pk_bf16_f32 v60, v82, v83
    v_add_f32 v37, v37, v83
    v_mfma_f32_16x16x32_bf16 v[12:15], a[108:111], a[44:47], v[24:27]
    v_exp_f32 v84, v84
    v_mfma_f32_16x16x32_bf16 v[12:15], a[104:107], a[40:43], v[12:15]
    v_add_f32 v37, v37, v84
    v_mfma_f32_16x16x32_bf16 v[12:15], a[100:103], a[36:39], v[12:15]
    v_exp_f32 v85, v85
    v_mfma_f32_16x16x32_bf16 v[12:15], a[96:99], a[32:35], v[12:15]
    v_cvt_pk_bf16_f32 v61, v84, v85
    v_add_f32 v37, v37, v85
    v_mfma_f32_16x16x32_bf16 v[78:81], a[112:115], a[32:35], v[24:27]
    v_exp_f32 v8, v8
    v_mfma_f32_16x16x32_bf16 v[78:81], a[116:119], a[36:39], v[78:81]
    v_add_f32 v38, v38, v8
    v_mfma_f32_16x16x32_bf16 v[78:81], a[120:123], a[40:43], v[78:81]
    v_exp_f32 v9, v9
    v_mfma_f32_16x16x32_bf16 v[78:81], a[124:127], a[44:47], v[78:81]
    v_cvt_pk_bf16_f32 v62, v8, v9
    v_add_f32 v38, v38, v9
    v_mfma_f32_16x16x32_bf16 v[82:85], a[140:143], a[44:47], v[24:27]
    v_exp_f32 v10, v10
    v_mfma_f32_16x16x32_bf16 v[82:85], a[136:139], a[40:43], v[82:85]
    v_add_f32 v38, v38, v10
    v_mfma_f32_16x16x32_bf16 v[82:85], a[132:135], a[36:39], v[82:85]
    v_exp_f32 v11, v11
    v_mfma_f32_16x16x32_bf16 v[82:85], a[128:131], a[32:35], v[82:85]
    v_cvt_pk_bf16_f32 v63, v10, v11
    v_add_f32 v38, v38, v11
    v_mfma_f32_16x16x32_bf16 v[128:131], v[54:57], a[212:215], v[128:131]
    v_exp_f32 v12, v12
    v_mfma_f32_16x16x32_bf16 v[128:131], v[58:61], a[216:219], v[128:131]
    v_add_f32 v38, v38, v12
    v_mfma_f32_16x16x32_bf16 v[132:135], v[54:57], a[220:223], v[132:135]
    v_exp_f32 v13, v13
    v_mfma_f32_16x16x32_bf16 v[132:135], v[58:61], a[224:227], v[132:135]
    v_cvt_pk_bf16_f32 v64, v12, v13
    v_add_f32 v38, v38, v13
    v_mfma_f32_16x16x32_bf16 v[136:139], v[54:57], a[152:155], v[136:139]
    v_exp_f32 v14, v14
    v_mfma_f32_16x16x32_bf16 v[136:139], v[58:61], a[184:187], v[136:139]
    v_add_f32 v38, v38, v14
    v_mfma_f32_16x16x32_bf16 v[140:143], v[54:57], a[156:159], v[140:143]
    v_exp_f32 v15, v15
    v_mfma_f32_16x16x32_bf16 v[140:143], v[58:61], a[188:191], v[140:143]
    v_cvt_pk_bf16_f32 v65, v14, v15
    v_add_f32 v38, v38, v15
    v_mfma_f32_16x16x32_bf16 v[144:147], v[54:57], a[228:231], v[144:147]
    v_exp_f32 v78, v78
    v_mfma_f32_16x16x32_bf16 v[144:147], v[58:61], a[232:235], v[144:147]
    v_add_f32 v38, v38, v78
    v_mfma_f32_16x16x32_bf16 v[148:151], v[54:57], a[236:239], v[148:151]
    v_exp_f32 v79, v79
    v_mfma_f32_16x16x32_bf16 v[148:151], v[58:61], a[240:243], v[148:151]
    v_cvt_pk_bf16_f32 v66, v78, v79
    v_add_f32 v38, v38, v79
    v_mfma_f32_16x16x32_bf16 v[152:155], v[54:57], a[168:171], v[152:155]
    v_exp_f32 v80, v80
    v_mfma_f32_16x16x32_bf16 v[152:155], v[58:61], a[200:203], v[152:155]
    v_add_f32 v38, v38, v80
    v_mfma_f32_16x16x32_bf16 v[156:159], v[54:57], a[172:175], v[156:159]
    v_exp_f32 v81, v81
    v_mfma_f32_16x16x32_bf16 v[156:159], v[58:61], a[204:207], v[156:159]
    v_cvt_pk_bf16_f32 v67, v80, v81
    v_add_f32 v38, v38, v81
    v_mfma_f32_16x16x32_bf16 v[8:11], a[80:83], a[48:51], v[28:31]
    v_exp_f32 v82, v82
    v_mfma_f32_16x16x32_bf16 v[8:11], a[84:87], a[52:55], v[8:11]
    v_add_f32 v38, v38, v82
    v_mfma_f32_16x16x32_bf16 v[8:11], a[88:91], a[56:59], v[8:11]
    v_exp_f32 v83, v83
    v_mfma_f32_16x16x32_bf16 v[8:11], a[92:95], a[60:63], v[8:11]
    v_cvt_pk_bf16_f32 v68, v82, v83
    v_add_f32 v38, v38, v83
    v_mfma_f32_16x16x32_bf16 v[12:15], a[108:111], a[60:63], v[28:31]
    v_exp_f32 v84, v84
    v_mfma_f32_16x16x32_bf16 v[12:15], a[104:107], a[56:59], v[12:15]
    v_add_f32 v38, v38, v84
    v_mfma_f32_16x16x32_bf16 v[12:15], a[100:103], a[52:55], v[12:15]
    v_exp_f32 v85, v85
    v_mfma_f32_16x16x32_bf16 v[12:15], a[96:99], a[48:51], v[12:15]
    v_cvt_pk_bf16_f32 v69, v84, v85
    v_add_f32 v38, v38, v85
    v_mfma_f32_16x16x32_bf16 v[78:81], a[112:115], a[48:51], v[28:31]
    v_exp_f32 v8, v8
    v_mfma_f32_16x16x32_bf16 v[78:81], a[116:119], a[52:55], v[78:81]
    s_barrier
    v_add_f32 v39, v39, v8
    v_mfma_f32_16x16x32_bf16 v[78:81], a[120:123], a[56:59], v[78:81]
    v_exp_f32 v9, v9
    v_mfma_f32_16x16x32_bf16 v[78:81], a[124:127], a[60:63], v[78:81]
    v_cvt_pk_bf16_f32 v54, v8, v9
    v_add_f32 v39, v39, v9
    v_mfma_f32_16x16x32_bf16 v[82:85], a[140:143], a[60:63], v[28:31]
    v_exp_f32 v10, v10
    v_mfma_f32_16x16x32_bf16 v[82:85], a[136:139], a[56:59], v[82:85]
    ds_read_b64_tr_b16 a[144:145], v46 offset:32768
    v_add_f32 v39, v39, v10
    v_mfma_f32_16x16x32_bf16 v[82:85], a[132:135], a[52:55], v[82:85]
    v_exp_f32 v11, v11
    v_mfma_f32_16x16x32_bf16 v[82:85], a[128:131], a[48:51], v[82:85]
    v_cvt_pk_bf16_f32 v55, v10, v11
    v_add_f32 v39, v39, v11
    v_mfma_f32_16x16x32_bf16 v[160:163], v[62:65], a[212:215], v[160:163]
    v_exp_f32 v12, v12
    v_mfma_f32_16x16x32_bf16 v[160:163], v[66:69], a[216:219], v[160:163]
    ds_read_b64_tr_b16 a[146:147], v46 offset:36864
    v_add_f32 v39, v39, v12
    v_mfma_f32_16x16x32_bf16 v[164:167], v[62:65], a[220:223], v[164:167]
    v_exp_f32 v13, v13
    v_mfma_f32_16x16x32_bf16 v[164:167], v[66:69], a[224:227], v[164:167]
    v_cvt_pk_bf16_f32 v56, v12, v13
    v_add_f32 v39, v39, v13
    v_mfma_f32_16x16x32_bf16 v[168:171], v[62:65], a[152:155], v[168:171]
    v_exp_f32 v14, v14
    v_mfma_f32_16x16x32_bf16 v[168:171], v[66:69], a[184:187], v[168:171]
    ds_read_b64_tr_b16 a[176:177], v46 offset:40960
    v_add_f32 v39, v39, v14
    v_mfma_f32_16x16x32_bf16 v[172:175], v[62:65], a[156:159], v[172:175]
    v_exp_f32 v15, v15
    v_mfma_f32_16x16x32_bf16 v[172:175], v[66:69], a[188:191], v[172:175]
    v_cvt_pk_bf16_f32 v57, v14, v15
    v_add_f32 v39, v39, v15
    v_mfma_f32_16x16x32_bf16 v[176:179], v[62:65], a[228:231], v[176:179]
    v_exp_f32 v78, v78
    v_mfma_f32_16x16x32_bf16 v[176:179], v[66:69], a[232:235], v[176:179]
    ds_read_b64_tr_b16 a[178:179], v46 offset:45056
    v_add_f32 v39, v39, v78
    v_mfma_f32_16x16x32_bf16 v[180:183], v[62:65], a[236:239], v[180:183]
    v_exp_f32 v79, v79
    v_mfma_f32_16x16x32_bf16 v[180:183], v[66:69], a[240:243], v[180:183]
    v_cvt_pk_bf16_f32 v58, v78, v79
    v_add_f32 v39, v39, v79
    v_mfma_f32_16x16x32_bf16 v[184:187], v[62:65], a[168:171], v[184:187]
    v_exp_f32 v80, v80
    v_mfma_f32_16x16x32_bf16 v[184:187], v[66:69], a[200:203], v[184:187]
    ds_read_b64_tr_b16 a[148:149], v47 offset:32768
    v_add_f32 v39, v39, v80
    v_mfma_f32_16x16x32_bf16 v[188:191], v[62:65], a[172:175], v[188:191]
    v_exp_f32 v81, v81
    v_mfma_f32_16x16x32_bf16 v[188:191], v[66:69], a[204:207], v[188:191]
    v_cvt_pk_bf16_f32 v59, v80, v81
    v_add_f32 v39, v39, v81
    v_mfma_f32_16x16x32_bf16 v[8:11], a[80:83], a[64:67], v[32:35]
    v_exp_f32 v82, v82
    v_mfma_f32_16x16x32_bf16 v[8:11], a[84:87], a[68:71], v[8:11]
    ds_read_b128 a[80:83], v42 offset:32768
    v_add_f32 v39, v39, v82
    v_mfma_f32_16x16x32_bf16 v[8:11], a[88:91], a[72:75], v[8:11]
    v_exp_f32 v83, v83
    v_mfma_f32_16x16x32_bf16 v[8:11], a[92:95], a[76:79], v[8:11]
    v_cvt_pk_bf16_f32 v60, v82, v83
    v_add_f32 v39, v39, v83
    v_mfma_f32_16x16x32_bf16 v[12:15], a[108:111], a[76:79], v[32:35]
    v_exp_f32 v84, v84
    v_mfma_f32_16x16x32_bf16 v[12:15], a[104:107], a[72:75], v[12:15]
    ds_read_b128 a[84:87], v43 offset:32768
    v_add_f32 v39, v39, v84
    v_mfma_f32_16x16x32_bf16 v[12:15], a[100:103], a[68:71], v[12:15]
    v_exp_f32 v85, v85
    v_mfma_f32_16x16x32_bf16 v[12:15], a[96:99], a[64:67], v[12:15]
    v_cvt_pk_bf16_f32 v61, v84, v85
    v_add_f32 v39, v39, v85
    v_mfma_f32_16x16x32_bf16 v[78:81], a[112:115], a[64:67], v[32:35]
    v_exp_f32 v8, v8
    v_mfma_f32_16x16x32_bf16 v[78:81], a[116:119], a[68:71], v[78:81]
    ds_read_b128 a[88:91], v44 offset:32768
    ds_read_b128 a[92:95], v45 offset:32768
    v_mfma_f32_16x16x32_bf16 v[78:81], a[120:123], a[72:75], v[78:81]
    v_exp_f32 v9, v9
    v_mfma_f32_16x16x32_bf16 v[78:81], a[124:127], a[76:79], v[78:81]
    ds_read_b128 a[108:111], v45 offset:36864
    v_cvt_pk_bf16_f32 v62, v8, v9
    v_mfma_f32_16x16x32_bf16 v[82:85], a[140:143], a[76:79], v[32:35]
    v_exp_f32 v10, v10
    v_mfma_f32_16x16x32_bf16 v[82:85], a[136:139], a[72:75], v[82:85]
    ds_read_b128 a[104:107], v44 offset:36864
    ds_read_b128 a[100:103], v43 offset:36864
    v_mfma_f32_16x16x32_bf16 v[82:85], a[132:135], a[68:71], v[82:85]
    v_exp_f32 v11, v11
    v_mfma_f32_16x16x32_bf16 v[82:85], a[128:131], a[64:67], v[82:85]
    ds_read_b128 a[96:99], v42 offset:36864
    v_cvt_pk_bf16_f32 v63, v10, v11
    v_mfma_f32_16x16x32_bf16 v[192:195], v[54:57], a[212:215], v[192:195]
    v_exp_f32 v12, v12
    v_mfma_f32_16x16x32_bf16 v[192:195], v[58:61], a[216:219], v[192:195]
    ds_read_b128 a[112:115], v42 offset:40960
    ds_read_b128 a[116:119], v43 offset:40960
    v_mfma_f32_16x16x32_bf16 v[196:199], v[54:57], a[220:223], v[196:199]
    v_exp_f32 v13, v13
    v_mfma_f32_16x16x32_bf16 v[196:199], v[58:61], a[224:227], v[196:199]
    ds_read_b128 a[120:123], v44 offset:40960
    v_cvt_pk_bf16_f32 v64, v12, v13
    v_mfma_f32_16x16x32_bf16 v[200:203], v[54:57], a[152:155], v[200:203]
    v_exp_f32 v14, v14
    v_mfma_f32_16x16x32_bf16 v[200:203], v[58:61], a[184:187], v[200:203]
    ds_read_b128 a[124:127], v45 offset:40960
    ds_read_b128 a[140:143], v45 offset:45056
    v_mfma_f32_16x16x32_bf16 v[204:207], v[54:57], a[156:159], v[204:207]
    v_exp_f32 v15, v15
    v_mfma_f32_16x16x32_bf16 v[204:207], v[58:61], a[188:191], v[204:207]
    ds_read_b128 a[136:139], v44 offset:45056
    v_cvt_pk_bf16_f32 v65, v14, v15
    v_mfma_f32_16x16x32_bf16 v[208:211], v[54:57], a[228:231], v[208:211]
    v_exp_f32 v78, v78
    v_mfma_f32_16x16x32_bf16 v[208:211], v[58:61], a[232:235], v[208:211]
    ds_read_b128 a[132:135], v43 offset:45056
    ds_read_b128 a[128:131], v42 offset:45056
    v_mfma_f32_16x16x32_bf16 v[212:215], v[54:57], a[236:239], v[212:215]
    v_exp_f32 v79, v79
    v_mfma_f32_16x16x32_bf16 v[212:215], v[58:61], a[240:243], v[212:215]
    ds_read_b64_tr_b16 a[150:151], v47 offset:36864
    v_cvt_pk_bf16_f32 v66, v78, v79
    v_mfma_f32_16x16x32_bf16 v[216:219], v[54:57], a[168:171], v[216:219]
    v_exp_f32 v80, v80
    v_mfma_f32_16x16x32_bf16 v[216:219], v[58:61], a[200:203], v[216:219]
    ds_read_b64_tr_b16 a[180:181], v47 offset:40960
    ds_read_b64_tr_b16 a[182:183], v47 offset:45056
    v_mfma_f32_16x16x32_bf16 v[220:223], v[54:57], a[172:175], v[220:223]
    v_exp_f32 v81, v81
    v_mfma_f32_16x16x32_bf16 v[220:223], v[58:61], a[204:207], v[220:223]
    s_waitcnt lgkmcnt(8)
    ds_read_b64_tr_b16 a[160:161], v50 offset:32768
    v_cvt_pk_bf16_f32 v67, v80, v81
    v_mfma_f32_16x16x32_bf16 v[8:11], a[80:83], a[0:3], v[16:19]
    v_exp_f32 v82, v82
    v_mfma_f32_16x16x32_bf16 v[8:11], a[84:87], a[4:7], v[8:11]
    ds_read_b64_tr_b16 a[162:163], v50 offset:36864
    ds_read_b64_tr_b16 a[192:193], v50 offset:40960
    v_mfma_f32_16x16x32_bf16 v[8:11], a[88:91], a[8:11], v[8:11]
    v_exp_f32 v83, v83
    v_mfma_f32_16x16x32_bf16 v[8:11], a[92:95], a[12:15], v[8:11]
    ds_read_b64_tr_b16 a[194:195], v50 offset:45056
    v_cvt_pk_bf16_f32 v68, v82, v83
    v_mfma_f32_16x16x32_bf16 v[12:15], a[108:111], a[12:15], v[16:19]
    v_exp_f32 v84, v84
    v_mfma_f32_16x16x32_bf16 v[12:15], a[104:107], a[8:11], v[12:15]
    ds_read_b64_tr_b16 a[164:165], v51 offset:32768
    ds_read_b64_tr_b16 a[166:167], v51 offset:36864
    v_mfma_f32_16x16x32_bf16 v[12:15], a[100:103], a[4:7], v[12:15]
    v_exp_f32 v85, v85
    v_mfma_f32_16x16x32_bf16 v[12:15], a[96:99], a[0:3], v[12:15]
    ds_read_b64_tr_b16 a[196:197], v51 offset:40960
    v_cvt_pk_bf16_f32 v69, v84, v85
    v_mfma_f32_16x16x32_bf16 v[78:81], a[112:115], a[0:3], v[16:19]
    v_exp_f32 v8, v8
    v_mfma_f32_16x16x32_bf16 v[78:81], a[116:119], a[4:7], v[78:81]
    ds_read_b64_tr_b16 a[198:199], v51 offset:45056
    v_mfma_f32_16x16x32_bf16 v[78:81], a[120:123], a[8:11], v[78:81]
    s_waitcnt lgkmcnt(7)
    v_exp_f32 v9, v9
    v_mfma_f32_16x16x32_bf16 v[78:81], a[124:127], a[12:15], v[78:81]
    v_cvt_pk_bf16_f32 v54, v8, v9
    v_mfma_f32_16x16x32_bf16 v[82:85], a[140:143], a[12:15], v[16:19]
    v_exp_f32 v10, v10
    v_mfma_f32_16x16x32_bf16 v[82:85], a[136:139], a[8:11], v[82:85]
    v_mfma_f32_16x16x32_bf16 v[82:85], a[132:135], a[4:7], v[82:85]
    v_exp_f32 v11, v11
    v_mfma_f32_16x16x32_bf16 v[82:85], a[128:131], a[0:3], v[82:85]
    v_cvt_pk_bf16_f32 v55, v10, v11
    v_smfmac_f32_16x16x64_bf16 a[252:255], a[208:211], v[62:69], v41
    v_mfma_f32_16x16x32_bf16 v[224:227], v[62:65], a[212:215], v[224:227]
    v_exp_f32 v12, v12
    v_mfma_f32_16x16x32_bf16 v[224:227], v[66:69], a[216:219], v[224:227]
    v_mfma_f32_16x16x32_bf16 v[228:231], v[62:65], a[220:223], v[228:231]
    v_exp_f32 v13, v13
    v_mfma_f32_16x16x32_bf16 v[228:231], v[66:69], a[224:227], v[228:231]
    v_cvt_pk_bf16_f32 v56, v12, v13
    v_mfma_f32_16x16x32_bf16 v[232:235], v[62:65], a[152:155], v[232:235]
    v_exp_f32 v14, v14
    v_mfma_f32_16x16x32_bf16 v[232:235], v[66:69], a[184:187], v[232:235]
    ds_read_b64_tr_b16 a[152:153], v48 offset:32768
    ds_read_b64_tr_b16 a[154:155], v48 offset:36864
    v_mfma_f32_16x16x32_bf16 v[236:239], v[62:65], a[156:159], v[236:239]
    v_exp_f32 v15, v15
    v_mfma_f32_16x16x32_bf16 v[236:239], v[66:69], a[188:191], v[236:239]
    ds_read_b64_tr_b16 a[184:185], v48 offset:40960
    v_cvt_pk_bf16_f32 v57, v14, v15
    v_mfma_f32_16x16x32_bf16 v[240:243], v[62:65], a[228:231], v[240:243]
    v_exp_f32 v78, v78
    v_mfma_f32_16x16x32_bf16 v[240:243], v[66:69], a[232:235], v[240:243]
    ds_read_b64_tr_b16 a[186:187], v48 offset:45056
    ds_read_b64_tr_b16 a[156:157], v49 offset:32768
    v_mfma_f32_16x16x32_bf16 v[244:247], v[62:65], a[236:239], v[244:247]
    v_exp_f32 v79, v79
    v_mfma_f32_16x16x32_bf16 v[244:247], v[66:69], a[240:243], v[244:247]
    ds_read_b64_tr_b16 a[158:159], v49 offset:36864
    v_cvt_pk_bf16_f32 v58, v78, v79
    v_mfma_f32_16x16x32_bf16 v[248:251], v[62:65], a[168:171], v[248:251]
    v_exp_f32 v80, v80
    v_mfma_f32_16x16x32_bf16 v[248:251], v[66:69], a[200:203], v[248:251]
    ds_read_b64_tr_b16 a[188:189], v49 offset:40960
    ds_read_b64_tr_b16 a[190:191], v49 offset:45056
    v_mfma_f32_16x16x32_bf16 v[252:255], v[62:65], a[172:175], v[252:255]
    v_exp_f32 v81, v81
    v_mfma_f32_16x16x32_bf16 v[252:255], v[66:69], a[204:207], v[252:255]
    ds_read_b64_tr_b16 a[168:169], v52 offset:32768
    v_cvt_pk_bf16_f32 v59, v80, v81
    v_mfma_f32_16x16x32_bf16 v[8:11], a[80:83], a[16:19], v[20:23]
    v_exp_f32 v82, v82
    v_mfma_f32_16x16x32_bf16 v[8:11], a[84:87], a[20:23], v[8:11]
    ds_read_b64_tr_b16 a[170:171], v52 offset:36864
    ds_read_b64_tr_b16 a[200:201], v52 offset:40960
    v_mfma_f32_16x16x32_bf16 v[8:11], a[88:91], a[24:27], v[8:11]
    v_exp_f32 v83, v83
    v_mfma_f32_16x16x32_bf16 v[8:11], a[92:95], a[28:31], v[8:11]
    ds_read_b64_tr_b16 a[202:203], v52 offset:45056
    v_cvt_pk_bf16_f32 v60, v82, v83
    v_mfma_f32_16x16x32_bf16 v[12:15], a[108:111], a[28:31], v[20:23]
    v_exp_f32 v84, v84
    v_mfma_f32_16x16x32_bf16 v[12:15], a[104:107], a[24:27], v[12:15]
    ds_read_b64_tr_b16 a[172:173], v53 offset:32768
    ds_read_b64_tr_b16 a[174:175], v53 offset:36864
    v_mfma_f32_16x16x32_bf16 v[12:15], a[100:103], a[20:23], v[12:15]
    v_exp_f32 v85, v85
    v_mfma_f32_16x16x32_bf16 v[12:15], a[96:99], a[16:19], v[12:15]
    ds_read_b64_tr_b16 a[204:205], v53 offset:40960
    v_cvt_pk_bf16_f32 v61, v84, v85
    v_mfma_f32_16x16x32_bf16 v[78:81], a[112:115], a[16:19], v[20:23]
    v_exp_f32 v8, v8
    v_mfma_f32_16x16x32_bf16 v[78:81], a[116:119], a[20:23], v[78:81]
    ds_read_b64_tr_b16 a[206:207], v53 offset:45056
    v_add_f32 v37, v37, v8
    v_mfma_f32_16x16x32_bf16 v[78:81], a[120:123], a[24:27], v[78:81]
    v_exp_f32 v9, v9
    v_mfma_f32_16x16x32_bf16 v[78:81], a[124:127], a[28:31], v[78:81]
    v_cvt_pk_bf16_f32 v62, v8, v9
    v_add_f32 v37, v37, v9
    v_mfma_f32_16x16x32_bf16 v[82:85], a[140:143], a[28:31], v[20:23]
    v_exp_f32 v10, v10
    v_mfma_f32_16x16x32_bf16 v[82:85], a[136:139], a[24:27], v[82:85]
    v_add_f32 v37, v37, v10
    v_mfma_f32_16x16x32_bf16 v[82:85], a[132:135], a[20:23], v[82:85]
    v_exp_f32 v11, v11
    v_mfma_f32_16x16x32_bf16 v[82:85], a[128:131], a[16:19], v[82:85]
    v_cvt_pk_bf16_f32 v63, v10, v11
    v_add_f32 v37, v37, v11
    v_smfmac_f32_16x16x64_bf16 a[248:251], a[208:211], v[54:61], v41
    v_mfma_f32_16x16x32_bf16 v[96:99], v[54:57], a[144:147], v[96:99]
    v_exp_f32 v12, v12
    v_mfma_f32_16x16x32_bf16 v[96:99], v[58:61], a[176:179], v[96:99]
    v_add_f32 v37, v37, v12
    v_mfma_f32_16x16x32_bf16 v[100:103], v[54:57], a[148:151], v[100:103]
    v_exp_f32 v13, v13
    v_mfma_f32_16x16x32_bf16 v[100:103], v[58:61], a[180:183], v[100:103]
    s_waitcnt lgkmcnt(0)
    v_cvt_pk_bf16_f32 v64, v12, v13
    v_add_f32 v37, v37, v13
    v_mfma_f32_16x16x32_bf16 v[104:107], v[54:57], a[152:155], v[104:107]
    v_exp_f32 v14, v14
    v_mfma_f32_16x16x32_bf16 v[104:107], v[58:61], a[184:187], v[104:107]
    v_add_f32 v37, v37, v14
    v_mfma_f32_16x16x32_bf16 v[108:111], v[54:57], a[156:159], v[108:111]
    v_exp_f32 v15, v15
    v_mfma_f32_16x16x32_bf16 v[108:111], v[58:61], a[188:191], v[108:111]
    v_cvt_pk_bf16_f32 v65, v14, v15
    v_add_f32 v37, v37, v15
    v_mfma_f32_16x16x32_bf16 v[112:115], v[54:57], a[160:163], v[112:115]
    v_exp_f32 v78, v78
    v_mfma_f32_16x16x32_bf16 v[112:115], v[58:61], a[192:195], v[112:115]
    v_add_f32 v37, v37, v78
    v_mfma_f32_16x16x32_bf16 v[116:119], v[54:57], a[164:167], v[116:119]
    v_exp_f32 v79, v79
    v_mfma_f32_16x16x32_bf16 v[116:119], v[58:61], a[196:199], v[116:119]
    v_cvt_pk_bf16_f32 v66, v78, v79
    v_add_f32 v37, v37, v79
    v_mfma_f32_16x16x32_bf16 v[120:123], v[54:57], a[168:171], v[120:123]
    v_exp_f32 v80, v80
    v_mfma_f32_16x16x32_bf16 v[120:123], v[58:61], a[200:203], v[120:123]
    v_add_f32 v37, v37, v80
    v_mfma_f32_16x16x32_bf16 v[124:127], v[54:57], a[172:175], v[124:127]
    v_exp_f32 v81, v81
    v_mfma_f32_16x16x32_bf16 v[124:127], v[58:61], a[204:207], v[124:127]
    v_cvt_pk_bf16_f32 v67, v80, v81
    v_add_f32 v37, v37, v81
    v_mfma_f32_16x16x32_bf16 v[8:11], a[80:83], a[32:35], v[24:27]
    v_exp_f32 v82, v82
    v_mfma_f32_16x16x32_bf16 v[8:11], a[84:87], a[36:39], v[8:11]
    v_add_f32 v37, v37, v82
    v_mfma_f32_16x16x32_bf16 v[8:11], a[88:91], a[40:43], v[8:11]
    v_exp_f32 v83, v83
    v_mfma_f32_16x16x32_bf16 v[8:11], a[92:95], a[44:47], v[8:11]
    v_cvt_pk_bf16_f32 v68, v82, v83
    v_add_f32 v37, v37, v83
    v_mfma_f32_16x16x32_bf16 v[12:15], a[108:111], a[44:47], v[24:27]
    v_exp_f32 v84, v84
    v_mfma_f32_16x16x32_bf16 v[12:15], a[104:107], a[40:43], v[12:15]
    v_add_f32 v37, v37, v84
    v_mfma_f32_16x16x32_bf16 v[12:15], a[100:103], a[36:39], v[12:15]
    v_exp_f32 v85, v85
    v_mfma_f32_16x16x32_bf16 v[12:15], a[96:99], a[32:35], v[12:15]
    v_cvt_pk_bf16_f32 v69, v84, v85
    v_add_f32 v37, v37, v85
    v_mfma_f32_16x16x32_bf16 v[78:81], a[112:115], a[32:35], v[24:27]
    v_exp_f32 v8, v8
    v_mfma_f32_16x16x32_bf16 v[78:81], a[116:119], a[36:39], v[78:81]
    v_add_f32 v38, v38, v8
    v_mfma_f32_16x16x32_bf16 v[78:81], a[120:123], a[40:43], v[78:81]
    v_exp_f32 v9, v9
    v_mfma_f32_16x16x32_bf16 v[78:81], a[124:127], a[44:47], v[78:81]
    v_cvt_pk_bf16_f32 v54, v8, v9
    v_add_f32 v38, v38, v9
    v_mfma_f32_16x16x32_bf16 v[82:85], a[140:143], a[44:47], v[24:27]
    v_exp_f32 v10, v10
    v_mfma_f32_16x16x32_bf16 v[82:85], a[136:139], a[40:43], v[82:85]
    v_add_f32 v38, v38, v10
    v_mfma_f32_16x16x32_bf16 v[82:85], a[132:135], a[36:39], v[82:85]
    v_exp_f32 v11, v11
    v_mfma_f32_16x16x32_bf16 v[82:85], a[128:131], a[32:35], v[82:85]
    v_cvt_pk_bf16_f32 v55, v10, v11
    v_add_f32 v38, v38, v11
    v_mfma_f32_16x16x32_bf16 v[128:131], v[62:65], a[144:147], v[128:131]
    v_exp_f32 v12, v12
    v_mfma_f32_16x16x32_bf16 v[128:131], v[66:69], a[176:179], v[128:131]
    v_add_f32 v38, v38, v12
    v_mfma_f32_16x16x32_bf16 v[132:135], v[62:65], a[148:151], v[132:135]
    v_exp_f32 v13, v13
    v_mfma_f32_16x16x32_bf16 v[132:135], v[66:69], a[180:183], v[132:135]
    v_cvt_pk_bf16_f32 v56, v12, v13
    v_add_f32 v38, v38, v13
    v_mfma_f32_16x16x32_bf16 v[136:139], v[62:65], a[152:155], v[136:139]
    v_exp_f32 v14, v14
    v_mfma_f32_16x16x32_bf16 v[136:139], v[66:69], a[184:187], v[136:139]
    v_add_f32 v38, v38, v14
    v_mfma_f32_16x16x32_bf16 v[140:143], v[62:65], a[156:159], v[140:143]
    v_exp_f32 v15, v15
    v_mfma_f32_16x16x32_bf16 v[140:143], v[66:69], a[188:191], v[140:143]
    v_cvt_pk_bf16_f32 v57, v14, v15
    v_add_f32 v38, v38, v15
    v_mfma_f32_16x16x32_bf16 v[144:147], v[62:65], a[160:163], v[144:147]
    v_exp_f32 v78, v78
    v_mfma_f32_16x16x32_bf16 v[144:147], v[66:69], a[192:195], v[144:147]
    v_add_f32 v38, v38, v78
    v_mfma_f32_16x16x32_bf16 v[148:151], v[62:65], a[164:167], v[148:151]
    v_exp_f32 v79, v79
    v_mfma_f32_16x16x32_bf16 v[148:151], v[66:69], a[196:199], v[148:151]
    v_cvt_pk_bf16_f32 v58, v78, v79
    v_add_f32 v38, v38, v79
    v_mfma_f32_16x16x32_bf16 v[152:155], v[62:65], a[168:171], v[152:155]
    v_exp_f32 v80, v80
    v_mfma_f32_16x16x32_bf16 v[152:155], v[66:69], a[200:203], v[152:155]
    v_add_f32 v38, v38, v80
    v_mfma_f32_16x16x32_bf16 v[156:159], v[62:65], a[172:175], v[156:159]
    v_exp_f32 v81, v81
    v_mfma_f32_16x16x32_bf16 v[156:159], v[66:69], a[204:207], v[156:159]
    v_cvt_pk_bf16_f32 v59, v80, v81
    v_add_f32 v38, v38, v81
    v_mfma_f32_16x16x32_bf16 v[8:11], a[80:83], a[48:51], v[28:31]
    v_exp_f32 v82, v82
    v_mfma_f32_16x16x32_bf16 v[8:11], a[84:87], a[52:55], v[8:11]
    v_add_f32 v38, v38, v82
    v_mfma_f32_16x16x32_bf16 v[8:11], a[88:91], a[56:59], v[8:11]
    v_exp_f32 v83, v83
    v_mfma_f32_16x16x32_bf16 v[8:11], a[92:95], a[60:63], v[8:11]
    v_cvt_pk_bf16_f32 v60, v82, v83
    v_add_f32 v38, v38, v83
    v_mfma_f32_16x16x32_bf16 v[12:15], a[108:111], a[60:63], v[28:31]
    v_exp_f32 v84, v84
    v_mfma_f32_16x16x32_bf16 v[12:15], a[104:107], a[56:59], v[12:15]
    v_add_f32 v38, v38, v84
    v_mfma_f32_16x16x32_bf16 v[12:15], a[100:103], a[52:55], v[12:15]
    v_exp_f32 v85, v85
    v_mfma_f32_16x16x32_bf16 v[12:15], a[96:99], a[48:51], v[12:15]
    v_cvt_pk_bf16_f32 v61, v84, v85
    v_add_f32 v38, v38, v85
    v_mfma_f32_16x16x32_bf16 v[78:81], a[112:115], a[48:51], v[28:31]
    v_exp_f32 v8, v8
    v_mfma_f32_16x16x32_bf16 v[78:81], a[116:119], a[52:55], v[78:81]
    s_barrier
    v_add_f32 v39, v39, v8
    v_mfma_f32_16x16x32_bf16 v[78:81], a[120:123], a[56:59], v[78:81]
    v_exp_f32 v9, v9
    v_mfma_f32_16x16x32_bf16 v[78:81], a[124:127], a[60:63], v[78:81]
    v_cvt_pk_bf16_f32 v62, v8, v9
    v_add_f32 v39, v39, v9
    v_mfma_f32_16x16x32_bf16 v[82:85], a[140:143], a[60:63], v[28:31]
    v_exp_f32 v10, v10
    v_mfma_f32_16x16x32_bf16 v[82:85], a[136:139], a[56:59], v[82:85]
    ds_read_b64_tr_b16 a[212:213], v46 offset:49152
    v_add_f32 v39, v39, v10
    v_mfma_f32_16x16x32_bf16 v[82:85], a[132:135], a[52:55], v[82:85]
    v_exp_f32 v11, v11
    v_mfma_f32_16x16x32_bf16 v[82:85], a[128:131], a[48:51], v[82:85]
    v_cvt_pk_bf16_f32 v63, v10, v11
    v_add_f32 v39, v39, v11
    v_mfma_f32_16x16x32_bf16 v[160:163], v[54:57], a[144:147], v[160:163]
    v_exp_f32 v12, v12
    v_mfma_f32_16x16x32_bf16 v[160:163], v[58:61], a[176:179], v[160:163]
    ds_read_b64_tr_b16 a[214:215], v46 offset:53248
    v_add_f32 v39, v39, v12
    v_mfma_f32_16x16x32_bf16 v[164:167], v[54:57], a[148:151], v[164:167]
    v_exp_f32 v13, v13
    v_mfma_f32_16x16x32_bf16 v[164:167], v[58:61], a[180:183], v[164:167]
    v_cvt_pk_bf16_f32 v64, v12, v13
    v_add_f32 v39, v39, v13
    v_mfma_f32_16x16x32_bf16 v[168:171], v[54:57], a[152:155], v[168:171]
    v_exp_f32 v14, v14
    v_mfma_f32_16x16x32_bf16 v[168:171], v[58:61], a[184:187], v[168:171]
    ds_read_b64_tr_b16 a[216:217], v46 offset:57344
    v_add_f32 v39, v39, v14
    v_mfma_f32_16x16x32_bf16 v[172:175], v[54:57], a[156:159], v[172:175]
    v_exp_f32 v15, v15
    v_mfma_f32_16x16x32_bf16 v[172:175], v[58:61], a[188:191], v[172:175]
    v_cvt_pk_bf16_f32 v65, v14, v15
    v_add_f32 v39, v39, v15
    v_mfma_f32_16x16x32_bf16 v[176:179], v[54:57], a[160:163], v[176:179]
    v_exp_f32 v78, v78
    v_mfma_f32_16x16x32_bf16 v[176:179], v[58:61], a[192:195], v[176:179]
    ds_read_b64_tr_b16 a[218:219], v46 offset:61440
    v_add_f32 v39, v39, v78
    v_mfma_f32_16x16x32_bf16 v[180:183], v[54:57], a[164:167], v[180:183]
    v_exp_f32 v79, v79
    v_mfma_f32_16x16x32_bf16 v[180:183], v[58:61], a[196:199], v[180:183]
    v_cvt_pk_bf16_f32 v66, v78, v79
    v_add_f32 v39, v39, v79
    v_mfma_f32_16x16x32_bf16 v[184:187], v[54:57], a[168:171], v[184:187]
    v_exp_f32 v80, v80
    v_mfma_f32_16x16x32_bf16 v[184:187], v[58:61], a[200:203], v[184:187]
    ds_read_b64_tr_b16 a[220:221], v47 offset:49152
    v_add_f32 v39, v39, v80
    v_mfma_f32_16x16x32_bf16 v[188:191], v[54:57], a[172:175], v[188:191]
    v_exp_f32 v81, v81
    v_mfma_f32_16x16x32_bf16 v[188:191], v[58:61], a[204:207], v[188:191]
    v_cvt_pk_bf16_f32 v67, v80, v81
    v_add_f32 v39, v39, v81
    v_mfma_f32_16x16x32_bf16 v[8:11], a[80:83], a[64:67], v[32:35]
    v_exp_f32 v82, v82
    v_mfma_f32_16x16x32_bf16 v[8:11], a[84:87], a[68:71], v[8:11]
    ds_read_b128 a[80:83], v42 offset:49152
    v_add_f32 v39, v39, v82
    v_mfma_f32_16x16x32_bf16 v[8:11], a[88:91], a[72:75], v[8:11]
    v_exp_f32 v83, v83
    v_mfma_f32_16x16x32_bf16 v[8:11], a[92:95], a[76:79], v[8:11]
    v_cvt_pk_bf16_f32 v68, v82, v83
    v_add_f32 v39, v39, v83
    v_mfma_f32_16x16x32_bf16 v[12:15], a[108:111], a[76:79], v[32:35]
    v_exp_f32 v84, v84
    v_mfma_f32_16x16x32_bf16 v[12:15], a[104:107], a[72:75], v[12:15]
    ds_read_b128 a[84:87], v43 offset:49152
    v_add_f32 v39, v39, v84
    v_mfma_f32_16x16x32_bf16 v[12:15], a[100:103], a[68:71], v[12:15]
    v_exp_f32 v85, v85
    v_mfma_f32_16x16x32_bf16 v[12:15], a[96:99], a[64:67], v[12:15]
    v_cvt_pk_bf16_f32 v69, v84, v85
    v_add_f32 v39, v39, v85
    v_mfma_f32_16x16x32_bf16 v[78:81], a[112:115], a[64:67], v[32:35]
    v_exp_f32 v8, v8
    v_mfma_f32_16x16x32_bf16 v[78:81], a[116:119], a[68:71], v[78:81]
    ds_read_b128 a[88:91], v44 offset:49152
    ds_read_b128 a[92:95], v45 offset:49152
    v_mfma_f32_16x16x32_bf16 v[78:81], a[120:123], a[72:75], v[78:81]
    v_exp_f32 v9, v9
    v_mfma_f32_16x16x32_bf16 v[78:81], a[124:127], a[76:79], v[78:81]
    ds_read_b128 a[108:111], v45 offset:53248
    v_cvt_pk_bf16_f32 v54, v8, v9
    v_mfma_f32_16x16x32_bf16 v[82:85], a[140:143], a[76:79], v[32:35]
    v_exp_f32 v10, v10
    v_mfma_f32_16x16x32_bf16 v[82:85], a[136:139], a[72:75], v[82:85]
    ds_read_b128 a[104:107], v44 offset:53248
    ds_read_b128 a[100:103], v43 offset:53248
    v_mfma_f32_16x16x32_bf16 v[82:85], a[132:135], a[68:71], v[82:85]
    v_exp_f32 v11, v11
    v_mfma_f32_16x16x32_bf16 v[82:85], a[128:131], a[64:67], v[82:85]
    ds_read_b128 a[96:99], v42 offset:53248
    v_cvt_pk_bf16_f32 v55, v10, v11
    v_mfma_f32_16x16x32_bf16 v[192:195], v[62:65], a[144:147], v[192:195]
    v_exp_f32 v12, v12
    v_mfma_f32_16x16x32_bf16 v[192:195], v[66:69], a[176:179], v[192:195]
    ds_read_b128 a[112:115], v42 offset:57344
    ds_read_b128 a[116:119], v43 offset:57344
    v_mfma_f32_16x16x32_bf16 v[196:199], v[62:65], a[148:151], v[196:199]
    v_exp_f32 v13, v13
    v_mfma_f32_16x16x32_bf16 v[196:199], v[66:69], a[180:183], v[196:199]
    ds_read_b128 a[120:123], v44 offset:57344
    v_cvt_pk_bf16_f32 v56, v12, v13
    v_mfma_f32_16x16x32_bf16 v[200:203], v[62:65], a[152:155], v[200:203]
    v_exp_f32 v14, v14
    v_mfma_f32_16x16x32_bf16 v[200:203], v[66:69], a[184:187], v[200:203]
    ds_read_b128 a[124:127], v45 offset:57344
    ds_read_b128 a[140:143], v45 offset:61440
    v_mfma_f32_16x16x32_bf16 v[204:207], v[62:65], a[156:159], v[204:207]
    v_exp_f32 v15, v15
    v_mfma_f32_16x16x32_bf16 v[204:207], v[66:69], a[188:191], v[204:207]
    ds_read_b128 a[136:139], v44 offset:61440
    v_cvt_pk_bf16_f32 v57, v14, v15
    v_mfma_f32_16x16x32_bf16 v[208:211], v[62:65], a[160:163], v[208:211]
    v_exp_f32 v78, v78
    v_mfma_f32_16x16x32_bf16 v[208:211], v[66:69], a[192:195], v[208:211]
    ds_read_b128 a[132:135], v43 offset:61440
    ds_read_b128 a[128:131], v42 offset:61440
    v_mfma_f32_16x16x32_bf16 v[212:215], v[62:65], a[164:167], v[212:215]
    v_exp_f32 v79, v79
    v_mfma_f32_16x16x32_bf16 v[212:215], v[66:69], a[196:199], v[212:215]
    ds_read_b64_tr_b16 a[222:223], v47 offset:53248
    v_cvt_pk_bf16_f32 v58, v78, v79
    v_mfma_f32_16x16x32_bf16 v[216:219], v[62:65], a[168:171], v[216:219]
    v_exp_f32 v80, v80
    v_mfma_f32_16x16x32_bf16 v[216:219], v[66:69], a[200:203], v[216:219]
    s_sub_u32 s29, s29, 1
    ds_read_b64_tr_b16 a[224:225], v47 offset:57344
    ds_read_b64_tr_b16 a[226:227], v47 offset:61440
    v_mfma_f32_16x16x32_bf16 v[220:223], v[62:65], a[172:175], v[220:223]
    s_cmp_eq_u32 s29, 0
    v_exp_f32 v81, v81
    v_mfma_f32_16x16x32_bf16 v[220:223], v[66:69], a[204:207], v[220:223]
    s_waitcnt lgkmcnt(8)
    ds_read_b64_tr_b16 a[228:229], v50 offset:49152
    v_cvt_pk_bf16_f32 v59, v80, v81
    s_cbranch_scc1 L_exit_w5
    v_mfma_f32_16x16x32_bf16 v[8:11], a[80:83], a[0:3], v[16:19]
    v_exp_f32 v82, v82
    v_mfma_f32_16x16x32_bf16 v[8:11], a[84:87], a[4:7], v[8:11]
    ds_read_b64_tr_b16 a[230:231], v50 offset:53248
    ds_read_b64_tr_b16 a[232:233], v50 offset:57344
    v_mfma_f32_16x16x32_bf16 v[8:11], a[88:91], a[8:11], v[8:11]
    v_exp_f32 v83, v83
    v_mfma_f32_16x16x32_bf16 v[8:11], a[92:95], a[12:15], v[8:11]
    ds_read_b64_tr_b16 a[234:235], v50 offset:61440
    v_cvt_pk_bf16_f32 v60, v82, v83
    v_mfma_f32_16x16x32_bf16 v[12:15], a[108:111], a[12:15], v[16:19]
    v_exp_f32 v84, v84
    v_mfma_f32_16x16x32_bf16 v[12:15], a[104:107], a[8:11], v[12:15]
    ds_read_b64_tr_b16 a[236:237], v51 offset:49152
    ds_read_b64_tr_b16 a[238:239], v51 offset:53248
    v_mfma_f32_16x16x32_bf16 v[12:15], a[100:103], a[4:7], v[12:15]
    v_exp_f32 v85, v85
    v_mfma_f32_16x16x32_bf16 v[12:15], a[96:99], a[0:3], v[12:15]
    ds_read_b64_tr_b16 a[240:241], v51 offset:57344
    v_cvt_pk_bf16_f32 v61, v84, v85
    v_mfma_f32_16x16x32_bf16 v[78:81], a[112:115], a[0:3], v[16:19]
    v_exp_f32 v8, v8
    v_mfma_f32_16x16x32_bf16 v[78:81], a[116:119], a[4:7], v[78:81]
    ds_read_b64_tr_b16 a[242:243], v51 offset:61440
    v_mfma_f32_16x16x32_bf16 v[78:81], a[120:123], a[8:11], v[78:81]
    s_waitcnt lgkmcnt(7)
    v_exp_f32 v9, v9
    v_mfma_f32_16x16x32_bf16 v[78:81], a[124:127], a[12:15], v[78:81]
    v_cvt_pk_bf16_f32 v62, v8, v9
    v_mfma_f32_16x16x32_bf16 v[82:85], a[140:143], a[12:15], v[16:19]
    v_exp_f32 v10, v10
    v_mfma_f32_16x16x32_bf16 v[82:85], a[136:139], a[8:11], v[82:85]
    v_mfma_f32_16x16x32_bf16 v[82:85], a[132:135], a[4:7], v[82:85]
    v_exp_f32 v11, v11
    v_mfma_f32_16x16x32_bf16 v[82:85], a[128:131], a[0:3], v[82:85]
    v_cvt_pk_bf16_f32 v63, v10, v11
    v_smfmac_f32_16x16x64_bf16 a[252:255], a[208:211], v[54:61], v41
    v_mfma_f32_16x16x32_bf16 v[224:227], v[54:57], a[144:147], v[224:227]
    v_exp_f32 v12, v12
    v_mfma_f32_16x16x32_bf16 v[224:227], v[58:61], a[176:179], v[224:227]
    v_mfma_f32_16x16x32_bf16 v[228:231], v[54:57], a[148:151], v[228:231]
    v_exp_f32 v13, v13
    v_mfma_f32_16x16x32_bf16 v[228:231], v[58:61], a[180:183], v[228:231]
    v_cvt_pk_bf16_f32 v64, v12, v13
    v_mfma_f32_16x16x32_bf16 v[232:235], v[54:57], a[152:155], v[232:235]
    v_exp_f32 v14, v14
    v_mfma_f32_16x16x32_bf16 v[232:235], v[58:61], a[184:187], v[232:235]
    ds_read_b64_tr_b16 a[152:153], v48 offset:49152
    ds_read_b64_tr_b16 a[154:155], v48 offset:53248
    v_mfma_f32_16x16x32_bf16 v[236:239], v[54:57], a[156:159], v[236:239]
    v_exp_f32 v15, v15
    v_mfma_f32_16x16x32_bf16 v[236:239], v[58:61], a[188:191], v[236:239]
    ds_read_b64_tr_b16 a[184:185], v48 offset:57344
    v_cvt_pk_bf16_f32 v65, v14, v15
    v_mfma_f32_16x16x32_bf16 v[240:243], v[54:57], a[160:163], v[240:243]
    v_exp_f32 v78, v78
    v_mfma_f32_16x16x32_bf16 v[240:243], v[58:61], a[192:195], v[240:243]
    ds_read_b64_tr_b16 a[186:187], v48 offset:61440
    ds_read_b64_tr_b16 a[156:157], v49 offset:49152
    v_mfma_f32_16x16x32_bf16 v[244:247], v[54:57], a[164:167], v[244:247]
    v_exp_f32 v79, v79
    v_mfma_f32_16x16x32_bf16 v[244:247], v[58:61], a[196:199], v[244:247]
    ds_read_b64_tr_b16 a[158:159], v49 offset:53248
    v_cvt_pk_bf16_f32 v66, v78, v79
    v_mfma_f32_16x16x32_bf16 v[248:251], v[54:57], a[168:171], v[248:251]
    v_exp_f32 v80, v80
    v_mfma_f32_16x16x32_bf16 v[248:251], v[58:61], a[200:203], v[248:251]
    ds_read_b64_tr_b16 a[188:189], v49 offset:57344
    ds_read_b64_tr_b16 a[190:191], v49 offset:61440
    v_mfma_f32_16x16x32_bf16 v[252:255], v[54:57], a[172:175], v[252:255]
    v_exp_f32 v81, v81
    v_mfma_f32_16x16x32_bf16 v[252:255], v[58:61], a[204:207], v[252:255]
    ds_read_b64_tr_b16 a[168:169], v52 offset:49152
    v_cvt_pk_bf16_f32 v67, v80, v81
    v_mfma_f32_16x16x32_bf16 v[8:11], a[80:83], a[16:19], v[20:23]
    v_exp_f32 v82, v82
    v_mfma_f32_16x16x32_bf16 v[8:11], a[84:87], a[20:23], v[8:11]
    ds_read_b64_tr_b16 a[170:171], v52 offset:53248
    ds_read_b64_tr_b16 a[200:201], v52 offset:57344
    v_mfma_f32_16x16x32_bf16 v[8:11], a[88:91], a[24:27], v[8:11]
    v_exp_f32 v83, v83
    v_mfma_f32_16x16x32_bf16 v[8:11], a[92:95], a[28:31], v[8:11]
    ds_read_b64_tr_b16 a[202:203], v52 offset:61440
    v_cvt_pk_bf16_f32 v68, v82, v83
    v_mfma_f32_16x16x32_bf16 v[12:15], a[108:111], a[28:31], v[20:23]
    v_exp_f32 v84, v84
    v_mfma_f32_16x16x32_bf16 v[12:15], a[104:107], a[24:27], v[12:15]
    ds_read_b64_tr_b16 a[172:173], v53 offset:49152
    ds_read_b64_tr_b16 a[174:175], v53 offset:53248
    v_mfma_f32_16x16x32_bf16 v[12:15], a[100:103], a[20:23], v[12:15]
    v_exp_f32 v85, v85
    v_mfma_f32_16x16x32_bf16 v[12:15], a[96:99], a[16:19], v[12:15]
    ds_read_b64_tr_b16 a[204:205], v53 offset:57344
    v_cvt_pk_bf16_f32 v69, v84, v85
    v_mfma_f32_16x16x32_bf16 v[78:81], a[112:115], a[16:19], v[20:23]
    v_exp_f32 v8, v8
    v_mfma_f32_16x16x32_bf16 v[78:81], a[116:119], a[20:23], v[78:81]
    ds_read_b64_tr_b16 a[206:207], v53 offset:61440
    v_add_f32 v37, v37, v8
    v_mfma_f32_16x16x32_bf16 v[78:81], a[120:123], a[24:27], v[78:81]
    v_exp_f32 v9, v9
    v_mfma_f32_16x16x32_bf16 v[78:81], a[124:127], a[28:31], v[78:81]
    v_cvt_pk_bf16_f32 v54, v8, v9
    v_add_f32 v37, v37, v9
    v_mfma_f32_16x16x32_bf16 v[82:85], a[140:143], a[28:31], v[20:23]
    v_exp_f32 v10, v10
    v_mfma_f32_16x16x32_bf16 v[82:85], a[136:139], a[24:27], v[82:85]
    v_add_f32 v37, v37, v10
    v_mfma_f32_16x16x32_bf16 v[82:85], a[132:135], a[20:23], v[82:85]
    v_exp_f32 v11, v11
    v_mfma_f32_16x16x32_bf16 v[82:85], a[128:131], a[16:19], v[82:85]
    v_cvt_pk_bf16_f32 v55, v10, v11
    v_add_f32 v37, v37, v11
    v_smfmac_f32_16x16x64_bf16 a[248:251], a[208:211], v[62:69], v41
    v_mfma_f32_16x16x32_bf16 v[96:99], v[62:65], a[212:215], v[96:99]
    v_exp_f32 v12, v12
    v_mfma_f32_16x16x32_bf16 v[96:99], v[66:69], a[216:219], v[96:99]
    v_add_f32 v37, v37, v12
    v_mfma_f32_16x16x32_bf16 v[100:103], v[62:65], a[220:223], v[100:103]
    v_exp_f32 v13, v13
    v_mfma_f32_16x16x32_bf16 v[100:103], v[66:69], a[224:227], v[100:103]
    s_waitcnt lgkmcnt(0)
    v_cvt_pk_bf16_f32 v56, v12, v13
    v_add_f32 v37, v37, v13
    v_mfma_f32_16x16x32_bf16 v[104:107], v[62:65], a[152:155], v[104:107]
    v_exp_f32 v14, v14
    v_mfma_f32_16x16x32_bf16 v[104:107], v[66:69], a[184:187], v[104:107]
    v_add_f32 v37, v37, v14
    v_mfma_f32_16x16x32_bf16 v[108:111], v[62:65], a[156:159], v[108:111]
    v_exp_f32 v15, v15
    v_mfma_f32_16x16x32_bf16 v[108:111], v[66:69], a[188:191], v[108:111]
    v_cvt_pk_bf16_f32 v57, v14, v15
    v_add_f32 v37, v37, v15
    v_mfma_f32_16x16x32_bf16 v[112:115], v[62:65], a[228:231], v[112:115]
    v_exp_f32 v78, v78
    v_mfma_f32_16x16x32_bf16 v[112:115], v[66:69], a[232:235], v[112:115]
    v_add_f32 v37, v37, v78
    v_mfma_f32_16x16x32_bf16 v[116:119], v[62:65], a[236:239], v[116:119]
    v_exp_f32 v79, v79
    v_mfma_f32_16x16x32_bf16 v[116:119], v[66:69], a[240:243], v[116:119]
    v_cvt_pk_bf16_f32 v58, v78, v79
    v_add_f32 v37, v37, v79
    v_mfma_f32_16x16x32_bf16 v[120:123], v[62:65], a[168:171], v[120:123]
    v_exp_f32 v80, v80
    v_mfma_f32_16x16x32_bf16 v[120:123], v[66:69], a[200:203], v[120:123]
    v_add_f32 v37, v37, v80
    v_mfma_f32_16x16x32_bf16 v[124:127], v[62:65], a[172:175], v[124:127]
    v_exp_f32 v81, v81
    v_mfma_f32_16x16x32_bf16 v[124:127], v[66:69], a[204:207], v[124:127]
    v_cvt_pk_bf16_f32 v59, v80, v81
    v_add_f32 v37, v37, v81
    v_mfma_f32_16x16x32_bf16 v[8:11], a[80:83], a[32:35], v[24:27]
    v_exp_f32 v82, v82
    v_mfma_f32_16x16x32_bf16 v[8:11], a[84:87], a[36:39], v[8:11]
    v_add_f32 v37, v37, v82
    v_mfma_f32_16x16x32_bf16 v[8:11], a[88:91], a[40:43], v[8:11]
    v_exp_f32 v83, v83
    v_mfma_f32_16x16x32_bf16 v[8:11], a[92:95], a[44:47], v[8:11]
    v_cvt_pk_bf16_f32 v60, v82, v83
    v_add_f32 v37, v37, v83
    v_mfma_f32_16x16x32_bf16 v[12:15], a[108:111], a[44:47], v[24:27]
    v_exp_f32 v84, v84
    v_mfma_f32_16x16x32_bf16 v[12:15], a[104:107], a[40:43], v[12:15]
    v_add_f32 v37, v37, v84
    v_mfma_f32_16x16x32_bf16 v[12:15], a[100:103], a[36:39], v[12:15]
    v_exp_f32 v85, v85
    v_mfma_f32_16x16x32_bf16 v[12:15], a[96:99], a[32:35], v[12:15]
    v_cvt_pk_bf16_f32 v61, v84, v85
    v_add_f32 v37, v37, v85
    v_mfma_f32_16x16x32_bf16 v[78:81], a[112:115], a[32:35], v[24:27]
    v_exp_f32 v8, v8
    v_mfma_f32_16x16x32_bf16 v[78:81], a[116:119], a[36:39], v[78:81]
    v_add_f32 v38, v38, v8
    v_mfma_f32_16x16x32_bf16 v[78:81], a[120:123], a[40:43], v[78:81]
    v_exp_f32 v9, v9
    v_mfma_f32_16x16x32_bf16 v[78:81], a[124:127], a[44:47], v[78:81]
    v_cvt_pk_bf16_f32 v62, v8, v9
    v_add_f32 v38, v38, v9
    v_mfma_f32_16x16x32_bf16 v[82:85], a[140:143], a[44:47], v[24:27]
    v_exp_f32 v10, v10
    v_mfma_f32_16x16x32_bf16 v[82:85], a[136:139], a[40:43], v[82:85]
    v_add_f32 v38, v38, v10
    v_mfma_f32_16x16x32_bf16 v[82:85], a[132:135], a[36:39], v[82:85]
    v_exp_f32 v11, v11
    v_mfma_f32_16x16x32_bf16 v[82:85], a[128:131], a[32:35], v[82:85]
    v_cvt_pk_bf16_f32 v63, v10, v11
    v_add_f32 v38, v38, v11
    v_mfma_f32_16x16x32_bf16 v[128:131], v[54:57], a[212:215], v[128:131]
    v_exp_f32 v12, v12
    v_mfma_f32_16x16x32_bf16 v[128:131], v[58:61], a[216:219], v[128:131]
    v_add_f32 v38, v38, v12
    v_mfma_f32_16x16x32_bf16 v[132:135], v[54:57], a[220:223], v[132:135]
    v_exp_f32 v13, v13
    v_mfma_f32_16x16x32_bf16 v[132:135], v[58:61], a[224:227], v[132:135]
    v_cvt_pk_bf16_f32 v64, v12, v13
    v_add_f32 v38, v38, v13
    v_mfma_f32_16x16x32_bf16 v[136:139], v[54:57], a[152:155], v[136:139]
    v_exp_f32 v14, v14
    v_mfma_f32_16x16x32_bf16 v[136:139], v[58:61], a[184:187], v[136:139]
    v_add_f32 v38, v38, v14
    v_mfma_f32_16x16x32_bf16 v[140:143], v[54:57], a[156:159], v[140:143]
    v_exp_f32 v15, v15
    v_mfma_f32_16x16x32_bf16 v[140:143], v[58:61], a[188:191], v[140:143]
    v_cvt_pk_bf16_f32 v65, v14, v15
    v_add_f32 v38, v38, v15
    v_mfma_f32_16x16x32_bf16 v[144:147], v[54:57], a[228:231], v[144:147]
    v_exp_f32 v78, v78
    v_mfma_f32_16x16x32_bf16 v[144:147], v[58:61], a[232:235], v[144:147]
    v_add_f32 v38, v38, v78
    v_mfma_f32_16x16x32_bf16 v[148:151], v[54:57], a[236:239], v[148:151]
    v_exp_f32 v79, v79
    v_mfma_f32_16x16x32_bf16 v[148:151], v[58:61], a[240:243], v[148:151]
    v_cvt_pk_bf16_f32 v66, v78, v79
    v_add_f32 v38, v38, v79
    v_mfma_f32_16x16x32_bf16 v[152:155], v[54:57], a[168:171], v[152:155]
    v_exp_f32 v80, v80
    v_mfma_f32_16x16x32_bf16 v[152:155], v[58:61], a[200:203], v[152:155]
    v_add_f32 v38, v38, v80
    v_mfma_f32_16x16x32_bf16 v[156:159], v[54:57], a[172:175], v[156:159]
    v_exp_f32 v81, v81
    v_mfma_f32_16x16x32_bf16 v[156:159], v[58:61], a[204:207], v[156:159]
    v_cvt_pk_bf16_f32 v67, v80, v81
    v_add_f32 v38, v38, v81
    v_mfma_f32_16x16x32_bf16 v[8:11], a[80:83], a[48:51], v[28:31]
    v_exp_f32 v82, v82
    v_mfma_f32_16x16x32_bf16 v[8:11], a[84:87], a[52:55], v[8:11]
    v_add_f32 v38, v38, v82
    v_mfma_f32_16x16x32_bf16 v[8:11], a[88:91], a[56:59], v[8:11]
    v_exp_f32 v83, v83
    v_mfma_f32_16x16x32_bf16 v[8:11], a[92:95], a[60:63], v[8:11]
    v_cvt_pk_bf16_f32 v68, v82, v83
    v_add_f32 v38, v38, v83
    v_mfma_f32_16x16x32_bf16 v[12:15], a[108:111], a[60:63], v[28:31]
    v_exp_f32 v84, v84
    v_mfma_f32_16x16x32_bf16 v[12:15], a[104:107], a[56:59], v[12:15]
    v_add_f32 v38, v38, v84
    v_mfma_f32_16x16x32_bf16 v[12:15], a[100:103], a[52:55], v[12:15]
    v_exp_f32 v85, v85
    v_mfma_f32_16x16x32_bf16 v[12:15], a[96:99], a[48:51], v[12:15]
    v_cvt_pk_bf16_f32 v69, v84, v85
    v_add_f32 v38, v38, v85
    v_mfma_f32_16x16x32_bf16 v[78:81], a[112:115], a[48:51], v[28:31]
    v_exp_f32 v8, v8
    v_mfma_f32_16x16x32_bf16 v[78:81], a[116:119], a[52:55], v[78:81]
    s_barrier
    v_add_f32 v39, v39, v8
    v_mfma_f32_16x16x32_bf16 v[78:81], a[120:123], a[56:59], v[78:81]
    v_exp_f32 v9, v9
    v_mfma_f32_16x16x32_bf16 v[78:81], a[124:127], a[60:63], v[78:81]
    v_cvt_pk_bf16_f32 v54, v8, v9
    v_add_f32 v39, v39, v9
    v_mfma_f32_16x16x32_bf16 v[82:85], a[140:143], a[60:63], v[28:31]
    v_exp_f32 v10, v10
    v_mfma_f32_16x16x32_bf16 v[82:85], a[136:139], a[56:59], v[82:85]
    ds_read_b64_tr_b16 a[144:145], v46 offset:0
    v_add_f32 v39, v39, v10
    v_mfma_f32_16x16x32_bf16 v[82:85], a[132:135], a[52:55], v[82:85]
    v_exp_f32 v11, v11
    v_mfma_f32_16x16x32_bf16 v[82:85], a[128:131], a[48:51], v[82:85]
    v_cvt_pk_bf16_f32 v55, v10, v11
    v_add_f32 v39, v39, v11
    v_mfma_f32_16x16x32_bf16 v[160:163], v[62:65], a[212:215], v[160:163]
    v_exp_f32 v12, v12
    v_mfma_f32_16x16x32_bf16 v[160:163], v[66:69], a[216:219], v[160:163]
    ds_read_b64_tr_b16 a[146:147], v46 offset:4096
    v_add_f32 v39, v39, v12
    v_mfma_f32_16x16x32_bf16 v[164:167], v[62:65], a[220:223], v[164:167]
    v_exp_f32 v13, v13
    v_mfma_f32_16x16x32_bf16 v[164:167], v[66:69], a[224:227], v[164:167]
    v_cvt_pk_bf16_f32 v56, v12, v13
    v_add_f32 v39, v39, v13
    v_mfma_f32_16x16x32_bf16 v[168:171], v[62:65], a[152:155], v[168:171]
    v_exp_f32 v14, v14
    v_mfma_f32_16x16x32_bf16 v[168:171], v[66:69], a[184:187], v[168:171]
    ds_read_b64_tr_b16 a[176:177], v46 offset:8192
    v_add_f32 v39, v39, v14
    v_mfma_f32_16x16x32_bf16 v[172:175], v[62:65], a[156:159], v[172:175]
    v_exp_f32 v15, v15
    v_mfma_f32_16x16x32_bf16 v[172:175], v[66:69], a[188:191], v[172:175]
    v_cvt_pk_bf16_f32 v57, v14, v15
    v_add_f32 v39, v39, v15
    v_mfma_f32_16x16x32_bf16 v[176:179], v[62:65], a[228:231], v[176:179]
    v_exp_f32 v78, v78
    v_mfma_f32_16x16x32_bf16 v[176:179], v[66:69], a[232:235], v[176:179]
    ds_read_b64_tr_b16 a[178:179], v46 offset:12288
    v_add_f32 v39, v39, v78
    v_mfma_f32_16x16x32_bf16 v[180:183], v[62:65], a[236:239], v[180:183]
    v_exp_f32 v79, v79
    v_mfma_f32_16x16x32_bf16 v[180:183], v[66:69], a[240:243], v[180:183]
    v_cvt_pk_bf16_f32 v58, v78, v79
    v_add_f32 v39, v39, v79
    v_mfma_f32_16x16x32_bf16 v[184:187], v[62:65], a[168:171], v[184:187]
    v_exp_f32 v80, v80
    v_mfma_f32_16x16x32_bf16 v[184:187], v[66:69], a[200:203], v[184:187]
    ds_read_b64_tr_b16 a[148:149], v47 offset:0
    v_add_f32 v39, v39, v80
    v_mfma_f32_16x16x32_bf16 v[188:191], v[62:65], a[172:175], v[188:191]
    v_exp_f32 v81, v81
    v_mfma_f32_16x16x32_bf16 v[188:191], v[66:69], a[204:207], v[188:191]
    v_cvt_pk_bf16_f32 v59, v80, v81
    v_add_f32 v39, v39, v81
    v_mfma_f32_16x16x32_bf16 v[8:11], a[80:83], a[64:67], v[32:35]
    v_exp_f32 v82, v82
    v_mfma_f32_16x16x32_bf16 v[8:11], a[84:87], a[68:71], v[8:11]
    ds_read_b128 a[80:83], v42 offset:0
    v_add_f32 v39, v39, v82
    v_mfma_f32_16x16x32_bf16 v[8:11], a[88:91], a[72:75], v[8:11]
    v_exp_f32 v83, v83
    v_mfma_f32_16x16x32_bf16 v[8:11], a[92:95], a[76:79], v[8:11]
    v_cvt_pk_bf16_f32 v60, v82, v83
    v_add_f32 v39, v39, v83
    v_mfma_f32_16x16x32_bf16 v[12:15], a[108:111], a[76:79], v[32:35]
    v_exp_f32 v84, v84
    v_mfma_f32_16x16x32_bf16 v[12:15], a[104:107], a[72:75], v[12:15]
    ds_read_b128 a[84:87], v43 offset:0
    v_add_f32 v39, v39, v84
    v_mfma_f32_16x16x32_bf16 v[12:15], a[100:103], a[68:71], v[12:15]
    v_exp_f32 v85, v85
    v_mfma_f32_16x16x32_bf16 v[12:15], a[96:99], a[64:67], v[12:15]
    v_cvt_pk_bf16_f32 v61, v84, v85
    v_add_f32 v39, v39, v85
    v_mfma_f32_16x16x32_bf16 v[78:81], a[112:115], a[64:67], v[32:35]
    v_exp_f32 v8, v8
    v_mfma_f32_16x16x32_bf16 v[78:81], a[116:119], a[68:71], v[78:81]
    ds_read_b128 a[88:91], v44 offset:0
    ds_read_b128 a[92:95], v45 offset:0
    v_mfma_f32_16x16x32_bf16 v[78:81], a[120:123], a[72:75], v[78:81]
    v_exp_f32 v9, v9
    v_mfma_f32_16x16x32_bf16 v[78:81], a[124:127], a[76:79], v[78:81]
    ds_read_b128 a[108:111], v45 offset:4096
    v_cvt_pk_bf16_f32 v62, v8, v9
    v_mfma_f32_16x16x32_bf16 v[82:85], a[140:143], a[76:79], v[32:35]
    v_exp_f32 v10, v10
    v_mfma_f32_16x16x32_bf16 v[82:85], a[136:139], a[72:75], v[82:85]
    ds_read_b128 a[104:107], v44 offset:4096
    ds_read_b128 a[100:103], v43 offset:4096
    v_mfma_f32_16x16x32_bf16 v[82:85], a[132:135], a[68:71], v[82:85]
    v_exp_f32 v11, v11
    v_mfma_f32_16x16x32_bf16 v[82:85], a[128:131], a[64:67], v[82:85]
    ds_read_b128 a[96:99], v42 offset:4096
    v_cvt_pk_bf16_f32 v63, v10, v11
    v_mfma_f32_16x16x32_bf16 v[192:195], v[54:57], a[212:215], v[192:195]
    v_exp_f32 v12, v12
    v_mfma_f32_16x16x32_bf16 v[192:195], v[58:61], a[216:219], v[192:195]
    ds_read_b128 a[112:115], v42 offset:8192
    ds_read_b128 a[116:119], v43 offset:8192
    v_mfma_f32_16x16x32_bf16 v[196:199], v[54:57], a[220:223], v[196:199]
    v_exp_f32 v13, v13
    v_mfma_f32_16x16x32_bf16 v[196:199], v[58:61], a[224:227], v[196:199]
    ds_read_b128 a[120:123], v44 offset:8192
    v_cvt_pk_bf16_f32 v64, v12, v13
    v_mfma_f32_16x16x32_bf16 v[200:203], v[54:57], a[152:155], v[200:203]
    v_exp_f32 v14, v14
    v_mfma_f32_16x16x32_bf16 v[200:203], v[58:61], a[184:187], v[200:203]
    ds_read_b128 a[124:127], v45 offset:8192
    ds_read_b128 a[140:143], v45 offset:12288
    v_mfma_f32_16x16x32_bf16 v[204:207], v[54:57], a[156:159], v[204:207]
    v_exp_f32 v15, v15
    v_mfma_f32_16x16x32_bf16 v[204:207], v[58:61], a[188:191], v[204:207]
    ds_read_b128 a[136:139], v44 offset:12288
    v_cvt_pk_bf16_f32 v65, v14, v15
    v_mfma_f32_16x16x32_bf16 v[208:211], v[54:57], a[228:231], v[208:211]
    v_exp_f32 v78, v78
    v_mfma_f32_16x16x32_bf16 v[208:211], v[58:61], a[232:235], v[208:211]
    ds_read_b128 a[132:135], v43 offset:12288
    ds_read_b128 a[128:131], v42 offset:12288
    v_mfma_f32_16x16x32_bf16 v[212:215], v[54:57], a[236:239], v[212:215]
    v_exp_f32 v79, v79
    v_mfma_f32_16x16x32_bf16 v[212:215], v[58:61], a[240:243], v[212:215]
    ds_read_b64_tr_b16 a[150:151], v47 offset:4096
    v_cvt_pk_bf16_f32 v66, v78, v79
    v_mfma_f32_16x16x32_bf16 v[216:219], v[54:57], a[168:171], v[216:219]
    v_exp_f32 v80, v80
    v_mfma_f32_16x16x32_bf16 v[216:219], v[58:61], a[200:203], v[216:219]
    ds_read_b64_tr_b16 a[180:181], v47 offset:8192
    ds_read_b64_tr_b16 a[182:183], v47 offset:12288
    v_mfma_f32_16x16x32_bf16 v[220:223], v[54:57], a[172:175], v[220:223]
    v_exp_f32 v81, v81
    v_mfma_f32_16x16x32_bf16 v[220:223], v[58:61], a[204:207], v[220:223]
    s_waitcnt lgkmcnt(8)
    ds_read_b64_tr_b16 a[160:161], v50 offset:0
    v_cvt_pk_bf16_f32 v67, v80, v81
    s_branch L_loop_w5
L_exit_w5:
    s_waitcnt lgkmcnt(0)
    v_mfma_f32_16x16x32_bf16 v[8:11], a[80:83], a[0:3], v[16:19]
    v_exp_f32 v82, v82
    v_mfma_f32_16x16x32_bf16 v[8:11], a[84:87], a[4:7], v[8:11]
    ds_read_b64_tr_b16 a[230:231], v50 offset:53248
    ds_read_b64_tr_b16 a[232:233], v50 offset:57344
    v_mfma_f32_16x16x32_bf16 v[8:11], a[88:91], a[8:11], v[8:11]
    v_exp_f32 v83, v83
    v_mfma_f32_16x16x32_bf16 v[8:11], a[92:95], a[12:15], v[8:11]
    ds_read_b64_tr_b16 a[234:235], v50 offset:61440
    v_cvt_pk_bf16_f32 v60, v82, v83
    v_mfma_f32_16x16x32_bf16 v[12:15], a[108:111], a[12:15], v[16:19]
    v_exp_f32 v84, v84
    v_mfma_f32_16x16x32_bf16 v[12:15], a[104:107], a[8:11], v[12:15]
    ds_read_b64_tr_b16 a[236:237], v51 offset:49152
    ds_read_b64_tr_b16 a[238:239], v51 offset:53248
    v_mfma_f32_16x16x32_bf16 v[12:15], a[100:103], a[4:7], v[12:15]
    v_exp_f32 v85, v85
    v_mfma_f32_16x16x32_bf16 v[12:15], a[96:99], a[0:3], v[12:15]
    ds_read_b64_tr_b16 a[240:241], v51 offset:57344
    v_cvt_pk_bf16_f32 v61, v84, v85
    v_mfma_f32_16x16x32_bf16 v[78:81], a[112:115], a[0:3], v[16:19]
    v_exp_f32 v8, v8
    v_mfma_f32_16x16x32_bf16 v[78:81], a[116:119], a[4:7], v[78:81]
    ds_read_b64_tr_b16 a[242:243], v51 offset:61440
    v_mfma_f32_16x16x32_bf16 v[78:81], a[120:123], a[8:11], v[78:81]
    v_exp_f32 v9, v9
    v_mfma_f32_16x16x32_bf16 v[78:81], a[124:127], a[12:15], v[78:81]
    v_cvt_pk_bf16_f32 v62, v8, v9
    v_mfma_f32_16x16x32_bf16 v[82:85], a[140:143], a[12:15], v[16:19]
    v_exp_f32 v10, v10
    v_mfma_f32_16x16x32_bf16 v[82:85], a[136:139], a[8:11], v[82:85]
    v_mfma_f32_16x16x32_bf16 v[82:85], a[132:135], a[4:7], v[82:85]
    v_exp_f32 v11, v11
    v_mfma_f32_16x16x32_bf16 v[82:85], a[128:131], a[0:3], v[82:85]
    v_cvt_pk_bf16_f32 v63, v10, v11
    v_smfmac_f32_16x16x64_bf16 a[252:255], a[208:211], v[54:61], v41
    v_mfma_f32_16x16x32_bf16 v[224:227], v[54:57], a[144:147], v[224:227]
    v_exp_f32 v12, v12
    v_mfma_f32_16x16x32_bf16 v[224:227], v[58:61], a[176:179], v[224:227]
    v_mfma_f32_16x16x32_bf16 v[228:231], v[54:57], a[148:151], v[228:231]
    v_exp_f32 v13, v13
    v_mfma_f32_16x16x32_bf16 v[228:231], v[58:61], a[180:183], v[228:231]
    v_cvt_pk_bf16_f32 v64, v12, v13
    v_mfma_f32_16x16x32_bf16 v[232:235], v[54:57], a[152:155], v[232:235]
    v_exp_f32 v14, v14
    v_mfma_f32_16x16x32_bf16 v[232:235], v[58:61], a[184:187], v[232:235]
    ds_read_b64_tr_b16 a[152:153], v48 offset:49152
    ds_read_b64_tr_b16 a[154:155], v48 offset:53248
    v_mfma_f32_16x16x32_bf16 v[236:239], v[54:57], a[156:159], v[236:239]
    v_exp_f32 v15, v15
    v_mfma_f32_16x16x32_bf16 v[236:239], v[58:61], a[188:191], v[236:239]
    ds_read_b64_tr_b16 a[184:185], v48 offset:57344
    v_cvt_pk_bf16_f32 v65, v14, v15
    v_mfma_f32_16x16x32_bf16 v[240:243], v[54:57], a[160:163], v[240:243]
    v_exp_f32 v78, v78
    v_mfma_f32_16x16x32_bf16 v[240:243], v[58:61], a[192:195], v[240:243]
    ds_read_b64_tr_b16 a[186:187], v48 offset:61440
    ds_read_b64_tr_b16 a[156:157], v49 offset:49152
    v_mfma_f32_16x16x32_bf16 v[244:247], v[54:57], a[164:167], v[244:247]
    v_exp_f32 v79, v79
    v_mfma_f32_16x16x32_bf16 v[244:247], v[58:61], a[196:199], v[244:247]
    ds_read_b64_tr_b16 a[158:159], v49 offset:53248
    v_cvt_pk_bf16_f32 v66, v78, v79
    v_mfma_f32_16x16x32_bf16 v[248:251], v[54:57], a[168:171], v[248:251]
    v_exp_f32 v80, v80
    v_mfma_f32_16x16x32_bf16 v[248:251], v[58:61], a[200:203], v[248:251]
    ds_read_b64_tr_b16 a[188:189], v49 offset:57344
    ds_read_b64_tr_b16 a[190:191], v49 offset:61440
    v_mfma_f32_16x16x32_bf16 v[252:255], v[54:57], a[172:175], v[252:255]
    v_exp_f32 v81, v81
    v_mfma_f32_16x16x32_bf16 v[252:255], v[58:61], a[204:207], v[252:255]
    ds_read_b64_tr_b16 a[168:169], v52 offset:49152
    v_cvt_pk_bf16_f32 v67, v80, v81
    v_mfma_f32_16x16x32_bf16 v[8:11], a[80:83], a[16:19], v[20:23]
    v_exp_f32 v82, v82
    v_mfma_f32_16x16x32_bf16 v[8:11], a[84:87], a[20:23], v[8:11]
    ds_read_b64_tr_b16 a[170:171], v52 offset:53248
    ds_read_b64_tr_b16 a[200:201], v52 offset:57344
    v_mfma_f32_16x16x32_bf16 v[8:11], a[88:91], a[24:27], v[8:11]
    v_exp_f32 v83, v83
    v_mfma_f32_16x16x32_bf16 v[8:11], a[92:95], a[28:31], v[8:11]
    ds_read_b64_tr_b16 a[202:203], v52 offset:61440
    v_cvt_pk_bf16_f32 v68, v82, v83
    v_mfma_f32_16x16x32_bf16 v[12:15], a[108:111], a[28:31], v[20:23]
    v_exp_f32 v84, v84
    v_mfma_f32_16x16x32_bf16 v[12:15], a[104:107], a[24:27], v[12:15]
    ds_read_b64_tr_b16 a[172:173], v53 offset:49152
    ds_read_b64_tr_b16 a[174:175], v53 offset:53248
    v_mfma_f32_16x16x32_bf16 v[12:15], a[100:103], a[20:23], v[12:15]
    v_exp_f32 v85, v85
    v_mfma_f32_16x16x32_bf16 v[12:15], a[96:99], a[16:19], v[12:15]
    ds_read_b64_tr_b16 a[204:205], v53 offset:57344
    v_cvt_pk_bf16_f32 v69, v84, v85
    v_mfma_f32_16x16x32_bf16 v[78:81], a[112:115], a[16:19], v[20:23]
    v_exp_f32 v8, v8
    v_mfma_f32_16x16x32_bf16 v[78:81], a[116:119], a[20:23], v[78:81]
    ds_read_b64_tr_b16 a[206:207], v53 offset:61440
    v_add_f32 v37, v37, v8
    v_mfma_f32_16x16x32_bf16 v[78:81], a[120:123], a[24:27], v[78:81]
    v_exp_f32 v9, v9
    v_mfma_f32_16x16x32_bf16 v[78:81], a[124:127], a[28:31], v[78:81]
    v_cvt_pk_bf16_f32 v54, v8, v9
    v_add_f32 v37, v37, v9
    v_mfma_f32_16x16x32_bf16 v[82:85], a[140:143], a[28:31], v[20:23]
    v_exp_f32 v10, v10
    v_mfma_f32_16x16x32_bf16 v[82:85], a[136:139], a[24:27], v[82:85]
    v_add_f32 v37, v37, v10
    v_mfma_f32_16x16x32_bf16 v[82:85], a[132:135], a[20:23], v[82:85]
    v_exp_f32 v11, v11
    v_mfma_f32_16x16x32_bf16 v[82:85], a[128:131], a[16:19], v[82:85]
    v_cvt_pk_bf16_f32 v55, v10, v11
    v_add_f32 v37, v37, v11
    v_smfmac_f32_16x16x64_bf16 a[248:251], a[208:211], v[62:69], v41
    v_mfma_f32_16x16x32_bf16 v[96:99], v[62:65], a[212:215], v[96:99]
    v_exp_f32 v12, v12
    v_mfma_f32_16x16x32_bf16 v[96:99], v[66:69], a[216:219], v[96:99]
    v_add_f32 v37, v37, v12
    v_mfma_f32_16x16x32_bf16 v[100:103], v[62:65], a[220:223], v[100:103]
    v_exp_f32 v13, v13
    v_mfma_f32_16x16x32_bf16 v[100:103], v[66:69], a[224:227], v[100:103]
    v_cvt_pk_bf16_f32 v56, v12, v13
    v_add_f32 v37, v37, v13
    v_mfma_f32_16x16x4_f32 v[16:19], a248, v75, 0
    v_mfma_f32_16x16x4_f32 v[16:19], a249, v75, v[16:19]
    s_waitcnt lgkmcnt(0)
    v_mfma_f32_16x16x32_bf16 v[104:107], v[62:65], a[152:155], v[104:107]
    v_exp_f32 v14, v14
    v_mfma_f32_16x16x32_bf16 v[104:107], v[66:69], a[184:187], v[104:107]
    v_add_f32 v37, v37, v14
    v_mfma_f32_16x16x32_bf16 v[108:111], v[62:65], a[156:159], v[108:111]
    v_exp_f32 v15, v15
    v_mfma_f32_16x16x32_bf16 v[108:111], v[66:69], a[188:191], v[108:111]
    v_cvt_pk_bf16_f32 v57, v14, v15
    v_add_f32 v37, v37, v15
    v_mfma_f32_16x16x32_bf16 v[112:115], v[62:65], a[228:231], v[112:115]
    v_exp_f32 v78, v78
    v_max3_f32 v5, v16, v17, v18
    v_rcp_f32 v16, v16
    v_mfma_f32_16x16x32_bf16 v[112:115], v[66:69], a[232:235], v[112:115]
    v_add_f32 v37, v37, v78
    v_max_f32 v5, v5, v19
    v_rcp_f32 v17, v17
    v_cmp_nlt_f32 vcc, v5, s46
    v_mfma_f32_16x16x32_bf16 v[116:119], v[62:65], a[236:239], v[116:119]
    v_exp_f32 v79, v79
    v_rcp_f32 v18, v18
    v_rcp_f32 v19, v19
    v_mfma_f32_16x16x32_bf16 v[116:119], v[66:69], a[240:243], v[116:119]
    v_cvt_pk_bf16_f32 v58, v78, v79
    v_add_f32 v37, v37, v79
    s_or_b64 s[44:45], s[44:45], vcc
    v_pk_mul_f32 v[96:97], v[96:97], v[16:17]
    v_pk_mul_f32 v[98:99], v[98:99], v[18:19]
    v_pk_mul_f32 v[100:101], v[100:101], v[16:17]
    v_pk_mul_f32 v[102:103], v[102:103], v[18:19]
    v_pk_mul_f32 v[104:105], v[104:105], v[16:17]
    v_pk_mul_f32 v[106:107], v[106:107], v[18:19]
    v_pk_mul_f32 v[108:109], v[108:109], v[16:17]
    v_pk_mul_f32 v[110:111], v[110:111], v[18:19]
    v_mfma_f32_16x16x32_bf16 v[120:123], v[62:65], a[168:171], v[120:123]
    v_exp_f32 v80, v80
    v_cvt_pk_bf16_f32 v86, v96, v100
    v_cvt_pk_bf16_f32 v87, v104, v108
    v_mfma_f32_16x16x32_bf16 v[120:123], v[66:69], a[200:203], v[120:123]
    v_add_f32 v37, v37, v80
    v_cvt_pk_bf16_f32 v88, v97, v101
    v_cvt_pk_bf16_f32 v89, v105, v109
    v_cvt_pk_bf16_f32 v96, v98, v102
    v_mfma_f32_16x16x32_bf16 v[124:127], v[62:65], a[172:175], v[124:127]
    v_exp_f32 v81, v81
    v_cvt_pk_bf16_f32 v97, v106, v110
    v_cvt_pk_bf16_f32 v100, v99, v103
    v_mfma_f32_16x16x32_bf16 v[124:127], v[66:69], a[204:207], v[124:127]
    v_cvt_pk_bf16_f32 v59, v80, v81
    v_add_f32 v37, v37, v81
    v_cvt_pk_bf16_f32 v101, v107, v111
    v_mfma_f32_16x16x32_bf16 v[8:11], a[80:83], a[32:35], v[24:27]
    v_exp_f32 v82, v82
    v_mfma_f32_16x16x32_bf16 v[8:11], a[84:87], a[36:39], v[8:11]
    ds_write_b64 v70, v[86:87] offset:0
    ds_write_b64 v71, v[88:89] offset:0
    v_add_f32 v37, v37, v82
    v_mfma_f32_16x16x32_bf16 v[8:11], a[88:91], a[40:43], v[8:11]
    ds_write_b64 v70, v[96:97] offset:512
    ds_write_b64 v71, v[100:101] offset:512
    v_exp_f32 v83, v83
    v_pk_mul_f32 v[112:113], v[112:113], v[16:17]
    v_pk_mul_f32 v[114:115], v[114:115], v[18:19]
    v_pk_mul_f32 v[116:117], v[116:117], v[16:17]
    v_pk_mul_f32 v[118:119], v[118:119], v[18:19]
    v_pk_mul_f32 v[120:121], v[120:121], v[16:17]
    v_pk_mul_f32 v[122:123], v[122:123], v[18:19]
    v_pk_mul_f32 v[124:125], v[124:125], v[16:17]
    v_pk_mul_f32 v[126:127], v[126:127], v[18:19]
    v_mfma_f32_16x16x32_bf16 v[8:11], a[92:95], a[44:47], v[8:11]
    v_cvt_pk_bf16_f32 v60, v82, v83
    v_add_f32 v37, v37, v83
    v_cvt_pk_bf16_f32 v86, v112, v116
    v_cvt_pk_bf16_f32 v87, v120, v124
    v_mfma_f32_16x16x32_bf16 v[12:15], a[108:111], a[44:47], v[24:27]
    v_exp_f32 v84, v84
    v_cvt_pk_bf16_f32 v88, v113, v117
    v_cvt_pk_bf16_f32 v89, v121, v125
    v_mfma_f32_16x16x32_bf16 v[12:15], a[104:107], a[40:43], v[12:15]
    v_add_f32 v37, v37, v84
    v_cvt_pk_bf16_f32 v112, v114, v118
    v_cvt_pk_bf16_f32 v113, v122, v126
    v_cvt_pk_bf16_f32 v116, v115, v119
    v_mfma_f32_16x16x32_bf16 v[12:15], a[100:103], a[36:39], v[12:15]
    v_exp_f32 v85, v85
    v_cvt_pk_bf16_f32 v117, v123, v127
    v_mfma_f32_16x16x32_bf16 v[12:15], a[96:99], a[32:35], v[12:15]
    ds_write_b64 v70, v[86:87] offset:128
    ds_write_b64 v71, v[88:89] offset:128
    v_cvt_pk_bf16_f32 v61, v84, v85
    v_add_f32 v37, v37, v85
    v_mfma_f32_16x16x32_bf16 v[78:81], a[112:115], a[32:35], v[24:27]
    v_exp_f32 v8, v8
    v_mfma_f32_16x16x4_f32 v[20:23], v37, v74, 0
    v_mfma_f32_16x16x32_bf16 v[78:81], a[116:119], a[36:39], v[78:81]
    ds_write_b64 v70, v[112:113] offset:640
    ds_write_b64 v71, v[116:117] offset:640
    v_add_f32 v38, v38, v8
    v_mfma_f32_16x16x32_bf16 v[78:81], a[120:123], a[40:43], v[78:81]
    ds_read_b64_tr_b16 v[104:105], v72 offset:0
    ds_read_b64_tr_b16 v[106:107], v73 offset:0
    v_exp_f32 v9, v9
    v_mfma_f32_16x16x32_bf16 v[78:81], a[124:127], a[44:47], v[78:81]
    ds_read_b64_tr_b16 v[108:109], v72 offset:1024
    ds_read_b64_tr_b16 v[110:111], v73 offset:1024
    v_cvt_pk_bf16_f32 v62, v8, v9
    v_add_f32 v38, v38, v9
    v_mfma_f32_16x16x32_bf16 v[82:85], a[140:143], a[44:47], v[24:27]
    v_exp_f32 v10, v10
    v_mfma_f32_16x16x32_bf16 v[82:85], a[136:139], a[40:43], v[82:85]
    ds_read_b64_tr_b16 v[120:121], v72 offset:2048
    ds_read_b64_tr_b16 v[122:123], v73 offset:2048
    v_add_f32 v38, v38, v10
    v_mfma_f32_16x16x32_bf16 v[82:85], a[132:135], a[36:39], v[82:85]
    ds_read_b64_tr_b16 v[124:125], v72 offset:3072
    ds_read_b64_tr_b16 v[126:127], v73 offset:3072
    v_exp_f32 v11, v11
    v_mfma_f32_16x16x32_bf16 v[82:85], a[128:131], a[32:35], v[82:85]
    v_cvt_pk_bf16_f32 v63, v10, v11
    v_add_f32 v38, v38, v11
    v_max3_f32 v5, v20, v21, v22
    v_rcp_f32 v20, v20
    v_mfma_f32_16x16x32_bf16 v[128:131], v[54:57], a[212:215], v[128:131]
    v_exp_f32 v12, v12
    v_max_f32 v5, v5, v23
    v_rcp_f32 v21, v21
    v_mfma_f32_16x16x32_bf16 v[128:131], v[58:61], a[216:219], v[128:131]
    v_add_f32 v38, v38, v12
    v_cmp_nlt_f32 vcc, v5, s46
    v_rcp_f32 v22, v22
    v_rcp_f32 v23, v23
    v_mfma_f32_16x16x32_bf16 v[132:135], v[54:57], a[220:223], v[132:135]
    v_exp_f32 v13, v13
    s_or_b64 s[44:45], s[44:45], vcc
    v_mfma_f32_16x16x32_bf16 v[132:135], v[58:61], a[224:227], v[132:135]
    v_cvt_pk_bf16_f32 v64, v12, v13
    v_add_f32 v38, v38, v13
    v_mfma_f32_16x16x32_bf16 v[136:139], v[54:57], a[152:155], v[136:139]
    s_add_u32 s35, s36, 0
    s_waitcnt lgkmcnt(1)
    buffer_store_dwordx4 v[104:107], v6, s[24:27], s35 offen offset:0 sc1 nt
    v_exp_f32 v14, v14
    v_mfma_f32_16x16x32_bf16 v[136:139], v[58:61], a[184:187], v[136:139]
    buffer_store_dwordx4 v[108:111], v6, s[24:27], s35 offen offset:1024 sc1 nt
    v_add_f32 v38, v38, v14
    v_mfma_f32_16x16x32_bf16 v[140:143], v[54:57], a[156:159], v[140:143]
    buffer_store_dwordx4 v[120:123], v6, s[24:27], s35 offen offset:2048 sc1 nt
    v_exp_f32 v15, v15
    v_mfma_f32_16x16x32_bf16 v[140:143], v[58:61], a[188:191], v[140:143]
    s_waitcnt lgkmcnt(0)
    buffer_store_dwordx4 v[124:127], v6, s[24:27], s35 offen offset:3072 sc1 nt
    v_cvt_pk_bf16_f32 v65, v14, v15
    v_add_f32 v38, v38, v15
    v_mfma_f32_16x16x32_bf16 v[144:147], v[54:57], a[228:231], v[144:147]
    v_exp_f32 v78, v78
    v_mfma_f32_16x16x32_bf16 v[144:147], v[58:61], a[232:235], v[144:147]
    v_add_f32 v38, v38, v78
    v_mfma_f32_16x16x32_bf16 v[148:151], v[54:57], a[236:239], v[148:151]
    v_exp_f32 v79, v79
    v_pk_mul_f32 v[128:129], v[128:129], v[20:21]
    v_pk_mul_f32 v[130:131], v[130:131], v[22:23]
    v_pk_mul_f32 v[132:133], v[132:133], v[20:21]
    v_pk_mul_f32 v[134:135], v[134:135], v[22:23]
    v_pk_mul_f32 v[136:137], v[136:137], v[20:21]
    v_pk_mul_f32 v[138:139], v[138:139], v[22:23]
    v_pk_mul_f32 v[140:141], v[140:141], v[20:21]
    v_pk_mul_f32 v[142:143], v[142:143], v[22:23]
    v_mfma_f32_16x16x32_bf16 v[148:151], v[58:61], a[240:243], v[148:151]
    v_cvt_pk_bf16_f32 v66, v78, v79
    v_add_f32 v38, v38, v79
    v_cvt_pk_bf16_f32 v86, v128, v132
    v_cvt_pk_bf16_f32 v87, v136, v140
    v_mfma_f32_16x16x32_bf16 v[152:155], v[54:57], a[168:171], v[152:155]
    v_exp_f32 v80, v80
    v_cvt_pk_bf16_f32 v88, v129, v133
    v_cvt_pk_bf16_f32 v89, v137, v141
    v_mfma_f32_16x16x32_bf16 v[152:155], v[58:61], a[200:203], v[152:155]
    v_add_f32 v38, v38, v80
    v_cvt_pk_bf16_f32 v128, v130, v134
    v_cvt_pk_bf16_f32 v129, v138, v142
    v_cvt_pk_bf16_f32 v132, v131, v135
    v_mfma_f32_16x16x32_bf16 v[156:159], v[54:57], a[172:175], v[156:159]
    v_exp_f32 v81, v81
    v_cvt_pk_bf16_f32 v133, v139, v143
    v_mfma_f32_16x16x32_bf16 v[156:159], v[58:61], a[204:207], v[156:159]
    ds_write_b64 v70, v[86:87] offset:4096
    ds_write_b64 v71, v[88:89] offset:4096
    v_cvt_pk_bf16_f32 v67, v80, v81
    v_add_f32 v38, v38, v81
    v_mfma_f32_16x16x32_bf16 v[8:11], a[80:83], a[48:51], v[28:31]
    v_exp_f32 v82, v82
    v_mfma_f32_16x16x32_bf16 v[8:11], a[84:87], a[52:55], v[8:11]
    ds_write_b64 v70, v[128:129] offset:4608
    ds_write_b64 v71, v[132:133] offset:4608
    v_add_f32 v38, v38, v82
    v_mfma_f32_16x16x32_bf16 v[8:11], a[88:91], a[56:59], v[8:11]
    v_exp_f32 v83, v83
    v_pk_mul_f32 v[144:145], v[144:145], v[20:21]
    v_pk_mul_f32 v[146:147], v[146:147], v[22:23]
    v_pk_mul_f32 v[148:149], v[148:149], v[20:21]
    v_pk_mul_f32 v[150:151], v[150:151], v[22:23]
    v_pk_mul_f32 v[152:153], v[152:153], v[20:21]
    v_pk_mul_f32 v[154:155], v[154:155], v[22:23]
    v_pk_mul_f32 v[156:157], v[156:157], v[20:21]
    v_pk_mul_f32 v[158:159], v[158:159], v[22:23]
    v_mfma_f32_16x16x32_bf16 v[8:11], a[92:95], a[60:63], v[8:11]
    v_cvt_pk_bf16_f32 v68, v82, v83
    v_add_f32 v38, v38, v83
    v_cvt_pk_bf16_f32 v86, v144, v148
    v_cvt_pk_bf16_f32 v87, v152, v156
    v_mfma_f32_16x16x32_bf16 v[12:15], a[108:111], a[60:63], v[28:31]
    v_exp_f32 v84, v84
    v_cvt_pk_bf16_f32 v88, v145, v149
    v_cvt_pk_bf16_f32 v89, v153, v157
    v_mfma_f32_16x16x32_bf16 v[12:15], a[104:107], a[56:59], v[12:15]
    v_add_f32 v38, v38, v84
    v_cvt_pk_bf16_f32 v144, v146, v150
    v_cvt_pk_bf16_f32 v145, v154, v158
    v_cvt_pk_bf16_f32 v148, v147, v151
    v_mfma_f32_16x16x32_bf16 v[12:15], a[100:103], a[52:55], v[12:15]
    v_exp_f32 v85, v85
    v_cvt_pk_bf16_f32 v149, v155, v159
    v_mfma_f32_16x16x32_bf16 v[12:15], a[96:99], a[48:51], v[12:15]
    ds_write_b64 v70, v[86:87] offset:4224
    ds_write_b64 v71, v[88:89] offset:4224
    v_cvt_pk_bf16_f32 v69, v84, v85
    v_add_f32 v38, v38, v85
    v_mfma_f32_16x16x32_bf16 v[78:81], a[112:115], a[48:51], v[28:31]
    v_exp_f32 v8, v8
    v_mfma_f32_16x16x4_f32 v[24:27], v38, v74, 0
    v_mfma_f32_16x16x32_bf16 v[78:81], a[116:119], a[52:55], v[78:81]
    ds_write_b64 v70, v[144:145] offset:4736
    ds_write_b64 v71, v[148:149] offset:4736
    v_add_f32 v39, v39, v8
    v_mfma_f32_16x16x32_bf16 v[78:81], a[120:123], a[56:59], v[78:81]
    ds_read_b64_tr_b16 v[136:137], v72 offset:4096
    ds_read_b64_tr_b16 v[138:139], v73 offset:4096
    v_exp_f32 v9, v9
    v_mfma_f32_16x16x32_bf16 v[78:81], a[124:127], a[60:63], v[78:81]
    ds_read_b64_tr_b16 v[140:141], v72 offset:5120
    ds_read_b64_tr_b16 v[142:143], v73 offset:5120
    v_cvt_pk_bf16_f32 v54, v8, v9
    v_add_f32 v39, v39, v9
    v_mfma_f32_16x16x32_bf16 v[82:85], a[140:143], a[60:63], v[28:31]
    v_exp_f32 v10, v10
    v_mfma_f32_16x16x32_bf16 v[82:85], a[136:139], a[56:59], v[82:85]
    ds_read_b64_tr_b16 v[152:153], v72 offset:6144
    ds_read_b64_tr_b16 v[154:155], v73 offset:6144
    v_add_f32 v39, v39, v10
    v_mfma_f32_16x16x32_bf16 v[82:85], a[132:135], a[52:55], v[82:85]
    ds_read_b64_tr_b16 v[156:157], v72 offset:7168
    ds_read_b64_tr_b16 v[158:159], v73 offset:7168
    v_exp_f32 v11, v11
    v_mfma_f32_16x16x32_bf16 v[82:85], a[128:131], a[48:51], v[82:85]
    v_cvt_pk_bf16_f32 v55, v10, v11
    v_add_f32 v39, v39, v11
    v_max3_f32 v5, v24, v25, v26
    v_rcp_f32 v24, v24
    v_mfma_f32_16x16x32_bf16 v[160:163], v[62:65], a[212:215], v[160:163]
    v_exp_f32 v12, v12
    v_max_f32 v5, v5, v27
    v_rcp_f32 v25, v25
    v_mfma_f32_16x16x32_bf16 v[160:163], v[66:69], a[216:219], v[160:163]
    v_add_f32 v39, v39, v12
    v_cmp_nlt_f32 vcc, v5, s46
    v_rcp_f32 v26, v26
    v_rcp_f32 v27, v27
    v_mfma_f32_16x16x32_bf16 v[164:167], v[62:65], a[220:223], v[164:167]
    v_exp_f32 v13, v13
    s_or_b64 s[44:45], s[44:45], vcc
    v_mfma_f32_16x16x32_bf16 v[164:167], v[66:69], a[224:227], v[164:167]
    v_cvt_pk_bf16_f32 v56, v12, v13
    v_add_f32 v39, v39, v13
    v_mfma_f32_16x16x32_bf16 v[168:171], v[62:65], a[152:155], v[168:171]
    s_add_u32 s35, s36, 4096
    s_waitcnt lgkmcnt(1)
    buffer_store_dwordx4 v[136:139], v6, s[24:27], s35 offen offset:0 sc1 nt
    v_exp_f32 v14, v14
    v_mfma_f32_16x16x32_bf16 v[168:171], v[66:69], a[184:187], v[168:171]
    buffer_store_dwordx4 v[140:143], v6, s[24:27], s35 offen offset:1024 sc1 nt
    v_add_f32 v39, v39, v14
    v_mfma_f32_16x16x32_bf16 v[172:175], v[62:65], a[156:159], v[172:175]
    buffer_store_dwordx4 v[152:155], v6, s[24:27], s35 offen offset:2048 sc1 nt
    v_exp_f32 v15, v15
    v_mfma_f32_16x16x32_bf16 v[172:175], v[66:69], a[188:191], v[172:175]
    s_waitcnt lgkmcnt(0)
    buffer_store_dwordx4 v[156:159], v6, s[24:27], s35 offen offset:3072 sc1 nt
    v_cvt_pk_bf16_f32 v57, v14, v15
    v_add_f32 v39, v39, v15
    v_mfma_f32_16x16x32_bf16 v[176:179], v[62:65], a[228:231], v[176:179]
    v_exp_f32 v78, v78
    v_mfma_f32_16x16x32_bf16 v[176:179], v[66:69], a[232:235], v[176:179]
    v_add_f32 v39, v39, v78
    v_mfma_f32_16x16x32_bf16 v[180:183], v[62:65], a[236:239], v[180:183]
    v_exp_f32 v79, v79
    v_pk_mul_f32 v[160:161], v[160:161], v[24:25]
    v_pk_mul_f32 v[162:163], v[162:163], v[26:27]
    v_pk_mul_f32 v[164:165], v[164:165], v[24:25]
    v_pk_mul_f32 v[166:167], v[166:167], v[26:27]
    v_pk_mul_f32 v[168:169], v[168:169], v[24:25]
    v_pk_mul_f32 v[170:171], v[170:171], v[26:27]
    v_pk_mul_f32 v[172:173], v[172:173], v[24:25]
    v_pk_mul_f32 v[174:175], v[174:175], v[26:27]
    v_mfma_f32_16x16x32_bf16 v[180:183], v[66:69], a[240:243], v[180:183]
    v_cvt_pk_bf16_f32 v58, v78, v79
    v_add_f32 v39, v39, v79
    v_cvt_pk_bf16_f32 v86, v160, v164
    v_cvt_pk_bf16_f32 v87, v168, v172
    v_mfma_f32_16x16x32_bf16 v[184:187], v[62:65], a[168:171], v[184:187]
    v_exp_f32 v80, v80
    v_cvt_pk_bf16_f32 v88, v161, v165
    v_cvt_pk_bf16_f32 v89, v169, v173
    v_mfma_f32_16x16x32_bf16 v[184:187], v[66:69], a[200:203], v[184:187]
    v_add_f32 v39, v39, v80
    v_cvt_pk_bf16_f32 v160, v162, v166
    v_cvt_pk_bf16_f32 v161, v170, v174
    v_cvt_pk_bf16_f32 v164, v163, v167
    v_mfma_f32_16x16x32_bf16 v[188:191], v[62:65], a[172:175], v[188:191]
    v_exp_f32 v81, v81
    v_cvt_pk_bf16_f32 v165, v171, v175
    v_mfma_f32_16x16x32_bf16 v[188:191], v[66:69], a[204:207], v[188:191]
    ds_write_b64 v70, v[86:87] offset:0
    ds_write_b64 v71, v[88:89] offset:0
    v_cvt_pk_bf16_f32 v59, v80, v81
    v_add_f32 v39, v39, v81
    v_mfma_f32_16x16x32_bf16 v[8:11], a[80:83], a[64:67], v[32:35]
    v_exp_f32 v82, v82
    v_mfma_f32_16x16x32_bf16 v[8:11], a[84:87], a[68:71], v[8:11]
    ds_write_b64 v70, v[160:161] offset:512
    ds_write_b64 v71, v[164:165] offset:512
    v_add_f32 v39, v39, v82
    v_mfma_f32_16x16x32_bf16 v[8:11], a[88:91], a[72:75], v[8:11]
    v_exp_f32 v83, v83
    v_pk_mul_f32 v[176:177], v[176:177], v[24:25]
    v_pk_mul_f32 v[178:179], v[178:179], v[26:27]
    v_pk_mul_f32 v[180:181], v[180:181], v[24:25]
    v_pk_mul_f32 v[182:183], v[182:183], v[26:27]
    v_pk_mul_f32 v[184:185], v[184:185], v[24:25]
    v_pk_mul_f32 v[186:187], v[186:187], v[26:27]
    v_pk_mul_f32 v[188:189], v[188:189], v[24:25]
    v_pk_mul_f32 v[190:191], v[190:191], v[26:27]
    v_mfma_f32_16x16x32_bf16 v[8:11], a[92:95], a[76:79], v[8:11]
    v_cvt_pk_bf16_f32 v60, v82, v83
    v_add_f32 v39, v39, v83
    v_cvt_pk_bf16_f32 v86, v176, v180
    v_cvt_pk_bf16_f32 v87, v184, v188
    v_mfma_f32_16x16x32_bf16 v[12:15], a[108:111], a[76:79], v[32:35]
    v_exp_f32 v84, v84
    v_cvt_pk_bf16_f32 v88, v177, v181
    v_cvt_pk_bf16_f32 v89, v185, v189
    v_mfma_f32_16x16x32_bf16 v[12:15], a[104:107], a[72:75], v[12:15]
    v_add_f32 v39, v39, v84
    v_cvt_pk_bf16_f32 v176, v178, v182
    v_cvt_pk_bf16_f32 v177, v186, v190
    v_cvt_pk_bf16_f32 v180, v179, v183
    v_mfma_f32_16x16x32_bf16 v[12:15], a[100:103], a[68:71], v[12:15]
    v_exp_f32 v85, v85
    v_cvt_pk_bf16_f32 v181, v187, v191
    v_mfma_f32_16x16x32_bf16 v[12:15], a[96:99], a[64:67], v[12:15]
    ds_write_b64 v70, v[86:87] offset:128
    ds_write_b64 v71, v[88:89] offset:128
    v_cvt_pk_bf16_f32 v61, v84, v85
    v_add_f32 v39, v39, v85
    v_mfma_f32_16x16x32_bf16 v[78:81], a[112:115], a[64:67], v[32:35]
    v_exp_f32 v8, v8
    v_mfma_f32_16x16x4_f32 v[28:31], v39, v74, 0
    v_mfma_f32_16x16x32_bf16 v[78:81], a[116:119], a[68:71], v[78:81]
    ds_write_b64 v70, v[176:177] offset:640
    ds_write_b64 v71, v[180:181] offset:640
    v_mfma_f32_16x16x32_bf16 v[78:81], a[120:123], a[72:75], v[78:81]
    v_exp_f32 v9, v9
    v_mfma_f32_16x16x32_bf16 v[78:81], a[124:127], a[76:79], v[78:81]
    ds_read_b64_tr_b16 v[168:169], v72 offset:0
    ds_read_b64_tr_b16 v[170:171], v73 offset:0
    v_cvt_pk_bf16_f32 v62, v8, v9
    v_mfma_f32_16x16x32_bf16 v[82:85], a[140:143], a[76:79], v[32:35]
    v_exp_f32 v10, v10
    v_mfma_f32_16x16x32_bf16 v[82:85], a[136:139], a[72:75], v[82:85]
    ds_read_b64_tr_b16 v[172:173], v72 offset:1024
    ds_read_b64_tr_b16 v[174:175], v73 offset:1024
    v_mfma_f32_16x16x32_bf16 v[82:85], a[132:135], a[68:71], v[82:85]
    v_exp_f32 v11, v11
    v_mfma_f32_16x16x32_bf16 v[82:85], a[128:131], a[64:67], v[82:85]
    ds_read_b64_tr_b16 v[184:185], v72 offset:2048
    ds_read_b64_tr_b16 v[186:187], v73 offset:2048
    v_cvt_pk_bf16_f32 v63, v10, v11
    v_mfma_f32_16x16x32_bf16 v[192:195], v[54:57], a[212:215], v[192:195]
    v_exp_f32 v12, v12
    v_mfma_f32_16x16x32_bf16 v[192:195], v[58:61], a[216:219], v[192:195]
    ds_read_b64_tr_b16 v[188:189], v72 offset:3072
    ds_read_b64_tr_b16 v[190:191], v73 offset:3072
    v_mfma_f32_16x16x32_bf16 v[196:199], v[54:57], a[220:223], v[196:199]
    v_exp_f32 v13, v13
    v_max3_f32 v5, v28, v29, v30
    v_rcp_f32 v28, v28
    v_mfma_f32_16x16x32_bf16 v[196:199], v[58:61], a[224:227], v[196:199]
    v_cvt_pk_bf16_f32 v64, v12, v13
    v_max_f32 v5, v5, v31
    v_rcp_f32 v29, v29
    v_cmp_nlt_f32 vcc, v5, s46
    v_mfma_f32_16x16x32_bf16 v[200:203], v[54:57], a[152:155], v[200:203]
    v_exp_f32 v14, v14
    v_rcp_f32 v30, v30
    v_rcp_f32 v31, v31
    v_mfma_f32_16x16x32_bf16 v[200:203], v[58:61], a[184:187], v[200:203]
    s_or_b64 s[44:45], s[44:45], vcc
    v_mfma_f32_16x16x32_bf16 v[204:207], v[54:57], a[156:159], v[204:207]
    v_exp_f32 v15, v15
    v_mfma_f32_16x16x32_bf16 v[204:207], v[58:61], a[188:191], v[204:207]
    s_add_u32 s35, s36, 8192
    s_waitcnt lgkmcnt(2)
    buffer_store_dwordx4 v[168:171], v6, s[24:27], s35 offen offset:0 sc1 nt
    v_cvt_pk_bf16_f32 v65, v14, v15
    v_mfma_f32_16x16x32_bf16 v[208:211], v[54:57], a[228:231], v[208:211]
    buffer_store_dwordx4 v[172:175], v6, s[24:27], s35 offen offset:1024 sc1 nt
    v_exp_f32 v78, v78
    v_mfma_f32_16x16x32_bf16 v[208:211], v[58:61], a[232:235], v[208:211]
    buffer_store_dwordx4 v[184:187], v6, s[24:27], s35 offen offset:2048 sc1 nt
    v_mfma_f32_16x16x32_bf16 v[212:215], v[54:57], a[236:239], v[212:215]
    s_waitcnt lgkmcnt(0)
    buffer_store_dwordx4 v[188:191], v6, s[24:27], s35 offen offset:3072 sc1 nt
    v_exp_f32 v79, v79
    v_pk_mul_f32 v[192:193], v[192:193], v[28:29]
    v_pk_mul_f32 v[194:195], v[194:195], v[30:31]
    v_pk_mul_f32 v[196:197], v[196:197], v[28:29]
    v_pk_mul_f32 v[198:199], v[198:199], v[30:31]
    v_pk_mul_f32 v[200:201], v[200:201], v[28:29]
    v_pk_mul_f32 v[202:203], v[202:203], v[30:31]
    v_pk_mul_f32 v[204:205], v[204:205], v[28:29]
    v_pk_mul_f32 v[206:207], v[206:207], v[30:31]
    v_mfma_f32_16x16x32_bf16 v[212:215], v[58:61], a[240:243], v[212:215]
    v_cvt_pk_bf16_f32 v66, v78, v79
    v_cvt_pk_bf16_f32 v86, v192, v196
    v_cvt_pk_bf16_f32 v87, v200, v204
    v_cvt_pk_bf16_f32 v88, v193, v197
    v_mfma_f32_16x16x32_bf16 v[216:219], v[54:57], a[168:171], v[216:219]
    v_exp_f32 v80, v80
    v_cvt_pk_bf16_f32 v89, v201, v205
    v_cvt_pk_bf16_f32 v192, v194, v198
    v_mfma_f32_16x16x32_bf16 v[216:219], v[58:61], a[200:203], v[216:219]
    v_cvt_pk_bf16_f32 v193, v202, v206
    v_cvt_pk_bf16_f32 v196, v195, v199
    v_cvt_pk_bf16_f32 v197, v203, v207
    v_mfma_f32_16x16x32_bf16 v[220:223], v[54:57], a[172:175], v[220:223]
    v_exp_f32 v81, v81
    v_mfma_f32_16x16x32_bf16 v[220:223], v[58:61], a[204:207], v[220:223]
    ds_write_b64 v70, v[86:87] offset:4096
    ds_write_b64 v71, v[88:89] offset:4096
    v_cvt_pk_bf16_f32 v67, v80, v81
    v_exp_f32 v82, v82
    v_exp_f32 v83, v83
    s_nop 0
    v_cvt_pk_bf16_f32 v68, v82, v83
    v_exp_f32 v84, v84
    v_exp_f32 v85, v85
    s_nop 0
    v_cvt_pk_bf16_f32 v69, v84, v85
    s_nop 1
    v_smfmac_f32_16x16x64_bf16 a[252:255], a[208:211], v[62:69], v41
    v_mfma_f32_16x16x32_bf16 v[224:227], v[62:65], a[212:215], v[224:227]
    ds_write_b64 v70, v[192:193] offset:4608
    ds_write_b64 v71, v[196:197] offset:4608
    v_pk_mul_f32 v[208:209], v[208:209], v[28:29]
    v_pk_mul_f32 v[210:211], v[210:211], v[30:31]
    v_pk_mul_f32 v[212:213], v[212:213], v[28:29]
    v_pk_mul_f32 v[214:215], v[214:215], v[30:31]
    v_pk_mul_f32 v[216:217], v[216:217], v[28:29]
    v_pk_mul_f32 v[218:219], v[218:219], v[30:31]
    v_pk_mul_f32 v[220:221], v[220:221], v[28:29]
    v_pk_mul_f32 v[222:223], v[222:223], v[30:31]
    v_mfma_f32_16x16x32_bf16 v[224:227], v[66:69], a[216:219], v[224:227]
    v_cvt_pk_bf16_f32 v86, v208, v212
    v_cvt_pk_bf16_f32 v87, v216, v220
    v_cvt_pk_bf16_f32 v88, v209, v213
    v_cvt_pk_bf16_f32 v89, v217, v221
    v_mfma_f32_16x16x32_bf16 v[228:231], v[62:65], a[220:223], v[228:231]
    v_cvt_pk_bf16_f32 v208, v210, v214
    v_cvt_pk_bf16_f32 v209, v218, v222
    v_cvt_pk_bf16_f32 v212, v211, v215
    v_cvt_pk_bf16_f32 v213, v219, v223
    v_mfma_f32_16x16x32_bf16 v[228:231], v[66:69], a[224:227], v[228:231]
    ds_write_b64 v70, v[86:87] offset:4224
    ds_write_b64 v71, v[88:89] offset:4224
    v_mfma_f32_16x16x4_f32 v[32:35], a252, v75, 0
    v_mfma_f32_16x16x4_f32 v[32:35], a253, v75, v[32:35]
    v_mfma_f32_16x16x32_bf16 v[232:235], v[62:65], a[152:155], v[232:235]
    ds_write_b64 v70, v[208:209] offset:4736
    ds_write_b64 v71, v[212:213] offset:4736
    v_mfma_f32_16x16x32_bf16 v[232:235], v[66:69], a[184:187], v[232:235]
    ds_read_b64_tr_b16 v[200:201], v72 offset:4096
    ds_read_b64_tr_b16 v[202:203], v73 offset:4096
    v_mfma_f32_16x16x32_bf16 v[236:239], v[62:65], a[156:159], v[236:239]
    ds_read_b64_tr_b16 v[204:205], v72 offset:5120
    ds_read_b64_tr_b16 v[206:207], v73 offset:5120
    v_mfma_f32_16x16x32_bf16 v[236:239], v[66:69], a[188:191], v[236:239]
    ds_read_b64_tr_b16 v[216:217], v72 offset:6144
    ds_read_b64_tr_b16 v[218:219], v73 offset:6144
    v_mfma_f32_16x16x32_bf16 v[240:243], v[62:65], a[228:231], v[240:243]
    ds_read_b64_tr_b16 v[220:221], v72 offset:7168
    ds_read_b64_tr_b16 v[222:223], v73 offset:7168
    v_mfma_f32_16x16x32_bf16 v[240:243], v[66:69], a[232:235], v[240:243]
    v_max3_f32 v5, v32, v33, v34
    v_rcp_f32 v32, v32
    v_max_f32 v5, v5, v35
    v_rcp_f32 v33, v33
    v_mfma_f32_16x16x32_bf16 v[244:247], v[62:65], a[236:239], v[244:247]
    v_cmp_nlt_f32 vcc, v5, s46
    v_rcp_f32 v34, v34
    v_rcp_f32 v35, v35
    s_or_b64 s[44:45], s[44:45], vcc
    v_mfma_f32_16x16x32_bf16 v[244:247], v[66:69], a[240:243], v[244:247]
    v_pk_mul_f32 v[224:225], v[224:225], v[32:33]
    v_pk_mul_f32 v[226:227], v[226:227], v[34:35]
    v_pk_mul_f32 v[228:229], v[228:229], v[32:33]
    v_pk_mul_f32 v[230:231], v[230:231], v[34:35]
    v_pk_mul_f32 v[232:233], v[232:233], v[32:33]
    v_pk_mul_f32 v[234:235], v[234:235], v[34:35]
    v_pk_mul_f32 v[236:237], v[236:237], v[32:33]
    v_pk_mul_f32 v[238:239], v[238:239], v[34:35]
    v_mfma_f32_16x16x32_bf16 v[248:251], v[62:65], a[168:171], v[248:251]
    v_cvt_pk_bf16_f32 v86, v224, v228
    v_cvt_pk_bf16_f32 v87, v232, v236
    v_cvt_pk_bf16_f32 v88, v225, v229
    v_cvt_pk_bf16_f32 v89, v233, v237
    v_mfma_f32_16x16x32_bf16 v[248:251], v[66:69], a[200:203], v[248:251]
    v_cvt_pk_bf16_f32 v224, v226, v230
    v_cvt_pk_bf16_f32 v225, v234, v238
    v_cvt_pk_bf16_f32 v228, v227, v231
    v_cvt_pk_bf16_f32 v229, v235, v239
    v_mfma_f32_16x16x32_bf16 v[252:255], v[62:65], a[172:175], v[252:255]
    s_add_u32 s35, s36, 12288
    s_waitcnt lgkmcnt(0)
    buffer_store_dwordx4 v[200:203], v6, s[24:27], s35 offen offset:0 sc1 nt
    ds_write_b64 v70, v[86:87] offset:0
    ds_write_b64 v71, v[88:89] offset:0
    v_mfma_f32_16x16x32_bf16 v[252:255], v[66:69], a[204:207], v[252:255]
    buffer_store_dwordx4 v[204:207], v6, s[24:27], s35 offen offset:1024 sc1 nt
    ds_write_b64 v70, v[224:225] offset:512
    ds_write_b64 v71, v[228:229] offset:512
    buffer_store_dwordx4 v[216:219], v6, s[24:27], s35 offen offset:2048 sc1 nt
    buffer_store_dwordx4 v[220:223], v6, s[24:27], s35 offen offset:3072 sc1 nt
    v_pk_mul_f32 v[240:241], v[240:241], v[32:33]
    v_pk_mul_f32 v[242:243], v[242:243], v[34:35]
    v_pk_mul_f32 v[244:245], v[244:245], v[32:33]
    v_pk_mul_f32 v[246:247], v[246:247], v[34:35]
    v_pk_mul_f32 v[248:249], v[248:249], v[32:33]
    v_pk_mul_f32 v[250:251], v[250:251], v[34:35]
    v_pk_mul_f32 v[252:253], v[252:253], v[32:33]
    v_pk_mul_f32 v[254:255], v[254:255], v[34:35]
    v_cvt_pk_bf16_f32 v86, v240, v244
    v_cvt_pk_bf16_f32 v87, v248, v252
    v_cvt_pk_bf16_f32 v88, v241, v245
    v_cvt_pk_bf16_f32 v89, v249, v253
    v_cvt_pk_bf16_f32 v240, v242, v246
    v_cvt_pk_bf16_f32 v241, v250, v254
    v_cvt_pk_bf16_f32 v244, v243, v247
    v_cvt_pk_bf16_f32 v245, v251, v255
    ds_write_b64 v70, v[86:87] offset:128
    ds_write_b64 v71, v[88:89] offset:128
    ds_write_b64 v70, v[240:241] offset:640
    ds_write_b64 v71, v[244:245] offset:640
    ds_read_b64_tr_b16 v[232:233], v72 offset:0
    ds_read_b64_tr_b16 v[234:235], v73 offset:0
    ds_read_b64_tr_b16 v[236:237], v72 offset:1024
    ds_read_b64_tr_b16 v[238:239], v73 offset:1024
    ds_read_b64_tr_b16 v[248:249], v72 offset:2048
    ds_read_b64_tr_b16 v[250:251], v73 offset:2048
    ds_read_b64_tr_b16 v[252:253], v72 offset:3072
    ds_read_b64_tr_b16 v[254:255], v73 offset:3072
    s_add_u32 s35, s36, 16384
    s_waitcnt lgkmcnt(6)
    buffer_store_dwordx4 v[232:235], v6, s[24:27], s35 offen offset:0 sc1 nt
    s_waitcnt lgkmcnt(4)
    buffer_store_dwordx4 v[236:239], v6, s[24:27], s35 offen offset:1024 sc1 nt
    s_waitcnt lgkmcnt(2)
    buffer_store_dwordx4 v[248:251], v6, s[24:27], s35 offen offset:2048 sc1 nt
    s_waitcnt lgkmcnt(0)
    buffer_store_dwordx4 v[252:255], v6, s[24:27], s35 offen offset:3072 sc1 nt
    s_cmp_lg_u32 s31, 0
    s_cbranch_scc1 L_fin
    s_cmp_lg_u64 s[44:45], 0
    s_cselect_b32 s34, 1, 0
    v_mov_b32 v4, s34
    ds_write_b32 v7, v4
    s_waitcnt lgkmcnt(0)
    s_barrier
    v_and_b32 v4, 3, v1
    v_lshlrev_b32 v4, 13, v4
    v_add_u32 v4, 131072, v4
    ds_read_b32 v4, v4
    s_waitcnt lgkmcnt(0)
    v_cmp_ne_u32 vcc, 0, v4
    s_nop 3
    s_cmp_eq_u64 vcc, 0
    s_cbranch_scc1 L_fin
    s_branch L_slow_w5
.p2align 6
L_loop_w4:
    v_mfma_f32_16x16x32_bf16 v[8:11], a[80:83], a[0:3], v[16:19]
    s_add_u32 s30, s30, 4096
    v_exp_f32 v82, v82
    v_mfma_f32_16x16x32_bf16 v[8:11], a[84:87], a[4:7], v[8:11]
    ds_read_b64_tr_b16 a[148:149], v47 offset:0
    ds_read_b64_tr_b16 a[150:151], v47 offset:4096
    v_mfma_f32_16x16x32_bf16 v[8:11], a[88:91], a[8:11], v[8:11]
    v_exp_f32 v83, v83
    v_mfma_f32_16x16x32_bf16 v[8:11], a[92:95], a[12:15], v[8:11]
    ds_read_b64_tr_b16 a[180:181], v47 offset:8192
    v_cvt_pk_bf16_f32 v68, v82, v83
    v_mfma_f32_16x16x32_bf16 v[12:15], a[108:111], a[12:15], v[16:19]
    s_bitcmp0_b32 s88, s29
    s_cbranch_scc1 L_nogrow0
    s_waitcnt vmcnt(23)
    s_and_b32 m0, s30, 0xffff
    s_nop 0
    buffer_load_dwordx4 v90, s[16:19], s30 offen offset:0 nt lds
    buffer_load_dwordx4 v91, s[16:19], s30 offen offset:1024 nt lds
    buffer_load_dwordx4 v92, s[16:19], s30 offen offset:2048 nt lds
    buffer_load_dwordx4 v93, s[16:19], s30 offen offset:3072 nt lds
    s_waitcnt vmcnt(23)
    s_bitset1_b32 m0, 16
    s_nop 0
    buffer_load_dwordx4 v94, s[20:23], s30 offen offset:0 nt lds
    buffer_load_dwordx4 v95, s[20:23], s30 offen offset:1024 nt lds
    buffer_load_dwordx4 v94, s[20:23], s30 offen offset:2048 nt lds
    buffer_load_dwordx4 v95, s[20:23], s30 offen offset:3072 nt lds
    s_add_u32 s30, s30, 4096
    s_add_u32 s47, s47, 1
L_nogrow0:
    v_exp_f32 v84, v84
    v_mfma_f32_16x16x32_bf16 v[12:15], a[104:107], a[8:11], v[12:15]
    s_waitcnt vmcnt(23)
    ds_read_b64_tr_b16 a[182:183], v47 offset:12288
    ds_read_b64_tr_b16 a[160:161], v50 offset:0
    v_mfma_f32_16x16x32_bf16 v[12:15], a[100:103], a[4:7], v[12:15]
    s_and_b32 m0, s30, 0xffff
    v_exp_f32 v85, v85
    v_mfma_f32_16x16x32_bf16 v[12:15], a[96:99], a[0:3], v[12:15]
    buffer_load_dwordx4 v90, s[16:19], s30 offen offset:0 nt lds
    v_cvt_pk_bf16_f32 v69, v84, v85
    v_mfma_f32_16x16x32_bf16 v[78:81], a[112:115], a[0:3], v[16:19]
    v_exp_f32 v8, v8
    v_mfma_f32_16x16x32_bf16 v[78:81], a[116:119], a[4:7], v[78:81]
    s_waitcnt lgkmcnt(5)
    buffer_load_dwordx4 v91, s[16:19], s30 offen offset:1024 nt lds
    ds_read_b64_tr_b16 a[162:163], v50 offset:4096
    v_mfma_f32_16x16x32_bf16 v[78:81], a[120:123], a[8:11], v[78:81]
    v_exp_f32 v9, v9
    v_mfma_f32_16x16x32_bf16 v[78:81], a[124:127], a[12:15], v[78:81]
    ds_read_b64_tr_b16 a[192:193], v50 offset:8192
    v_cvt_pk_bf16_f32 v54, v8, v9
    v_mfma_f32_16x16x32_bf16 v[82:85], a[140:143], a[12:15], v[16:19]
    v_exp_f32 v10, v10
    v_mfma_f32_16x16x32_bf16 v[82:85], a[136:139], a[8:11], v[82:85]
    buffer_load_dwordx4 v92, s[16:19], s30 offen offset:2048 nt lds
    ds_read_b64_tr_b16 a[194:195], v50 offset:12288
    v_mfma_f32_16x16x32_bf16 v[82:85], a[132:135], a[4:7], v[82:85]
    v_exp_f32 v11, v11
    v_mfma_f32_16x16x32_bf16 v[82:85], a[128:131], a[0:3], v[82:85]
    ds_read_b64_tr_b16 a[164:165], v51 offset:0
    v_cvt_pk_bf16_f32 v55, v10, v11
    v_smfmac_f32_16x16x64_bf16 a[76:79], a[208:211], v[62:69], v41
    v_mfma_f32_16x16x32_bf16 v[192:195], v[62:65], a[212:215], v[192:195]
    v_exp_f32 v12, v12
    v_mfma_f32_16x16x32_bf16 v[192:195], v[66:69], a[216:219], v[192:195]
    buffer_load_dwordx4 v93, s[16:19], s30 offen offset:3072 nt lds
    ds_read_b64_tr_b16 a[166:167], v51 offset:4096
    v_mfma_f32_16x16x32_bf16 v[196:199], v[62:65], a[220:223], v[196:199]
    s_waitcnt vmcnt(23)
    v_exp_f32 v13, v13
    v_mfma_f32_16x16x32_bf16 v[196:199], v[66:69], a[224:227], v[196:199]
    s_bitset1_b32 m0, 16
    ds_read_b64_tr_b16 a[196:197], v51 offset:8192
    v_cvt_pk_bf16_f32 v56, v12, v13
    v_mfma_f32_16x16x32_bf16 v[200:203], v[62:65], a[152:155], v[200:203]
    v_exp_f32 v14, v14
    v_mfma_f32_16x16x32_bf16 v[200:203], v[66:69], a[184:187], v[200:203]
    buffer_load_dwordx4 v94, s[20:23], s30 offen offset:0 nt lds
    ds_read_b64_tr_b16 a[152:153], v48 offset:0
    v_mfma_f32_16x16x32_bf16 v[204:207], v[62:65], a[156:159], v[204:207]
    v_exp_f32 v15, v15
    v_mfma_f32_16x16x32_bf16 v[204:207], v[66:69], a[188:191], v[204:207]
    ds_read_b64_tr_b16 a[154:155], v48 offset:4096
    v_cvt_pk_bf16_f32 v57, v14, v15
    v_mfma_f32_16x16x32_bf16 v[208:211], v[62:65], a[228:231], v[208:211]
    v_exp_f32 v78, v78
    v_mfma_f32_16x16x32_bf16 v[208:211], v[66:69], a[232:235], v[208:211]
    buffer_load_dwordx4 v95, s[20:23], s30 offen offset:1024 nt lds
    ds_read_b64_tr_b16 a[184:185], v48 offset:8192
    v_mfma_f32_16x16x32_bf16 v[212:215], v[62:65], a[236:239], v[212:215]
    v_exp_f32 v79, v79
    v_mfma_f32_16x16x32_bf16 v[212:215], v[66:69], a[240:243], v[212:215]
    ds_read_b64_tr_b16 a[186:187], v48 offset:12288
    v_cvt_pk_bf16_f32 v58, v78, v79
    v_mfma_f32_16x16x32_bf16 v[216:219], v[62:65], a[168:171], v[216:219]
    v_exp_f32 v80, v80
    v_mfma_f32_16x16x32_bf16 v[216:219], v[66:69], a[200:203], v[216:219]
    buffer_load_dwordx4 v94, s[20:23], s30 offen offset:2048 nt lds
    ds_read_b64_tr_b16 a[156:157], v49 offset:0
    v_mfma_f32_16x16x32_bf16 v[220:223], v[62:65], a[172:175], v[220:223]
    v_exp_f32 v81, v81
    v_mfma_f32_16x16x32_bf16 v[220:223], v[66:69], a[204:207], v[220:223]
    ds_read_b64_tr_b16 a[158:159], v49 offset:4096
    v_cvt_pk_bf16_f32 v59, v80, v81
    v_mfma_f32_16x16x32_bf16 v[8:11], a[80:83], a[16:19], v[20:23]
    v_exp_f32 v82, v82
    v_mfma_f32_16x16x32_bf16 v[8:11], a[84:87], a[20:23], v[8:11]
    buffer_load_dwordx4 v95, s[20:23], s30 offen offset:3072 nt lds
    ds_read_b64_tr_b16 a[188:189], v49 offset:8192
    v_mfma_f32_16x16x32_bf16 v[8:11], a[88:91], a[24:27], v[8:11]
    s_add_u32 s30, s30, 4096
    v_exp_f32 v83, v83
    v_mfma_f32_16x16x32_bf16 v[8:11], a[92:95], a[28:31], v[8:11]
    s_waitcnt vmcnt(23)
    ds_read_b64_tr_b16 a[190:191], v49 offset:12288
    v_cvt_pk_bf16_f32 v60, v82, v83
    v_mfma_f32_16x16x32_bf16 v[12:15], a[108:111], a[28:31], v[20:23]
    s_and_b32 m0, s30, 0xffff
    v_exp_f32 v84, v84
    v_mfma_f32_16x16x32_bf16 v[12:15], a[104:107], a[24:27], v[12:15]
    buffer_load_dwordx4 v90, s[16:19], s30 offen offset:0 nt lds
    ds_read_b64_tr_b16 a[168:169], v52 offset:0
    v_mfma_f32_16x16x32_bf16 v[12:15], a[100:103], a[20:23], v[12:15]
    v_exp_f32 v85, v85
    v_mfma_f32_16x16x32_bf16 v[12:15], a[96:99], a[16:19], v[12:15]
    ds_read_b64_tr_b16 a[170:171], v52 offset:4096
    v_cvt_pk_bf16_f32 v61, v84, v85
    v_mfma_f32_16x16x32_bf16 v[78:81], a[112:115], a[16:19], v[20:23]
    v_exp_f32 v8, v8
    v_mfma_f32_16x16x32_bf16 v[78:81], a[116:119], a[20:23], v[78:81]
    buffer_load_dwordx4 v91, s[16:19], s30 offen offset:1024 nt lds
    ds_read_b64_tr_b16 a[200:201], v52 offset:8192
    v_mfma_f32_16x16x32_bf16 v[78:81], a[120:123], a[24:27], v[78:81]
    v_exp_f32 v9, v9
    v_mfma_f32_16x16x32_bf16 v[78:81], a[124:127], a[28:31], v[78:81]
    ds_read_b64_tr_b16 a[202:203], v52 offset:12288
    v_cvt_pk_bf16_f32 v62, v8, v9
    v_mfma_f32_16x16x32_bf16 v[82:85], a[140:143], a[28:31], v[20:23]
    v_exp_f32 v10, v10
    v_mfma_f32_16x16x32_bf16 v[82:85], a[136:139], a[24:27], v[82:85]
    buffer_load_dwordx4 v92, s[16:19], s30 offen offset:2048 nt lds
    ds_read_b64_tr_b16 a[172:173], v53 offset:0
    v_mfma_f32_16x16x32_bf16 v[82:85], a[132:135], a[20:23], v[82:85]
    v_exp_f32 v11, v11
    v_mfma_f32_16x16x32_bf16 v[82:85], a[128:131], a[16:19], v[82:85]
    ds_read_b64_tr_b16 a[174:175], v53 offset:4096
    ds_read_b64_tr_b16 a[198:199], v51 offset:12288
    v_cvt_pk_bf16_f32 v63, v10, v11
    v_smfmac_f32_16x16x64_bf16 a[64:67], a[208:211], v[54:61], v41
    v_mfma_f32_16x16x32_bf16 v[96:99], v[54:57], a[144:147], v[96:99]
    v_exp_f32 v12, v12
    v_mfma_f32_16x16x32_bf16 v[96:99], v[58:61], a[176:179], v[96:99]
    s_waitcnt lgkmcnt(5)
    buffer_load_dwordx4 v93, s[16:19], s30 offen offset:3072 nt lds
    ds_read_b64_tr_b16 a[204:205], v53 offset:8192
    v_mfma_f32_16x16x32_bf16 v[100:103], v[54:57], a[148:151], v[100:103]
    s_waitcnt vmcnt(23)
    v_exp_f32 v13, v13
    v_mfma_f32_16x16x32_bf16 v[100:103], v[58:61], a[180:183], v[100:103]
    s_bitset1_b32 m0, 16
    ds_read_b64_tr_b16 a[206:207], v53 offset:12288
    v_cvt_pk_bf16_f32 v64, v12, v13
    v_mfma_f32_16x16x32_bf16 v[104:107], v[54:57], a[152:155], v[104:107]
    v_exp_f32 v14, v14
    v_mfma_f32_16x16x32_bf16 v[104:107], v[58:61], a[184:187], v[104:107]
    buffer_load_dwordx4 v94, s[20:23], s30 offen offset:0 nt lds
    v_mfma_f32_16x16x32_bf16 v[108:111], v[54:57], a[156:159], v[108:111]
    v_exp_f32 v15, v15
    v_mfma_f32_16x16x32_bf16 v[108:111], v[58:61], a[188:191], v[108:111]
    v_cvt_pk_bf16_f32 v65, v14, v15
    v_mfma_f32_16x16x32_bf16 v[112:115], v[54:57], a[160:163], v[112:115]
    v_exp_f32 v78, v78
    v_mfma_f32_16x16x32_bf16 v[112:115], v[58:61], a[192:195], v[112:115]
    buffer_load_dwordx4 v95, s[20:23], s30 offen offset:1024 nt lds
    v_mfma_f32_16x16x32_bf16 v[116:119], v[54:57], a[164:167], v[116:119]
    s_waitcnt lgkmcnt(2)
    v_exp_f32 v79, v79
    v_mfma_f32_16x16x32_bf16 v[116:119], v[58:61], a[196:199], v[116:119]
    v_cvt_pk_bf16_f32 v66, v78, v79
    v_mfma_f32_16x16x32_bf16 v[120:123], v[54:57], a[168:171], v[120:123]
    v_exp_f32 v80, v80
    v_mfma_f32_16x16x32_bf16 v[120:123], v[58:61], a[200:203], v[120:123]
    buffer_load_dwordx4 v94, s[20:23], s30 offen offset:2048 nt lds
    v_mfma_f32_16x16x32_bf16 v[124:127], v[54:57], a[172:175], v[124:127]
    s_waitcnt lgkmcnt(0)
    v_exp_f32 v81, v81
    v_mfma_f32_16x16x32_bf16 v[124:127], v[58:61], a[204:207], v[124:127]
    v_cvt_pk_bf16_f32 v67, v80, v81
    v_mfma_f32_16x16x32_bf16 v[8:11], a[80:83], a[32:35], v[24:27]
    v_exp_f32 v82, v82
    v_mfma_f32_16x16x32_bf16 v[8:11], a[84:87], a[36:39], v[8:11]
    buffer_load_dwordx4 v95, s[20:23], s30 offen offset:3072 nt lds
    v_mfma_f32_16x16x32_bf16 v[8:11], a[88:91], a[40:43], v[8:11]
    s_add_u32 s30, s30, 4096
    v_exp_f32 v83, v83
    v_mfma_f32_16x16x32_bf16 v[8:11], a[92:95], a[44:47], v[8:11]
    s_waitcnt vmcnt(23)
    v_cvt_pk_bf16_f32 v68, v82, v83
    v_mfma_f32_16x16x32_bf16 v[12:15], a[108:111], a[44:47], v[24:27]
    s_and_b32 m0, s30, 0xffff
    v_exp_f32 v84, v84
    v_mfma_f32_16x16x32_bf16 v[12:15], a[104:107], a[40:43], v[12:15]
    buffer_load_dwordx4 v90, s[16:19], s30 offen offset:0 nt lds
    v_mfma_f32_16x16x32_bf16 v[12:15], a[100:103], a[36:39], v[12:15]
    v_exp_f32 v85, v85
    v_mfma_f32_16x16x32_bf16 v[12:15], a[96:99], a[32:35], v[12:15]
    v_cvt_pk_bf16_f32 v69, v84, v85
    v_mfma_f32_16x16x32_bf16 v[78:81], a[112:115], a[32:35], v[24:27]
    v_exp_f32 v8, v8
    v_mfma_f32_16x16x32_bf16 v[78:81], a[116:119], a[36:39], v[78:81]
    buffer_load_dwordx4 v91, s[16:19], s30 offen offset:1024 nt lds
    v_mfma_f32_16x16x32_bf16 v[78:81], a[120:123], a[40:43], v[78:81]
    v_exp_f32 v9, v9
    v_mfma_f32_16x16x32_bf16 v[78:81], a[124:127], a[44:47], v[78:81]
    v_cvt_pk_bf16_f32 v54, v8, v9
    v_mfma_f32_16x16x32_bf16 v[82:85], a[140:143], a[44:47], v[24:27]
    v_exp_f32 v10, v10
    v_mfma_f32_16x16x32_bf16 v[82:85], a[136:139], a[40:43], v[82:85]
    buffer_load_dwordx4 v92, s[16:19], s30 offen offset:2048 nt lds
    v_mfma_f32_16x16x32_bf16 v[82:85], a[132:135], a[36:39], v[82:85]
    v_exp_f32 v11, v11
    v_mfma_f32_16x16x32_bf16 v[82:85], a[128:131], a[32:35], v[82:85]
    v_cvt_pk_bf16_f32 v55, v10, v11
    v_smfmac_f32_16x16x64_bf16 a[68:71], a[208:211], v[62:69], v41
    v_mfma_f32_16x16x32_bf16 v[128:131], v[62:65], a[144:147], v[128:131]
    v_exp_f32 v12, v12
    v_mfma_f32_16x16x32_bf16 v[128:131], v[66:69], a[176:179], v[128:131]
    buffer_load_dwordx4 v93, s[16:19], s30 offen offset:3072 nt lds
    v_mfma_f32_16x16x32_bf16 v[132:135], v[62:65], a[148:151], v[132:135]
    s_waitcnt vmcnt(23)
    v_exp_f32 v13, v13
    v_mfma_f32_16x16x32_bf16 v[132:135], v[66:69], a[180:183], v[132:135]
    s_bitset1_b32 m0, 16
    v_cvt_pk_bf16_f32 v56, v12, v13
    v_mfma_f32_16x16x32_bf16 v[136:139], v[62:65], a[152:155], v[136:139]
    v_exp_f32 v14, v14
    v_mfma_f32_16x16x32_bf16 v[136:139], v[66:69], a[184:187], v[136:139]
    buffer_load_dwordx4 v94, s[20:23], s30 offen offset:0 nt lds
    v_mfma_f32_16x16x32_bf16 v[140:143], v[62:65], a[156:159], v[140:143]
    v_exp_f32 v15, v15
    v_mfma_f32_16x16x32_bf16 v[140:143], v[66:69], a[188:191], v[140:143]
    s_cmp_gt_u32 s47, 2
    s_cbranch_scc1 L_nw1
    s_waitcnt vmcnt(21)
    s_cmp_gt_u32 s47, 1
    s_cbranch_scc1 L_nw1
    s_waitcnt vmcnt(13)
    s_cmp_gt_u32 s47, 0
    s_cbranch_scc1 L_nw1
    s_waitcnt vmcnt(5)
L_nw1:
    v_cvt_pk_bf16_f32 v57, v14, v15
    v_mfma_f32_16x16x32_bf16 v[144:147], v[62:65], a[160:163], v[144:147]
    s_barrier
    v_exp_f32 v78, v78
    v_mfma_f32_16x16x32_bf16 v[144:147], v[66:69], a[192:195], v[144:147]
    buffer_load_dwordx4 v95, s[20:23], s30 offen offset:1024 nt lds
    ds_read_b64_tr_b16 a[212:213], v46 offset:16384
    v_mfma_f32_16x16x32_bf16 v[148:151], v[62:65], a[164:167], v[148:151]
    v_exp_f32 v79, v79
    v_mfma_f32_16x16x32_bf16 v[148:151], v[66:69], a[196:199], v[148:151]
    ds_read_b64_tr_b16 a[214:215], v46 offset:20480
    v_cvt_pk_bf16_f32 v58, v78, v79
    v_mfma_f32_16x16x32_bf16 v[152:155], v[62:65], a[168:171], v[152:155]
    v_exp_f32 v80, v80
    v_mfma_f32_16x16x32_bf16 v[152:155], v[66:69], a[200:203], v[152:155]
    buffer_load_dwordx4 v94, s[20:23], s30 offen offset:2048 nt lds
    ds_read_b64_tr_b16 a[216:217], v46 offset:24576
    v_mfma_f32_16x16x32_bf16 v[156:159], v[62:65], a[172:175], v[156:159]
    v_exp_f32 v81, v81
    v_mfma_f32_16x16x32_bf16 v[156:159], v[66:69], a[204:207], v[156:159]
    ds_read_b64_tr_b16 a[218:219], v46 offset:28672
    v_cvt_pk_bf16_f32 v59, v80, v81
    v_mfma_f32_16x16x32_bf16 v[8:11], a[80:83], a[48:51], v[28:31]
    v_exp_f32 v82, v82
    v_mfma_f32_16x16x32_bf16 v[8:11], a[84:87], a[52:55], v[8:11]
    buffer_load_dwordx4 v95, s[20:23], s30 offen offset:3072 nt lds
    ds_read_b128 a[80:83], v42 offset:16384
    v_mfma_f32_16x16x32_bf16 v[8:11], a[88:91], a[56:59], v[8:11]
    s_add_u32 s30, s30, 4096
    v_exp_f32 v83, v83
    v_mfma_f32_16x16x32_bf16 v[8:11], a[92:95], a[60:63], v[8:11]
    s_waitcnt vmcnt(23)
    ds_read_b128 a[84:87], v43 offset:16384
    v_cvt_pk_bf16_f32 v60, v82, v83
    v_mfma_f32_16x16x32_bf16 v[12:15], a[108:111], a[60:63], v[28:31]
    s_and_b32 m0, s30, 0xffff
    v_exp_f32 v84, v84
    v_mfma_f32_16x16x32_bf16 v[12:15], a[104:107], a[56:59], v[12:15]
    buffer_load_dwordx4 v90, s[16:19], s30 offen offset:0 nt lds
    ds_read_b128 a[88:91], v44 offset:16384
    v_mfma_f32_16x16x32_bf16 v[12:15], a[100:103], a[52:55], v[12:15]
    v_exp_f32 v85, v85
    v_mfma_f32_16x16x32_bf16 v[12:15], a[96:99], a[48:51], v[12:15]
    ds_read_b128 a[92:95], v45 offset:16384
    v_cvt_pk_bf16_f32 v61, v84, v85
    v_mfma_f32_16x16x32_bf16 v[78:81], a[112:115], a[48:51], v[28:31]
    v_exp_f32 v8, v8
    v_mfma_f32_16x16x32_bf16 v[78:81], a[116:119], a[52:55], v[78:81]
    buffer_load_dwordx4 v91, s[16:19], s30 offen offset:1024 nt lds
    ds_read_b128 a[108:111], v45 offset:20480
    v_mfma_f32_16x16x32_bf16 v[78:81], a[120:123], a[56:59], v[78:81]
    v_exp_f32 v9, v9
    v_mfma_f32_16x16x32_bf16 v[78:81], a[124:127], a[60:63], v[78:81]
    ds_read_b128 a[104:107], v44 offset:20480
    v_cvt_pk_bf16_f32 v62, v8, v9
    v_mfma_f32_16x16x32_bf16 v[82:85], a[140:143], a[60:63], v[28:31]
    v_exp_f32 v10, v10
    v_mfma_f32_16x16x32_bf16 v[82:85], a[136:139], a[56:59], v[82:85]
    buffer_load_dwordx4 v92, s[16:19], s30 offen offset:2048 nt lds
    ds_read_b128 a[100:103], v43 offset:20480
    v_mfma_f32_16x16x32_bf16 v[82:85], a[132:135], a[52:55], v[82:85]
    v_exp_f32 v11, v11
    v_mfma_f32_16x16x32_bf16 v[82:85], a[128:131], a[48:51], v[82:85]
    ds_read_b128 a[96:99], v42 offset:20480
    v_cvt_pk_bf16_f32 v63, v10, v11
    v_smfmac_f32_16x16x64_bf16 a[72:75], a[208:211], v[54:61], v41
    v_mfma_f32_16x16x32_bf16 v[160:163], v[54:57], a[144:147], v[160:163]
    v_exp_f32 v12, v12
    v_mfma_f32_16x16x32_bf16 v[160:163], v[58:61], a[176:179], v[160:163]
    buffer_load_dwordx4 v93, s[16:19], s30 offen offset:3072 nt lds
    ds_read_b128 a[112:115], v42 offset:24576
    v_mfma_f32_16x16x32_bf16 v[164:167], v[54:57], a[148:151], v[164:167]
    s_waitcnt vmcnt(23)
    v_exp_f32 v13, v13
    v_mfma_f32_16x16x32_bf16 v[164:167], v[58:61], a[180:183], v[164:167]
    s_bitset1_b32 m0, 16
    ds_read_b128 a[116:119], v43 offset:24576
    v_cvt_pk_bf16_f32 v64, v12, v13
    v_mfma_f32_16x16x32_bf16 v[168:171], v[54:57], a[152:155], v[168:171]
    v_exp_f32 v14, v14
    v_mfma_f32_16x16x32_bf16 v[168:171], v[58:61], a[184:187], v[168:171]
    buffer_load_dwordx4 v94, s[20:23], s30 offen offset:0 nt lds
    ds_read_b128 a[120:123], v44 offset:24576
    v_mfma_f32_16x16x32_bf16 v[172:175], v[54:57], a[156:159], v[172:175]
    v_exp_f32 v15, v15
    v_mfma_f32_16x16x32_bf16 v[172:175], v[58:61], a[188:191], v[172:175]
    ds_read_b128 a[124:127], v45 offset:24576
    v_cvt_pk_bf16_f32 v65, v14, v15
    v_mfma_f32_16x16x32_bf16 v[176:179], v[54:57], a[160:163], v[176:179]
    v_exp_f32 v78, v78
    v_mfma_f32_16x16x32_bf16 v[176:179], v[58:61], a[192:195], v[176:179]
    buffer_load_dwordx4 v95, s[20:23], s30 offen offset:1024 nt lds
    ds_read_b128 a[140:143], v45 offset:28672
    v_mfma_f32_16x16x32_bf16 v[180:183], v[54:57], a[164:167], v[180:183]
    v_exp_f32 v79, v79
    v_mfma_f32_16x16x32_bf16 v[180:183], v[58:61], a[196:199], v[180:183]
    ds_read_b128 a[136:139], v44 offset:28672
    v_cvt_pk_bf16_f32 v66, v78, v79
    v_mfma_f32_16x16x32_bf16 v[184:187], v[54:57], a[168:171], v[184:187]
    v_exp_f32 v80, v80
    v_mfma_f32_16x16x32_bf16 v[184:187], v[58:61], a[200:203], v[184:187]
    buffer_load_dwordx4 v94, s[20:23], s30 offen offset:2048 nt lds
    ds_read_b128 a[132:135], v43 offset:28672
    v_mfma_f32_16x16x32_bf16 v[188:191], v[54:57], a[172:175], v[188:191]
    v_exp_f32 v81, v81
    v_mfma_f32_16x16x32_bf16 v[188:191], v[58:61], a[204:207], v[188:191]
    s_waitcnt lgkmcnt(5)
    ds_read_b128 a[128:131], v42 offset:28672
    v_cvt_pk_bf16_f32 v67, v80, v81
L_entry_w4:
    v_mfma_f32_16x16x32_bf16 v[8:11], a[80:83], a[0:3], v[16:19]
    v_exp_f32 v82, v82
    v_mfma_f32_16x16x32_bf16 v[8:11], a[84:87], a[4:7], v[8:11]
    buffer_load_dwordx4 v95, s[20:23], s30 offen offset:3072 nt lds
    ds_read_b64_tr_b16 a[220:221], v47 offset:16384
    v_mfma_f32_16x16x32_bf16 v[8:11], a[88:91], a[8:11], v[8:11]
    s_add_u32 s30, s30, 4096
    v_exp_f32 v83, v83
    v_mfma_f32_16x16x32_bf16 v[8:11], a[92:95], a[12:15], v[8:11]
    s_waitcnt vmcnt(23)
    ds_read_b64_tr_b16 a[222:223], v47 offset:20480
    v_cvt_pk_bf16_f32 v68, v82, v83
    v_mfma_f32_16x16x32_bf16 v[12:15], a[108:111], a[12:15], v[16:19]
    s_and_b32 m0, s30, 0xffff
    v_exp_f32 v84, v84
    v_mfma_f32_16x16x32_bf16 v[12:15], a[104:107], a[8:11], v[12:15]
    buffer_load_dwordx4 v90, s[16:19], s30 offen offset:0 nt lds
    ds_read_b64_tr_b16 a[224:225], v47 offset:24576
    v_mfma_f32_16x16x32_bf16 v[12:15], a[100:103], a[4:7], v[12:15]
    v_exp_f32 v85, v85
    v_mfma_f32_16x16x32_bf16 v[12:15], a[96:99], a[0:3], v[12:15]
    ds_read_b64_tr_b16 a[226:227], v47 offset:28672
    v_cvt_pk_bf16_f32 v69, v84, v85
    v_mfma_f32_16x16x32_bf16 v[78:81], a[112:115], a[0:3], v[16:19]
    v_exp_f32 v8, v8
    v_mfma_f32_16x16x32_bf16 v[78:81], a[116:119], a[4:7], v[78:81]
    s_waitcnt lgkmcnt(5)
    buffer_load_dwordx4 v91, s[16:19], s30 offen offset:1024 nt lds
    ds_read_b64_tr_b16 a[228:229], v50 offset:16384
    v_mfma_f32_16x16x32_bf16 v[78:81], a[120:123], a[8:11], v[78:81]
    v_exp_f32 v9, v9
    v_mfma_f32_16x16x32_bf16 v[78:81], a[124:127], a[12:15], v[78:81]
    ds_read_b64_tr_b16 a[230:231], v50 offset:20480
    v_cvt_pk_bf16_f32 v54, v8, v9
    v_mfma_f32_16x16x32_bf16 v[82:85], a[140:143], a[12:15], v[16:19]
    v_exp_f32 v10, v10
    v_mfma_f32_16x16x32_bf16 v[82:85], a[136:139], a[8:11], v[82:85]
    buffer_load_dwordx4 v92, s[16:19], s30 offen offset:2048 nt lds
    ds_read_b64_tr_b16 a[232:233], v50 offset:24576
    v_mfma_f32_16x16x32_bf16 v[82:85], a[132:135], a[4:7], v[82:85]
    s_waitcnt lgkmcnt(5)
    v_exp_f32 v11, v11
    v_mfma_f32_16x16x32_bf16 v[82:85], a[128:131], a[0:3], v[82:85]
    ds_read_b64_tr_b16 a[234:235], v50 offset:28672
    v_cvt_pk_bf16_f32 v55, v10, v11
    v_smfmac_f32_16x16x64_bf16 a[76:79], a[208:211], v[62:69], v41
    v_mfma_f32_16x16x32_bf16 v[192:195], v[62:65], a[144:147], v[192:195]
    v_exp_f32 v12, v12
    v_mfma_f32_16x16x32_bf16 v[192:195], v[66:69], a[176:179], v[192:195]
    buffer_load_dwordx4 v93, s[16:19], s30 offen offset:3072 nt lds
    ds_read_b64_tr_b16 a[236:237], v51 offset:16384
    v_mfma_f32_16x16x32_bf16 v[196:199], v[62:65], a[148:151], v[196:199]
    s_waitcnt vmcnt(23)
    v_exp_f32 v13, v13
    v_mfma_f32_16x16x32_bf16 v[196:199], v[66:69], a[180:183], v[196:199]
    s_bitset1_b32 m0, 16
    ds_read_b64_tr_b16 a[238:239], v51 offset:20480
    v_cvt_pk_bf16_f32 v56, v12, v13
    v_mfma_f32_16x16x32_bf16 v[200:203], v[62:65], a[152:155], v[200:203]
    v_exp_f32 v14, v14
    v_mfma_f32_16x16x32_bf16 v[200:203], v[66:69], a[184:187], v[200:203]
    buffer_load_dwordx4 v94, s[20:23], s30 offen offset:0 nt lds
    ds_read_b64_tr_b16 a[152:153], v48 offset:16384
    v_mfma_f32_16x16x32_bf16 v[204:207], v[62:65], a[156:159], v[204:207]
    v_exp_f32 v15, v15
    v_mfma_f32_16x16x32_bf16 v[204:207], v[66:69], a[188:191], v[204:207]
    ds_read_b64_tr_b16 a[154:155], v48 offset:20480
    v_cvt_pk_bf16_f32 v57, v14, v15
    v_mfma_f32_16x16x32_bf16 v[208:211], v[62:65], a[160:163], v[208:211]
    v_exp_f32 v78, v78
    v_mfma_f32_16x16x32_bf16 v[208:211], v[66:69], a[192:195], v[208:211]
    buffer_load_dwordx4 v95, s[20:23], s30 offen offset:1024 nt lds
    ds_read_b64_tr_b16 a[184:185], v48 offset:24576
    v_mfma_f32_16x16x32_bf16 v[212:215], v[62:65], a[164:167], v[212:215]
    v_exp_f32 v79, v79
    v_mfma_f32_16x16x32_bf16 v[212:215], v[66:69], a[196:199], v[212:215]
    ds_read_b64_tr_b16 a[186:187], v48 offset:28672
    v_cvt_pk_bf16_f32 v58, v78, v79
    v_mfma_f32_16x16x32_bf16 v[216:219], v[62:65], a[168:171], v[216:219]
    v_exp_f32 v80, v80
    v_mfma_f32_16x16x32_bf16 v[216:219], v[66:69], a[200:203], v[216:219]
    buffer_load_dwordx4 v94, s[20:23], s30 offen offset:2048 nt lds
    ds_read_b64_tr_b16 a[156:157], v49 offset:16384
    v_mfma_f32_16x16x32_bf16 v[220:223], v[62:65], a[172:175], v[220:223]
    v_exp_f32 v81, v81
    v_mfma_f32_16x16x32_bf16 v[220:223], v[66:69], a[204:207], v[220:223]
    ds_read_b64_tr_b16 a[158:159], v49 offset:20480
    v_cvt_pk_bf16_f32 v59, v80, v81
    v_mfma_f32_16x16x32_bf16 v[8:11], a[80:83], a[16:19], v[20:23]
    v_exp_f32 v82, v82
    v_mfma_f32_16x16x32_bf16 v[8:11], a[84:87], a[20:23], v[8:11]
    buffer_load_dwordx4 v95, s[20:23], s30 offen offset:3072 nt lds
    ds_read_b64_tr_b16 a[188:189], v49 offset:24576
    v_mfma_f32_16x16x32_bf16 v[8:11], a[88:91], a[24:27], v[8:11]
    s_add_u32 s30, s30, 4096
    v_exp_f32 v83, v83
    v_mfma_f32_16x16x32_bf16 v[8:11], a[92:95], a[28:31], v[8:11]
    s_bitcmp0_b32 s89, s29
    s_cbranch_scc1 L_nogrow1
    s_waitcnt vmcnt(23)
    s_and_b32 m0, s30, 0xffff
    s_nop 0
    buffer_load_dwordx4 v90, s[16:19], s30 offen offset:0 nt lds
    buffer_load_dwordx4 v91, s[16:19], s30 offen offset:1024 nt lds
    buffer_load_dwordx4 v92, s[16:19], s30 offen offset:2048 nt lds
    buffer_load_dwordx4 v93, s[16:19], s30 offen offset:3072 nt lds
    s_waitcnt vmcnt(23)
    s_bitset1_b32 m0, 16
    s_nop 0
    buffer_load_dwordx4 v94, s[20:23], s30 offen offset:0 nt lds
    buffer_load_dwordx4 v95, s[20:23], s30 offen offset:1024 nt lds
    buffer_load_dwordx4 v94, s[20:23], s30 offen offset:2048 nt lds
    buffer_load_dwordx4 v95, s[20:23], s30 offen offset:3072 nt lds
    s_add_u32 s30, s30, 4096
    s_add_u32 s47, s47, 1
L_nogrow1:
    ds_read_b64_tr_b16 a[190:191], v49 offset:28672
    v_cvt_pk_bf16_f32 v60, v82, v83
    v_mfma_f32_16x16x32_bf16 v[12:15], a[108:111], a[28:31], v[20:23]
    s_waitcnt vmcnt(23)
    v_exp_f32 v84, v84
    v_mfma_f32_16x16x32_bf16 v[12:15], a[104:107], a[24:27], v[12:15]
    s_and_b32 m0, s30, 0xffff
    ds_read_b64_tr_b16 a[168:169], v52 offset:16384
    ds_read_b64_tr_b16 a[170:171], v52 offset:20480
    v_mfma_f32_16x16x32_bf16 v[12:15], a[100:103], a[20:23], v[12:15]
    v_exp_f32 v85, v85
    v_mfma_f32_16x16x32_bf16 v[12:15], a[96:99], a[16:19], v[12:15]
    buffer_load_dwordx4 v90, s[16:19], s30 offen offset:0 nt lds
    v_cvt_pk_bf16_f32 v61, v84, v85
    v_mfma_f32_16x16x32_bf16 v[78:81], a[112:115], a[16:19], v[20:23]
    v_exp_f32 v8, v8
    v_mfma_f32_16x16x32_bf16 v[78:81], a[116:119], a[20:23], v[78:81]
    buffer_load_dwordx4 v91, s[16:19], s30 offen offset:1024 nt lds
    ds_read_b64_tr_b16 a[200:201], v52 offset:24576
    v_mfma_f32_16x16x32_bf16 v[78:81], a[120:123], a[24:27], v[78:81]
    v_exp_f32 v9, v9
    v_mfma_f32_16x16x32_bf16 v[78:81], a[124:127], a[28:31], v[78:81]
    ds_read_b64_tr_b16 a[202:203], v52 offset:28672
    v_cvt_pk_bf16_f32 v62, v8, v9
    v_mfma_f32_16x16x32_bf16 v[82:85], a[140:143], a[28:31], v[20:23]
    v_exp_f32 v10, v10
    v_mfma_f32_16x16x32_bf16 v[82:85], a[136:139], a[24:27], v[82:85]
    buffer_load_dwordx4 v92, s[16:19], s30 offen offset:2048 nt lds
    ds_read_b64_tr_b16 a[172:173], v53 offset:16384
    ds_read_b64_tr_b16 a[242:243], v51 offset:28672
    v_mfma_f32_16x16x32_bf16 v[82:85], a[132:135], a[20:23], v[82:85]
    v_exp_f32 v11, v11
    v_mfma_f32_16x16x32_bf16 v[82:85], a[128:131], a[16:19], v[82:85]
    ds_read_b64_tr_b16 a[174:175], v53 offset:20480
    ds_read_b64_tr_b16 a[240:241], v51 offset:24576
    v_cvt_pk_bf16_f32 v63, v10, v11
    v_smfmac_f32_16x16x64_bf16 a[64:67], a[208:211], v[54:61], v41
    v_mfma_f32_16x16x32_bf16 v[96:99], v[54:57], a[212:215], v[96:99]
    v_exp_f32 v12, v12
    v_mfma_f32_16x16x32_bf16 v[96:99], v[58:61], a[216:219], v[96:99]
    buffer_load_dwordx4 v93, s[16:19], s30 offen offset:3072 nt lds
    ds_read_b64_tr_b16 a[204:205], v53 offset:24576
    v_mfma_f32_16x16x32_bf16 v[100:103], v[54:57], a[220:223], v[100:103]
    s_waitcnt lgkmcnt(7)
    s_waitcnt vmcnt(23)
    v_exp_f32 v13, v13
    v_mfma_f32_16x16x32_bf16 v[100:103], v[58:61], a[224:227], v[100:103]
    s_bitset1_b32 m0, 16
    ds_read_b64_tr_b16 a[206:207], v53 offset:28672
    v_cvt_pk_bf16_f32 v64, v12, v13
    v_mfma_f32_16x16x32_bf16 v[104:107], v[54:57], a[152:155], v[104:107]
    v_exp_f32 v14, v14
    v_mfma_f32_16x16x32_bf16 v[104:107], v[58:61], a[184:187], v[104:107]
    buffer_load_dwordx4 v94, s[20:23], s30 offen offset:0 nt lds
    v_mfma_f32_16x16x32_bf16 v[108:111], v[54:57], a[156:159], v[108:111]
    v_exp_f32 v15, v15
    v_mfma_f32_16x16x32_bf16 v[108:111], v[58:61], a[188:191], v[108:111]
    v_cvt_pk_bf16_f32 v65, v14, v15
    v_mfma_f32_16x16x32_bf16 v[112:115], v[54:57], a[228:231], v[112:115]
    v_exp_f32 v78, v78
    v_mfma_f32_16x16x32_bf16 v[112:115], v[58:61], a[232:235], v[112:115]
    buffer_load_dwordx4 v95, s[20:23], s30 offen offset:1024 nt lds
    v_mfma_f32_16x16x32_bf16 v[116:119], v[54:57], a[236:239], v[116:119]
    s_waitcnt lgkmcnt(2)
    v_exp_f32 v79, v79
    v_mfma_f32_16x16x32_bf16 v[116:119], v[58:61], a[240:243], v[116:119]
    v_cvt_pk_bf16_f32 v66, v78, v79
    v_mfma_f32_16x16x32_bf16 v[120:123], v[54:57], a[168:171], v[120:123]
    v_exp_f32 v80, v80
    v_mfma_f32_16x16x32_bf16 v[120:123], v[58:61], a[200:203], v[120:123]
    buffer_load_dwordx4 v94, s[20:23], s30 offen offset:2048 nt lds
    v_mfma_f32_16x16x32_bf16 v[124:127], v[54:57], a[172:175], v[124:127]
    s_waitcnt lgkmcnt(0)
    v_exp_f32 v81, v81
    v_mfma_f32_16x16x32_bf16 v[124:127], v[58:61], a[204:207], v[124:127]
    v_cvt_pk_bf16_f32 v67, v80, v81
    v_mfma_f32_16x16x32_bf16 v[8:11], a[80:83], a[32:35], v[24:27]
    v_exp_f32 v82, v82
    v_mfma_f32_16x16x32_bf16 v[8:11], a[84:87], a[36:39], v[8:11]
    buffer_load_dwordx4 v95, s[20:23], s30 offen offset:3072 nt lds
    v_mfma_f32_16x16x32_bf16 v[8:11], a[88:91], a[40:43], v[8:11]
    s_add_u32 s30, s30, 4096
    v_exp_f32 v83, v83
    v_mfma_f32_16x16x32_bf16 v[8:11], a[92:95], a[44:47], v[8:11]
    s_waitcnt vmcnt(23)
    v_cvt_pk_bf16_f32 v68, v82, v83
    v_mfma_f32_16x16x32_bf16 v[12:15], a[108:111], a[44:47], v[24:27]
    s_and_b32 m0, s30, 0xffff
    v_exp_f32 v84, v84
    v_mfma_f32_16x16x32_bf16 v[12:15], a[104:107], a[40:43], v[12:15]
    buffer_load_dwordx4 v90, s[16:19], s30 offen offset:0 nt lds
    v_mfma_f32_16x16x32_bf16 v[12:15], a[100:103], a[36:39], v[12:15]
    v_exp_f32 v85, v85
    v_mfma_f32_16x16x32_bf16 v[12:15], a[96:99], a[32:35], v[12:15]
    v_cvt_pk_bf16_f32 v69, v84, v85
    v_mfma_f32_16x16x32_bf16 v[78:81], a[112:115], a[32:35], v[24:27]
    v_exp_f32 v8, v8
    v_mfma_f32_16x16x32_bf16 v[78:81], a[116:119], a[36:39], v[78:81]
    buffer_load_dwordx4 v91, s[16:19], s30 offen offset:1024 nt lds
    v_mfma_f32_16x16x32_bf16 v[78:81], a[120:123], a[40:43], v[78:81]
    v_exp_f32 v9, v9
    v_mfma_f32_16x16x32_bf16 v[78:81], a[124:127], a[44:47], v[78:81]
    v_cvt_pk_bf16_f32 v54, v8, v9
    v_mfma_f32_16x16x32_bf16 v[82:85], a[140:143], a[44:47], v[24:27]
    v_exp_f32 v10, v10
    v_mfma_f32_16x16x32_bf16 v[82:85], a[136:139], a[40:43], v[82:85]
    buffer_load_dwordx4 v92, s[16:19], s30 offen offset:2048 nt lds
    v_mfma_f32_16x16x32_bf16 v[82:85], a[132:135], a[36:39], v[82:85]
    v_exp_f32 v11, v11
    v_mfma_f32_16x16x32_bf16 v[82:85], a[128:131], a[32:35], v[82:85]
    v_cvt_pk_bf16_f32 v55, v10, v11
    v_smfmac_f32_16x16x64_bf16 a[68:71], a[208:211], v[62:69], v41
    v_mfma_f32_16x16x32_bf16 v[128:131], v[62:65], a[212:215], v[128:131]
    v_exp_f32 v12, v12
    v_mfma_f32_16x16x32_bf16 v[128:131], v[66:69], a[216:219], v[128:131]
    buffer_load_dwordx4 v93, s[16:19], s30 offen offset:3072 nt lds
    v_mfma_f32_16x16x32_bf16 v[132:135], v[62:65], a[220:223], v[132:135]
    s_waitcnt vmcnt(23)
    v_exp_f32 v13, v13
    v_mfma_f32_16x16x32_bf16 v[132:135], v[66:69], a[224:227], v[132:135]
    s_bitset1_b32 m0, 16
    v_cvt_pk_bf16_f32 v56, v12, v13
    v_mfma_f32_16x16x32_bf16 v[136:139], v[62:65], a[152:155], v[136:139]
    v_exp_f32 v14, v14
    v_mfma_f32_16x16x32_bf16 v[136:139], v[66:69], a[184:187], v[136:139]
    buffer_load_dwordx4 v94, s[20:23], s30 offen offset:0 nt lds
    v_mfma_f32_16x16x32_bf16 v[140:143], v[62:65], a[156:159], v[140:143]
    v_exp_f32 v15, v15
    v_mfma_f32_16x16x32_bf16 v[140:143], v[66:69], a[188:191], v[140:143]
    s_cmp_gt_u32 s47, 2
    s_cbranch_scc1 L_nw3
    s_waitcnt vmcnt(21)
    s_cmp_gt_u32 s47, 1
    s_cbranch_scc1 L_nw3
    s_waitcnt vmcnt(13)
    s_cmp_gt_u32 s47, 0
    s_cbranch_scc1 L_nw3
    s_waitcnt vmcnt(5)
L_nw3:
    v_cvt_pk_bf16_f32 v57, v14, v15
    v_mfma_f32_16x16x32_bf16 v[144:147], v[62:65], a[228:231], v[144:147]
    s_barrier
    v_exp_f32 v78, v78
    v_mfma_f32_16x16x32_bf16 v[144:147], v[66:69], a[232:235], v[144:147]
    buffer_load_dwordx4 v95, s[20:23], s30 offen offset:1024 nt lds
    ds_read_b64_tr_b16 a[144:145], v46 offset:32768
    v_mfma_f32_16x16x32_bf16 v[148:151], v[62:65], a[236:239], v[148:151]
    v_exp_f32 v79, v79
    v_mfma_f32_16x16x32_bf16 v[148:151], v[66:69], a[240:243], v[148:151]
    ds_read_b64_tr_b16 a[146:147], v46 offset:36864
    v_cvt_pk_bf16_f32 v58, v78, v79
    v_mfma_f32_16x16x32_bf16 v[152:155], v[62:65], a[168:171], v[152:155]
    v_exp_f32 v80, v80
    v_mfma_f32_16x16x32_bf16 v[152:155], v[66:69], a[200:203], v[152:155]
    buffer_load_dwordx4 v94, s[20:23], s30 offen offset:2048 nt lds
    ds_read_b64_tr_b16 a[176:177], v46 offset:40960
    v_mfma_f32_16x16x32_bf16 v[156:159], v[62:65], a[172:175], v[156:159]
    v_exp_f32 v81, v81
    v_mfma_f32_16x16x32_bf16 v[156:159], v[66:69], a[204:207], v[156:159]
    ds_read_b64_tr_b16 a[178:179], v46 offset:45056
    v_cvt_pk_bf16_f32 v59, v80, v81
    v_mfma_f32_16x16x32_bf16 v[8:11], a[80:83], a[48:51], v[28:31]
    v_exp_f32 v82, v82
    v_mfma_f32_16x16x32_bf16 v[8:11], a[84:87], a[52:55], v[8:11]
    buffer_load_dwordx4 v95, s[20:23], s30 offen offset:3072 nt lds
    ds_read_b128 a[80:83], v42 offset:32768
    v_mfma_f32_16x16x32_bf16 v[8:11], a[88:91], a[56:59], v[8:11]
    s_add_u32 s30, s30, 4096
    v_exp_f32 v83, v83
    v_mfma_f32_16x16x32_bf16 v[8:11], a[92:95], a[60:63], v[8:11]
    s_waitcnt vmcnt(23)
    ds_read_b128 a[84:87], v43 offset:32768
    v_cvt_pk_bf16_f32 v60, v82, v83
    v_mfma_f32_16x16x32_bf16 v[12:15], a[108:111], a[60:63], v[28:31]
    s_and_b32 m0, s30, 0xffff
    v_exp_f32 v84, v84
    v_mfma_f32_16x16x32_bf16 v[12:15], a[104:107], a[56:59], v[12:15]
    buffer_load_dwordx4 v90, s[16:19], s30 offen offset:0 nt lds
    ds_read_b128 a[88:91], v44 offset:32768
    v_mfma_f32_16x16x32_bf16 v[12:15], a[100:103], a[52:55], v[12:15]
    v_exp_f32 v85, v85
    v_mfma_f32_16x16x32_bf16 v[12:15], a[96:99], a[48:51], v[12:15]
    ds_read_b128 a[92:95], v45 offset:32768
    v_cvt_pk_bf16_f32 v61, v84, v85
    v_mfma_f32_16x16x32_bf16 v[78:81], a[112:115], a[48:51], v[28:31]
    v_exp_f32 v8, v8
    v_mfma_f32_16x16x32_bf16 v[78:81], a[116:119], a[52:55], v[78:81]
    buffer_load_dwordx4 v91, s[16:19], s30 offen offset:1024 nt lds
    ds_read_b128 a[108:111], v45 offset:36864
    v_mfma_f32_16x16x32_bf16 v[78:81], a[120:123], a[56:59], v[78:81]
    v_exp_f32 v9, v9
    v_mfma_f32_16x16x32_bf16 v[78:81], a[124:127], a[60:63], v[78:81]
    ds_read_b128 a[104:107], v44 offset:36864
    v_cvt_pk_bf16_f32 v62, v8, v9
    v_mfma_f32_16x16x32_bf16 v[82:85], a[140:143], a[60:63], v[28:31]
    v_exp_f32 v10, v10
    v_mfma_f32_16x16x32_bf16 v[82:85], a[136:139], a[56:59], v[82:85]
    buffer_load_dwordx4 v92, s[16:19], s30 offen offset:2048 nt lds
    ds_read_b128 a[100:103], v43 offset:36864
    v_mfma_f32_16x16x32_bf16 v[82:85], a[132:135], a[52:55], v[82:85]
    v_exp_f32 v11, v11
    v_mfma_f32_16x16x32_bf16 v[82:85], a[128:131], a[48:51], v[82:85]
    ds_read_b128 a[96:99], v42 offset:36864
    v_cvt_pk_bf16_f32 v63, v10, v11
    v_smfmac_f32_16x16x64_bf16 a[72:75], a[208:211], v[54:61], v41
    v_mfma_f32_16x16x32_bf16 v[160:163], v[54:57], a[212:215], v[160:163]
    v_exp_f32 v12, v12
    v_mfma_f32_16x16x32_bf16 v[160:163], v[58:61], a[216:219], v[160:163]
    buffer_load_dwordx4 v93, s[16:19], s30 offen offset:3072 nt lds
    ds_read_b128 a[112:115], v42 offset:40960
    v_mfma_f32_16x16x32_bf16 v[164:167], v[54:57], a[220:223], v[164:167]
    s_waitcnt vmcnt(23)
    v_exp_f32 v13, v13
    v_mfma_f32_16x16x32_bf16 v[164:167], v[58:61], a[224:227], v[164:167]
    s_bitset1_b32 m0, 16
    ds_read_b128 a[116:119], v43 offset:40960
    v_cvt_pk_bf16_f32 v64, v12, v13
    v_mfma_f32_16x16x32_bf16 v[168:171], v[54:57], a[152:155], v[168:171]
    v_exp_f32 v14, v14
    v_mfma_f32_16x16x32_bf16 v[168:171], v[58:61], a[184:187], v[168:171]
    buffer_load_dwordx4 v94, s[20:23], s30 offen offset:0 nt lds
    ds_read_b128 a[120:123], v44 offset:40960
    v_mfma_f32_16x16x32_bf16 v[172:175], v[54:57], a[156:159], v[172:175]
    v_exp_f32 v15, v15
    v_mfma_f32_16x16x32_bf16 v[172:175], v[58:61], a[188:191], v[172:175]
    ds_read_b128 a[124:127], v45 offset:40960
    v_cvt_pk_bf16_f32 v65, v14, v15
    v_mfma_f32_16x16x32_bf16 v[176:179], v[54:57], a[228:231], v[176:179]
    v_exp_f32 v78, v78
    v_mfma_f32_16x16x32_bf16 v[176:179], v[58:61], a[232:235], v[176:179]
    buffer_load_dwordx4 v95, s[20:23], s30 offen offset:1024 nt lds
    ds_read_b128 a[140:143], v45 offset:45056
    v_mfma_f32_16x16x32_bf16 v[180:183], v[54:57], a[236:239], v[180:183]
    v_exp_f32 v79, v79
    v_mfma_f32_16x16x32_bf16 v[180:183], v[58:61], a[240:243], v[180:183]
    ds_read_b128 a[136:139], v44 offset:45056
    v_cvt_pk_bf16_f32 v66, v78, v79
    v_mfma_f32_16x16x32_bf16 v[184:187], v[54:57], a[168:171], v[184:187]
    v_exp_f32 v80, v80
    v_mfma_f32_16x16x32_bf16 v[184:187], v[58:61], a[200:203], v[184:187]
    buffer_load_dwordx4 v94, s[20:23], s30 offen offset:2048 nt lds
    ds_read_b128 a[132:135], v43 offset:45056
    v_mfma_f32_16x16x32_bf16 v[188:191], v[54:57], a[172:175], v[188:191]
    v_exp_f32 v81, v81
    v_mfma_f32_16x16x32_bf16 v[188:191], v[58:61], a[204:207], v[188:191]
    s_waitcnt lgkmcnt(5)
    ds_read_b128 a[128:131], v42 offset:45056
    v_cvt_pk_bf16_f32 v67, v80, v81
    v_mfma_f32_16x16x32_bf16 v[8:11], a[80:83], a[0:3], v[16:19]
    v_exp_f32 v82, v82
    v_mfma_f32_16x16x32_bf16 v[8:11], a[84:87], a[4:7], v[8:11]
    buffer_load_dwordx4 v95, s[20:23], s30 offen offset:3072 nt lds
    ds_read_b64_tr_b16 a[148:149], v47 offset:32768
    v_mfma_f32_16x16x32_bf16 v[8:11], a[88:91], a[8:11], v[8:11]
    s_add_u32 s30, s30, 4096
    v_exp_f32 v83, v83
    v_mfma_f32_16x16x32_bf16 v[8:11], a[92:95], a[12:15], v[8:11]
    s_waitcnt vmcnt(23)
    ds_read_b64_tr_b16 a[150:151], v47 offset:36864
    v_cvt_pk_bf16_f32 v68, v82, v83
    v_mfma_f32_16x16x32_bf16 v[12:15], a[108:111], a[12:15], v[16:19]
    s_and_b32 m0, s30, 0xffff
    v_exp_f32 v84, v84
    v_mfma_f32_16x16x32_bf16 v[12:15], a[104:107], a[8:11], v[12:15]
    buffer_load_dwordx4 v90, s[16:19], s30 offen offset:0 nt lds
    ds_read_b64_tr_b16 a[180:181], v47 offset:40960
    v_mfma_f32_16x16x32_bf16 v[12:15], a[100:103], a[4:7], v[12:15]
    v_exp_f32 v85, v85
    v_mfma_f32_16x16x32_bf16 v[12:15], a[96:99], a[0:3], v[12:15]
    buffer_load_dwordx4 v91, s[16:19], s30 offen offset:1024 nt lds
    v_cvt_pk_bf16_f32 v69, v84, v85
    v_mfma_f32_16x16x32_bf16 v[78:81], a[112:115], a[0:3], v[16:19]
    v_exp_f32 v8, v8
    v_mfma_f32_16x16x32_bf16 v[78:81], a[116:119], a[4:7], v[78:81]
    s_waitcnt lgkmcnt(4)
    ds_read_b64_tr_b16 a[182:183], v47 offset:45056
    ds_read_b64_tr_b16 a[160:161], v50 offset:32768
    v_mfma_f32_16x16x32_bf16 v[78:81], a[120:123], a[8:11], v[78:81]
    v_exp_f32 v9, v9
    v_mfma_f32_16x16x32_bf16 v[78:81], a[124:127], a[12:15], v[78:81]
    buffer_load_dwordx4 v92, s[16:19], s30 offen offset:2048 nt lds
    v_cvt_pk_bf16_f32 v54, v8, v9
    v_mfma_f32_16x16x32_bf16 v[82:85], a[140:143], a[12:15], v[16:19]
    v_exp_f32 v10, v10
    v_mfma_f32_16x16x32_bf16 v[82:85], a[136:139], a[8:11], v[82:85]
    ds_read_b64_tr_b16 a[162:163], v50 offset:36864
    ds_read_b64_tr_b16 a[192:193], v50 offset:40960
    v_mfma_f32_16x16x32_bf16 v[82:85], a[132:135], a[4:7], v[82:85]
    s_waitcnt lgkmcnt(5)
    v_exp_f32 v11, v11
    v_mfma_f32_16x16x32_bf16 v[82:85], a[128:131], a[0:3], v[82:85]
    buffer_load_dwordx4 v93, s[16:19], s30 offen offset:3072 nt lds
    v_cvt_pk_bf16_f32 v55, v10, v11
    v_smfmac_f32_16x16x64_bf16 a[76:79], a[208:211], v[62:69], v41
    v_mfma_f32_16x16x32_bf16 v[192:195], v[62:65], a[212:215], v[192:195]
    s_waitcnt vmcnt(23)
    v_exp_f32 v12, v12
    v_mfma_f32_16x16x32_bf16 v[192:195], v[66:69], a[216:219], v[192:195]
    s_bitset1_b32 m0, 16
    ds_read_b64_tr_b16 a[194:195], v50 offset:45056
    ds_read_b64_tr_b16 a[164:165], v51 offset:32768
    v_mfma_f32_16x16x32_bf16 v[196:199], v[62:65], a[220:223], v[196:199]
    v_exp_f32 v13, v13
    v_mfma_f32_16x16x32_bf16 v[196:199], v[66:69], a[224:227], v[196:199]
    buffer_load_dwordx4 v94, s[20:23], s30 offen offset:0 nt lds
    v_cvt_pk_bf16_f32 v56, v12, v13
    v_mfma_f32_16x16x32_bf16 v[200:203], v[62:65], a[152:155], v[200:203]
    v_exp_f32 v14, v14
    v_mfma_f32_16x16x32_bf16 v[200:203], v[66:69], a[184:187], v[200:203]
    ds_read_b64_tr_b16 a[152:153], v48 offset:32768
    ds_read_b64_tr_b16 a[154:155], v48 offset:36864
    v_mfma_f32_16x16x32_bf16 v[204:207], v[62:65], a[156:159], v[204:207]
    v_exp_f32 v15, v15
    v_mfma_f32_16x16x32_bf16 v[204:207], v[66:69], a[188:191], v[204:207]
    buffer_load_dwordx4 v95, s[20:23], s30 offen offset:1024 nt lds
    v_cvt_pk_bf16_f32 v57, v14, v15
    v_mfma_f32_16x16x32_bf16 v[208:211], v[62:65], a[228:231], v[208:211]
    v_exp_f32 v78, v78
    v_mfma_f32_16x16x32_bf16 v[208:211], v[66:69], a[232:235], v[208:211]
    ds_read_b64_tr_b16 a[184:185], v48 offset:40960
    ds_read_b64_tr_b16 a[186:187], v48 offset:45056
    v_mfma_f32_16x16x32_bf16 v[212:215], v[62:65], a[236:239], v[212:215]
    v_exp_f32 v79, v79
    v_mfma_f32_16x16x32_bf16 v[212:215], v[66:69], a[240:243], v[212:215]
    buffer_load_dwordx4 v94, s[20:23], s30 offen offset:2048 nt lds
    v_cvt_pk_bf16_f32 v58, v78, v79
    v_mfma_f32_16x16x32_bf16 v[216:219], v[62:65], a[168:171], v[216:219]
    v_exp_f32 v80, v80
    v_mfma_f32_16x16x32_bf16 v[216:219], v[66:69], a[200:203], v[216:219]
    ds_read_b64_tr_b16 a[156:157], v49 offset:32768
    ds_read_b64_tr_b16 a[158:159], v49 offset:36864
    v_mfma_f32_16x16x32_bf16 v[220:223], v[62:65], a[172:175], v[220:223]
    v_exp_f32 v81, v81
    v_mfma_f32_16x16x32_bf16 v[220:223], v[66:69], a[204:207], v[220:223]
    buffer_load_dwordx4 v95, s[20:23], s30 offen offset:3072 nt lds
    v_cvt_pk_bf16_f32 v59, v80, v81
    v_mfma_f32_16x16x32_bf16 v[8:11], a[80:83], a[16:19], v[20:23]
    s_add_u32 s30, s30, 4096
    v_exp_f32 v82, v82
    v_mfma_f32_16x16x32_bf16 v[8:11], a[84:87], a[20:23], v[8:11]
    s_bitcmp0_b32 s90, s29
    s_cbranch_scc1 L_nogrow2
    s_waitcnt vmcnt(23)
    s_and_b32 m0, s30, 0xffff
    s_nop 0
    buffer_load_dwordx4 v90, s[16:19], s30 offen offset:0 nt lds
    buffer_load_dwordx4 v91, s[16:19], s30 offen offset:1024 nt lds
    buffer_load_dwordx4 v92, s[16:19], s30 offen offset:2048 nt lds
    buffer_load_dwordx4 v93, s[16:19], s30 offen offset:3072 nt lds
    s_waitcnt vmcnt(23)
    s_bitset1_b32 m0, 16
    s_nop 0
    buffer_load_dwordx4 v94, s[20:23], s30 offen offset:0 nt lds
    buffer_load_dwordx4 v95, s[20:23], s30 offen offset:1024 nt lds
    buffer_load_dwordx4 v94, s[20:23], s30 offen offset:2048 nt lds
    buffer_load_dwordx4 v95, s[20:23], s30 offen offset:3072 nt lds
    s_add_u32 s30, s30, 4096
    s_add_u32 s47, s47, 1
L_nogrow2:
    ds_read_b64_tr_b16 a[188:189], v49 offset:40960
    ds_read_b64_tr_b16 a[190:191], v49 offset:45056
    v_mfma_f32_16x16x32_bf16 v[8:11], a[88:91], a[24:27], v[8:11]
    s_waitcnt vmcnt(23)
    v_exp_f32 v83, v83
    v_mfma_f32_16x16x32_bf16 v[8:11], a[92:95], a[28:31], v[8:11]
    s_and_b32 m0, s30, 0xffff
    ds_read_b64_tr_b16 a[168:169], v52 offset:32768
    v_cvt_pk_bf16_f32 v60, v82, v83
    v_mfma_f32_16x16x32_bf16 v[12:15], a[108:111], a[28:31], v[20:23]
    v_exp_f32 v84, v84
    v_mfma_f32_16x16x32_bf16 v[12:15], a[104:107], a[24:27], v[12:15]
    buffer_load_dwordx4 v90, s[16:19], s30 offen offset:0 nt lds
    ds_read_b64_tr_b16 a[170:171], v52 offset:36864
    v_mfma_f32_16x16x32_bf16 v[12:15], a[100:103], a[20:23], v[12:15]
    v_exp_f32 v85, v85
    v_mfma_f32_16x16x32_bf16 v[12:15], a[96:99], a[16:19], v[12:15]
    buffer_load_dwordx4 v91, s[16:19], s30 offen offset:1024 nt lds
    v_cvt_pk_bf16_f32 v61, v84, v85
    v_mfma_f32_16x16x32_bf16 v[78:81], a[112:115], a[16:19], v[20:23]
    v_exp_f32 v8, v8
    v_mfma_f32_16x16x32_bf16 v[78:81], a[116:119], a[20:23], v[78:81]
    ds_read_b64_tr_b16 a[200:201], v52 offset:40960
    ds_read_b64_tr_b16 a[202:203], v52 offset:45056
    v_mfma_f32_16x16x32_bf16 v[78:81], a[120:123], a[24:27], v[78:81]
    v_exp_f32 v9, v9
    v_mfma_f32_16x16x32_bf16 v[78:81], a[124:127], a[28:31], v[78:81]
    buffer_load_dwordx4 v92, s[16:19], s30 offen offset:2048 nt lds
    ds_read_b64_tr_b16 a[198:199], v51 offset:45056
    v_cvt_pk_bf16_f32 v62, v8, v9
    v_mfma_f32_16x16x32_bf16 v[82:85], a[140:143], a[28:31], v[20:23]
    v_exp_f32 v10, v10
    v_mfma_f32_16x16x32_bf16 v[82:85], a[136:139], a[24:27], v[82:85]
    ds_read_b64_tr_b16 a[172:173], v53 offset:32768
    ds_read_b64_tr_b16 a[174:175], v53 offset:36864
    ds_read_b64_tr_b16 a[166:167], v51 offset:36864
    v_mfma_f32_16x16x32_bf16 v[82:85], a[132:135], a[20:23], v[82:85]
    v_exp_f32 v11, v11
    v_mfma_f32_16x16x32_bf16 v[82:85], a[128:131], a[16:19], v[82:85]
    buffer_load_dwordx4 v93, s[16:19], s30 offen offset:3072 nt lds
    ds_read_b64_tr_b16 a[196:197], v51 offset:40960
    v_cvt_pk_bf16_f32 v63, v10, v11
    v_smfmac_f32_16x16x64_bf16 a[64:67], a[208:211], v[54:61], v41
    v_mfma_f32_16x16x32_bf16 v[96:99], v[54:57], a[144:147], v[96:99]
    s_waitcnt vmcnt(23)
    v_exp_f32 v12, v12
    v_mfma_f32_16x16x32_bf16 v[96:99], v[58:61], a[176:179], v[96:99]
    s_bitset1_b32 m0, 16
    ds_read_b64_tr_b16 a[204:205], v53 offset:40960
    ds_read_b64_tr_b16 a[206:207], v53 offset:45056
    v_mfma_f32_16x16x32_bf16 v[100:103], v[54:57], a[148:151], v[100:103]
    s_waitcnt lgkmcnt(9)
    v_exp_f32 v13, v13
    v_mfma_f32_16x16x32_bf16 v[100:103], v[58:61], a[180:183], v[100:103]
    buffer_load_dwordx4 v94, s[20:23], s30 offen offset:0 nt lds
    v_cvt_pk_bf16_f32 v64, v12, v13
    v_mfma_f32_16x16x32_bf16 v[104:107], v[54:57], a[152:155], v[104:107]
    v_exp_f32 v14, v14
    v_mfma_f32_16x16x32_bf16 v[104:107], v[58:61], a[184:187], v[104:107]
    v_mfma_f32_16x16x32_bf16 v[108:111], v[54:57], a[156:159], v[108:111]
    v_exp_f32 v15, v15
    v_mfma_f32_16x16x32_bf16 v[108:111], v[58:61], a[188:191], v[108:111]
    buffer_load_dwordx4 v95, s[20:23], s30 offen offset:1024 nt lds
    v_cvt_pk_bf16_f32 v65, v14, v15
    v_mfma_f32_16x16x32_bf16 v[112:115], v[54:57], a[160:163], v[112:115]
    v_exp_f32 v78, v78
    v_mfma_f32_16x16x32_bf16 v[112:115], v[58:61], a[192:195], v[112:115]
    s_waitcnt lgkmcnt(2)
    v_mfma_f32_16x16x32_bf16 v[116:119], v[54:57], a[164:167], v[116:119]
    v_exp_f32 v79, v79
    v_mfma_f32_16x16x32_bf16 v[116:119], v[58:61], a[196:199], v[116:119]
    buffer_load_dwordx4 v94, s[20:23], s30 offen offset:2048 nt lds
    v_cvt_pk_bf16_f32 v66, v78, v79
    v_mfma_f32_16x16x32_bf16 v[120:123], v[54:57], a[168:171], v[120:123]
    v_exp_f32 v80, v80
    v_mfma_f32_16x16x32_bf16 v[120:123], v[58:61], a[200:203], v[120:123]
    v_mfma_f32_16x16x32_bf16 v[124:127], v[54:57], a[172:175], v[124:127]
    s_waitcnt lgkmcnt(0)
    v_exp_f32 v81, v81
    v_mfma_f32_16x16x32_bf16 v[124:127], v[58:61], a[204:207], v[124:127]
    buffer_load_dwordx4 v95, s[20:23], s30 offen offset:3072 nt lds
    v_cvt_pk_bf16_f32 v67, v80, v81
    v_mfma_f32_16x16x32_bf16 v[8:11], a[80:83], a[32:35], v[24:27]
    s_add_u32 s30, s30, 4096
    v_exp_f32 v82, v82
    v_mfma_f32_16x16x32_bf16 v[8:11], a[84:87], a[36:39], v[8:11]
    s_waitcnt vmcnt(23)
    v_mfma_f32_16x16x32_bf16 v[8:11], a[88:91], a[40:43], v[8:11]
    s_and_b32 m0, s30, 0xffff
    v_exp_f32 v83, v83
    v_mfma_f32_16x16x32_bf16 v[8:11], a[92:95], a[44:47], v[8:11]
    buffer_load_dwordx4 v90, s[16:19], s30 offen offset:0 nt lds
    v_cvt_pk_bf16_f32 v68, v82, v83
    v_mfma_f32_16x16x32_bf16 v[12:15], a[108:111], a[44:47], v[24:27]
    v_exp_f32 v84, v84
    v_mfma_f32_16x16x32_bf16 v[12:15], a[104:107], a[40:43], v[12:15]
    v_mfma_f32_16x16x32_bf16 v[12:15], a[100:103], a[36:39], v[12:15]
    v_exp_f32 v85, v85
    v_mfma_f32_16x16x32_bf16 v[12:15], a[96:99], a[32:35], v[12:15]
    buffer_load_dwordx4 v91, s[16:19], s30 offen offset:1024 nt lds
    v_cvt_pk_bf16_f32 v69, v84, v85
    v_mfma_f32_16x16x32_bf16 v[78:81], a[112:115], a[32:35], v[24:27]
    v_exp_f32 v8, v8
    v_mfma_f32_16x16x32_bf16 v[78:81], a[116:119], a[36:39], v[78:81]
    v_mfma_f32_16x16x32_bf16 v[78:81], a[120:123], a[40:43], v[78:81]
    v_exp_f32 v9, v9
    v_mfma_f32_16x16x32_bf16 v[78:81], a[124:127], a[44:47], v[78:81]
    buffer_load_dwordx4 v92, s[16:19], s30 offen offset:2048 nt lds
    v_cvt_pk_bf16_f32 v54, v8, v9
    v_mfma_f32_16x16x32_bf16 v[82:85], a[140:143], a[44:47], v[24:27]
    v_exp_f32 v10, v10
    v_mfma_f32_16x16x32_bf16 v[82:85], a[136:139], a[40:43], v[82:85]
    v_mfma_f32_16x16x32_bf16 v[82:85], a[132:135], a[36:39], v[82:85]
    v_exp_f32 v11, v11
    v_mfma_f32_16x16x32_bf16 v[82:85], a[128:131], a[32:35], v[82:85]
    buffer_load_dwordx4 v93, s[16:19], s30 offen offset:3072 nt lds
    v_cvt_pk_bf16_f32 v55, v10, v11
    v_smfmac_f32_16x16x64_bf16 a[68:71], a[208:211], v[62:69], v41
    v_mfma_f32_16x16x32_bf16 v[128:131], v[62:65], a[144:147], v[128:131]
    s_waitcnt vmcnt(23)
    v_exp_f32 v12, v12
    v_mfma_f32_16x16x32_bf16 v[128:131], v[66:69], a[176:179], v[128:131]
    s_bitset1_b32 m0, 16
    v_mfma_f32_16x16x32_bf16 v[132:135], v[62:65], a[148:151], v[132:135]
    v_exp_f32 v13, v13
    v_mfma_f32_16x16x32_bf16 v[132:135], v[66:69], a[180:183], v[132:135]
    buffer_load_dwordx4 v94, s[20:23], s30 offen offset:0 nt lds
    v_cvt_pk_bf16_f32 v56, v12, v13
    v_mfma_f32_16x16x32_bf16 v[136:139], v[62:65], a[152:155], v[136:139]
    v_exp_f32 v14, v14
    v_mfma_f32_16x16x32_bf16 v[136:139], v[66:69], a[184:187], v[136:139]
    v_mfma_f32_16x16x32_bf16 v[140:143], v[62:65], a[156:159], v[140:143]
    v_exp_f32 v15, v15
    v_mfma_f32_16x16x32_bf16 v[140:143], v[66:69], a[188:191], v[140:143]
    s_cmp_gt_u32 s47, 2
    s_cbranch_scc1 L_nw5
    s_waitcnt vmcnt(21)
    s_cmp_gt_u32 s47, 1
    s_cbranch_scc1 L_nw5
    s_waitcnt vmcnt(13)
    s_cmp_gt_u32 s47, 0
    s_cbranch_scc1 L_nw5
    s_waitcnt vmcnt(5)
L_nw5:
    buffer_load_dwordx4 v95, s[20:23], s30 offen offset:1024 nt lds
    v_cvt_pk_bf16_f32 v57, v14, v15
    v_mfma_f32_16x16x32_bf16 v[144:147], v[62:65], a[160:163], v[144:147]
    s_barrier
    v_exp_f32 v78, v78
    v_mfma_f32_16x16x32_bf16 v[144:147], v[66:69], a[192:195], v[144:147]
    ds_read_b64_tr_b16 a[212:213], v46 offset:49152
    ds_read_b64_tr_b16 a[214:215], v46 offset:53248
    v_mfma_f32_16x16x32_bf16 v[148:151], v[62:65], a[164:167], v[148:151]
    v_exp_f32 v79, v79
    v_mfma_f32_16x16x32_bf16 v[148:151], v[66:69], a[196:199], v[148:151]
    buffer_load_dwordx4 v94, s[20:23], s30 offen offset:2048 nt lds
    v_cvt_pk_bf16_f32 v58, v78, v79
    v_mfma_f32_16x16x32_bf16 v[152:155], v[62:65], a[168:171], v[152:155]
    v_exp_f32 v80, v80
    v_mfma_f32_16x16x32_bf16 v[152:155], v[66:69], a[200:203], v[152:155]
    ds_read_b64_tr_b16 a[216:217], v46 offset:57344
    ds_read_b64_tr_b16 a[218:219], v46 offset:61440
    v_mfma_f32_16x16x32_bf16 v[156:159], v[62:65], a[172:175], v[156:159]
    v_exp_f32 v81, v81
    v_mfma_f32_16x16x32_bf16 v[156:159], v[66:69], a[204:207], v[156:159]
    buffer_load_dwordx4 v95, s[20:23], s30 offen offset:3072 nt lds
    v_cvt_pk_bf16_f32 v59, v80, v81
    v_mfma_f32_16x16x32_bf16 v[8:11], a[80:83], a[48:51], v[28:31]
    s_add_u32 s30, s30, 4096
    v_exp_f32 v82, v82
    v_mfma_f32_16x16x32_bf16 v[8:11], a[84:87], a[52:55], v[8:11]
    s_waitcnt vmcnt(23)
    ds_read_b128 a[80:83], v42 offset:49152
    ds_read_b128 a[84:87], v43 offset:49152
    v_mfma_f32_16x16x32_bf16 v[8:11], a[88:91], a[56:59], v[8:11]
    s_and_b32 m0, s30, 0xffff
    v_exp_f32 v83, v83
    v_mfma_f32_16x16x32_bf16 v[8:11], a[92:95], a[60:63], v[8:11]
    buffer_load_dwordx4 v90, s[16:19], s30 offen offset:0 nt lds
    v_cvt_pk_bf16_f32 v60, v82, v83
    v_mfma_f32_16x16x32_bf16 v[12:15], a[108:111], a[60:63], v[28:31]
    v_exp_f32 v84, v84
    v_mfma_f32_16x16x32_bf16 v[12:15], a[104:107], a[56:59], v[12:15]
    ds_read_b128 a[88:91], v44 offset:49152
    ds_read_b128 a[92:95], v45 offset:49152
    v_mfma_f32_16x16x32_bf16 v[12:15], a[100:103], a[52:55], v[12:15]
    v_exp_f32 v85, v85
    v_mfma_f32_16x16x32_bf16 v[12:15], a[96:99], a[48:51], v[12:15]
    buffer_load_dwordx4 v91, s[16:19], s30 offen offset:1024 nt lds
    v_cvt_pk_bf16_f32 v61, v84, v85
    v_mfma_f32_16x16x32_bf16 v[78:81], a[112:115], a[48:51], v[28:31]
    v_exp_f32 v8, v8
    v_mfma_f32_16x16x32_bf16 v[78:81], a[116:119], a[52:55], v[78:81]
    ds_read_b128 a[108:111], v45 offset:53248
    ds_read_b128 a[104:107], v44 offset:53248
    v_mfma_f32_16x16x32_bf16 v[78:81], a[120:123], a[56:59], v[78:81]
    v_exp_f32 v9, v9
    v_mfma_f32_16x16x32_bf16 v[78:81], a[124:127], a[60:63], v[78:81]
    buffer_load_dwordx4 v92, s[16:19], s30 offen offset:2048 nt lds
    v_cvt_pk_bf16_f32 v62, v8, v9
    v_mfma_f32_16x16x32_bf16 v[82:85], a[140:143], a[60:63], v[28:31]
    v_exp_f32 v10, v10
    v_mfma_f32_16x16x32_bf16 v[82:85], a[136:139], a[56:59], v[82:85]
    ds_read_b128 a[100:103], v43 offset:53248
    ds_read_b128 a[96:99], v42 offset:53248
    v_mfma_f32_16x16x32_bf16 v[82:85], a[132:135], a[52:55], v[82:85]
    v_exp_f32 v11, v11
    v_mfma_f32_16x16x32_bf16 v[82:85], a[128:131], a[48:51], v[82:85]
    buffer_load_dwordx4 v93, s[16:19], s30 offen offset:3072 nt lds
    v_cvt_pk_bf16_f32 v63, v10, v11
    v_smfmac_f32_16x16x64_bf16 a[72:75], a[208:211], v[54:61], v41
    v_mfma_f32_16x16x32_bf16 v[160:163], v[54:57], a[144:147], v[160:163]
    s_waitcnt vmcnt(23)
    v_exp_f32 v12, v12
    v_mfma_f32_16x16x32_bf16 v[160:163], v[58:61], a[176:179], v[160:163]
    s_bitset1_b32 m0, 16
    ds_read_b128 a[112:115], v42 offset:57344
    ds_read_b128 a[116:119], v43 offset:57344
    v_mfma_f32_16x16x32_bf16 v[164:167], v[54:57], a[148:151], v[164:167]
    v_exp_f32 v13, v13
    v_mfma_f32_16x16x32_bf16 v[164:167], v[58:61], a[180:183], v[164:167]
    buffer_load_dwordx4 v94, s[20:23], s30 offen offset:0 nt lds
    v_cvt_pk_bf16_f32 v64, v12, v13
    v_mfma_f32_16x16x32_bf16 v[168:171], v[54:57], a[152:155], v[168:171]
    v_exp_f32 v14, v14
    v_mfma_f32_16x16x32_bf16 v[168:171], v[58:61], a[184:187], v[168:171]
    ds_read_b128 a[120:123], v44 offset:57344
    ds_read_b128 a[124:127], v45 offset:57344
    v_mfma_f32_16x16x32_bf16 v[172:175], v[54:57], a[156:159], v[172:175]
    v_exp_f32 v15, v15
    v_mfma_f32_16x16x32_bf16 v[172:175], v[58:61], a[188:191], v[172:175]
    buffer_load_dwordx4 v95, s[20:23], s30 offen offset:1024 nt lds
    v_cvt_pk_bf16_f32 v65, v14, v15
    v_mfma_f32_16x16x32_bf16 v[176:179], v[54:57], a[160:163], v[176:179]
    v_exp_f32 v78, v78
    v_mfma_f32_16x16x32_bf16 v[176:179], v[58:61], a[192:195], v[176:179]
    ds_read_b128 a[140:143], v45 offset:61440
    ds_read_b128 a[136:139], v44 offset:61440
    v_mfma_f32_16x16x32_bf16 v[180:183], v[54:57], a[164:167], v[180:183]
    v_exp_f32 v79, v79
    v_mfma_f32_16x16x32_bf16 v[180:183], v[58:61], a[196:199], v[180:183]
    buffer_load_dwordx4 v94, s[20:23], s30 offen offset:2048 nt lds
    v_cvt_pk_bf16_f32 v66, v78, v79
    v_mfma_f32_16x16x32_bf16 v[184:187], v[54:57], a[168:171], v[184:187]
    v_exp_f32 v80, v80
    v_mfma_f32_16x16x32_bf16 v[184:187], v[58:61], a[200:203], v[184:187]
    s_sub_u32 s29, s29, 1
    ds_read_b128 a[132:135], v43 offset:61440
    ds_read_b128 a[128:131], v42 offset:61440
    v_mfma_f32_16x16x32_bf16 v[188:191], v[54:57], a[172:175], v[188:191]
    s_cmp_eq_u32 s29, 0
    v_exp_f32 v81, v81
    v_mfma_f32_16x16x32_bf16 v[188:191], v[58:61], a[204:207], v[188:191]
    s_waitcnt lgkmcnt(6)
    buffer_load_dwordx4 v95, s[20:23], s30 offen offset:3072 nt lds
    v_cvt_pk_bf16_f32 v67, v80, v81
    s_cbranch_scc1 L_exit_w4
    v_mfma_f32_16x16x32_bf16 v[8:11], a[80:83], a[0:3], v[16:19]
    s_add_u32 s30, s30, 4096
    v_exp_f32 v82, v82
    v_mfma_f32_16x16x32_bf16 v[8:11], a[84:87], a[4:7], v[8:11]
    s_waitcnt vmcnt(23)
    ds_read_b64_tr_b16 a[220:221], v47 offset:49152
    ds_read_b64_tr_b16 a[222:223], v47 offset:53248
    v_mfma_f32_16x16x32_bf16 v[8:11], a[88:91], a[8:11], v[8:11]
    s_and_b32 m0, s30, 0xffff
    v_exp_f32 v83, v83
    v_mfma_f32_16x16x32_bf16 v[8:11], a[92:95], a[12:15], v[8:11]
    buffer_load_dwordx4 v90, s[16:19], s30 offen offset:0 nt lds
    v_cvt_pk_bf16_f32 v68, v82, v83
    v_mfma_f32_16x16x32_bf16 v[12:15], a[108:111], a[12:15], v[16:19]
    v_exp_f32 v84, v84
    v_mfma_f32_16x16x32_bf16 v[12:15], a[104:107], a[8:11], v[12:15]
    ds_read_b64_tr_b16 a[224:225], v47 offset:57344
    ds_read_b64_tr_b16 a[226:227], v47 offset:61440
    v_mfma_f32_16x16x32_bf16 v[12:15], a[100:103], a[4:7], v[12:15]
    v_exp_f32 v85, v85
    v_mfma_f32_16x16x32_bf16 v[12:15], a[96:99], a[0:3], v[12:15]
    buffer_load_dwordx4 v91, s[16:19], s30 offen offset:1024 nt lds
    v_cvt_pk_bf16_f32 v69, v84, v85
    v_mfma_f32_16x16x32_bf16 v[78:81], a[112:115], a[0:3], v[16:19]
    v_exp_f32 v8, v8
    v_mfma_f32_16x16x32_bf16 v[78:81], a[116:119], a[4:7], v[78:81]
    s_waitcnt lgkmcnt(4)
    ds_read_b64_tr_b16 a[228:229], v50 offset:49152
    ds_read_b64_tr_b16 a[230:231], v50 offset:53248
    v_mfma_f32_16x16x32_bf16 v[78:81], a[120:123], a[8:11], v[78:81]
    v_exp_f32 v9, v9
    v_mfma_f32_16x16x32_bf16 v[78:81], a[124:127], a[12:15], v[78:81]
    buffer_load_dwordx4 v92, s[16:19], s30 offen offset:2048 nt lds
    v_cvt_pk_bf16_f32 v54, v8, v9
    v_mfma_f32_16x16x32_bf16 v[82:85], a[140:143], a[12:15], v[16:19]
    v_exp_f32 v10, v10
    v_mfma_f32_16x16x32_bf16 v[82:85], a[136:139], a[8:11], v[82:85]
    ds_read_b64_tr_b16 a[232:233], v50 offset:57344
    ds_read_b64_tr_b16 a[234:235], v50 offset:61440
    v_mfma_f32_16x16x32_bf16 v[82:85], a[132:135], a[4:7], v[82:85]
    v_exp_f32 v11, v11
    v_mfma_f32_16x16x32_bf16 v[82:85], a[128:131], a[0:3], v[82:85]
    buffer_load_dwordx4 v93, s[16:19], s30 offen offset:3072 nt lds
    v_cvt_pk_bf16_f32 v55, v10, v11
    v_smfmac_f32_16x16x64_bf16 a[76:79], a[208:211], v[62:69], v41
    v_mfma_f32_16x16x32_bf16 v[192:195], v[62:65], a[144:147], v[192:195]
    s_waitcnt vmcnt(23)
    v_exp_f32 v12, v12
    v_mfma_f32_16x16x32_bf16 v[192:195], v[66:69], a[176:179], v[192:195]
    s_bitset1_b32 m0, 16
    ds_read_b64_tr_b16 a[236:237], v51 offset:49152
    ds_read_b64_tr_b16 a[238:239], v51 offset:53248
    v_mfma_f32_16x16x32_bf16 v[196:199], v[62:65], a[148:151], v[196:199]
    v_exp_f32 v13, v13
    v_mfma_f32_16x16x32_bf16 v[196:199], v[66:69], a[180:183], v[196:199]
    buffer_load_dwordx4 v94, s[20:23], s30 offen offset:0 nt lds
    v_cvt_pk_bf16_f32 v56, v12, v13
    v_mfma_f32_16x16x32_bf16 v[200:203], v[62:65], a[152:155], v[200:203]
    v_exp_f32 v14, v14
    v_mfma_f32_16x16x32_bf16 v[200:203], v[66:69], a[184:187], v[200:203]
    ds_read_b64_tr_b16 a[152:153], v48 offset:49152
    ds_read_b64_tr_b16 a[154:155], v48 offset:53248
    v_mfma_f32_16x16x32_bf16 v[204:207], v[62:65], a[156:159], v[204:207]
    v_exp_f32 v15, v15
    v_mfma_f32_16x16x32_bf16 v[204:207], v[66:69], a[188:191], v[204:207]
    buffer_load_dwordx4 v95, s[20:23], s30 offen offset:1024 nt lds
    v_cvt_pk_bf16_f32 v57, v14, v15
    v_mfma_f32_16x16x32_bf16 v[208:211], v[62:65], a[160:163], v[208:211]
    v_exp_f32 v78, v78
    v_mfma_f32_16x16x32_bf16 v[208:211], v[66:69], a[192:195], v[208:211]
    ds_read_b64_tr_b16 a[184:185], v48 offset:57344
    ds_read_b64_tr_b16 a[186:187], v48 offset:61440
    v_mfma_f32_16x16x32_bf16 v[212:215], v[62:65], a[164:167], v[212:215]
    v_exp_f32 v79, v79
    v_mfma_f32_16x16x32_bf16 v[212:215], v[66:69], a[196:199], v[212:215]
    buffer_load_dwordx4 v94, s[20:23], s30 offen offset:2048 nt lds
    v_cvt_pk_bf16_f32 v58, v78, v79
    v_mfma_f32_16x16x32_bf16 v[216:219], v[62:65], a[168:171], v[216:219]
    v_exp_f32 v80, v80
    v_mfma_f32_16x16x32_bf16 v[216:219], v[66:69], a[200:203], v[216:219]
    ds_read_b64_tr_b16 a[156:157], v49 offset:49152
    ds_read_b64_tr_b16 a[158:159], v49 offset:53248
    v_mfma_f32_16x16x32_bf16 v[220:223], v[62:65], a[172:175], v[220:223]
    v_exp_f32 v81, v81
    v_mfma_f32_16x16x32_bf16 v[220:223], v[66:69], a[204:207], v[220:223]
    buffer_load_dwordx4 v95, s[20:23], s30 offen offset:3072 nt lds
    v_cvt_pk_bf16_f32 v59, v80, v81
    v_mfma_f32_16x16x32_bf16 v[8:11], a[80:83], a[16:19], v[20:23]
    s_add_u32 s30, s30, 4096
    v_exp_f32 v82, v82
    v_mfma_f32_16x16x32_bf16 v[8:11], a[84:87], a[20:23], v[8:11]
    s_bitcmp0_b32 s91, s29
    s_cbranch_scc1 L_nogrow3
    s_waitcnt vmcnt(23)
    s_and_b32 m0, s30, 0xffff
    s_nop 0
    buffer_load_dwordx4 v90, s[16:19], s30 offen offset:0 nt lds
    buffer_load_dwordx4 v91, s[16:19], s30 offen offset:1024 nt lds
    buffer_load_dwordx4 v92, s[16:19], s30 offen offset:2048 nt lds
    buffer_load_dwordx4 v93, s[16:19], s30 offen offset:3072 nt lds
    s_waitcnt vmcnt(23)
    s_bitset1_b32 m0, 16
    s_nop 0
    buffer_load_dwordx4 v94, s[20:23], s30 offen offset:0 nt lds
    buffer_load_dwordx4 v95, s[20:23], s30 offen offset:1024 nt lds
    buffer_load_dwordx4 v94, s[20:23], s30 offen offset:2048 nt lds
    buffer_load_dwordx4 v95, s[20:23], s30 offen offset:3072 nt lds
    s_add_u32 s30, s30, 4096
    s_add_u32 s47, s47, 1
L_nogrow3:
    ds_read_b64_tr_b16 a[188:189], v49 offset:57344
    ds_read_b64_tr_b16 a[190:191], v49 offset:61440
    v_mfma_f32_16x16x32_bf16 v[8:11], a[88:91], a[24:27], v[8:11]
    s_waitcnt vmcnt(23)
    v_exp_f32 v83, v83
    v_mfma_f32_16x16x32_bf16 v[8:11], a[92:95], a[28:31], v[8:11]
    s_and_b32 m0, s30, 0xffff
    ds_read_b64_tr_b16 a[168:169], v52 offset:49152
    v_cvt_pk_bf16_f32 v60, v82, v83
    v_mfma_f32_16x16x32_bf16 v[12:15], a[108:111], a[28:31], v[20:23]
    v_exp_f32 v84, v84
    v_mfma_f32_16x16x32_bf16 v[12:15], a[104:107], a[24:27], v[12:15]
    buffer_load_dwordx4 v90, s[16:19], s30 offen offset:0 nt lds
    ds_read_b64_tr_b16 a[170:171], v52 offset:53248
    v_mfma_f32_16x16x32_bf16 v[12:15], a[100:103], a[20:23], v[12:15]
    v_exp_f32 v85, v85
    v_mfma_f32_16x16x32_bf16 v[12:15], a[96:99], a[16:19], v[12:15]
    buffer_load_dwordx4 v91, s[16:19], s30 offen offset:1024 nt lds
    v_cvt_pk_bf16_f32 v61, v84, v85
    v_mfma_f32_16x16x32_bf16 v[78:81], a[112:115], a[16:19], v[20:23]
    v_exp_f32 v8, v8
    v_mfma_f32_16x16x32_bf16 v[78:81], a[116:119], a[20:23], v[78:81]
    ds_read_b64_tr_b16 a[200:201], v52 offset:57344
    ds_read_b64_tr_b16 a[202:203], v52 offset:61440
    v_mfma_f32_16x16x32_bf16 v[78:81], a[120:123], a[24:27], v[78:81]
    v_exp_f32 v9, v9
    v_mfma_f32_16x16x32_bf16 v[78:81], a[124:127], a[28:31], v[78:81]
    buffer_load_dwordx4 v92, s[16:19], s30 offen offset:2048 nt lds
    v_cvt_pk_bf16_f32 v62, v8, v9
    v_mfma_f32_16x16x32_bf16 v[82:85], a[140:143], a[28:31], v[20:23]
    v_exp_f32 v10, v10
    v_mfma_f32_16x16x32_bf16 v[82:85], a[136:139], a[24:27], v[82:85]
    ds_read_b64_tr_b16 a[172:173], v53 offset:49152
    ds_read_b64_tr_b16 a[174:175], v53 offset:53248
    ds_read_b64_tr_b16 a[242:243], v51 offset:61440
    v_mfma_f32_16x16x32_bf16 v[82:85], a[132:135], a[20:23], v[82:85]
    v_exp_f32 v11, v11
    v_mfma_f32_16x16x32_bf16 v[82:85], a[128:131], a[16:19], v[82:85]
    buffer_load_dwordx4 v93, s[16:19], s30 offen offset:3072 nt lds
    ds_read_b64_tr_b16 a[240:241], v51 offset:57344
    v_cvt_pk_bf16_f32 v63, v10, v11
    v_smfmac_f32_16x16x64_bf16 a[64:67], a[208:211], v[54:61], v41
    v_mfma_f32_16x16x32_bf16 v[96:99], v[54:57], a[212:215], v[96:99]
    s_waitcnt vmcnt(23)
    v_exp_f32 v12, v12
    v_mfma_f32_16x16x32_bf16 v[96:99], v[58:61], a[216:219], v[96:99]
    s_waitcnt lgkmcnt(6)
    s_bitset1_b32 m0, 16
    ds_read_b64_tr_b16 a[204:205], v53 offset:57344
    ds_read_b64_tr_b16 a[206:207], v53 offset:61440
    v_mfma_f32_16x16x32_bf16 v[100:103], v[54:57], a[220:223], v[100:103]
    v_exp_f32 v13, v13
    v_mfma_f32_16x16x32_bf16 v[100:103], v[58:61], a[224:227], v[100:103]
    buffer_load_dwordx4 v94, s[20:23], s30 offen offset:0 nt lds
    v_cvt_pk_bf16_f32 v64, v12, v13
    v_mfma_f32_16x16x32_bf16 v[104:107], v[54:57], a[152:155], v[104:107]
    v_exp_f32 v14, v14
    v_mfma_f32_16x16x32_bf16 v[104:107], v[58:61], a[184:187], v[104:107]
    v_mfma_f32_16x16x32_bf16 v[108:111], v[54:57], a[156:159], v[108:111]
    v_exp_f32 v15, v15
    v_mfma_f32_16x16x32_bf16 v[108:111], v[58:61], a[188:191], v[108:111]
    buffer_load_dwordx4 v95, s[20:23], s30 offen offset:1024 nt lds
    v_cvt_pk_bf16_f32 v65, v14, v15
    v_mfma_f32_16x16x32_bf16 v[112:115], v[54:57], a[228:231], v[112:115]
    v_exp_f32 v78, v78
    v_mfma_f32_16x16x32_bf16 v[112:115], v[58:61], a[232:235], v[112:115]
    v_mfma_f32_16x16x32_bf16 v[116:119], v[54:57], a[236:239], v[116:119]
    s_waitcnt lgkmcnt(2)
    v_exp_f32 v79, v79
    v_mfma_f32_16x16x32_bf16 v[116:119], v[58:61], a[240:243], v[116:119]
    buffer_load_dwordx4 v94, s[20:23], s30 offen offset:2048 nt lds
    v_cvt_pk_bf16_f32 v66, v78, v79
    v_mfma_f32_16x16x32_bf16 v[120:123], v[54:57], a[168:171], v[120:123]
    v_exp_f32 v80, v80
    v_mfma_f32_16x16x32_bf16 v[120:123], v[58:61], a[200:203], v[120:123]
    v_mfma_f32_16x16x32_bf16 v[124:127], v[54:57], a[172:175], v[124:127]
    s_waitcnt lgkmcnt(0)
    v_exp_f32 v81, v81
    v_mfma_f32_16x16x32_bf16 v[124:127], v[58:61], a[204:207], v[124:127]
    buffer_load_dwordx4 v95, s[20:23], s30 offen offset:3072 nt lds
    v_cvt_pk_bf16_f32 v67, v80, v81
    v_mfma_f32_16x16x32_bf16 v[8:11], a[80:83], a[32:35], v[24:27]
    s_add_u32 s30, s30, 4096
    v_exp_f32 v82, v82
    v_mfma_f32_16x16x32_bf16 v[8:11], a[84:87], a[36:39], v[8:11]
    s_waitcnt vmcnt(23)
    v_mfma_f32_16x16x32_bf16 v[8:11], a[88:91], a[40:43], v[8:11]
    s_and_b32 m0, s30, 0xffff
    v_exp_f32 v83, v83
    v_mfma_f32_16x16x32_bf16 v[8:11], a[92:95], a[44:47], v[8:11]
    buffer_load_dwordx4 v90, s[16:19], s30 offen offset:0 nt lds
    v_cvt_pk_bf16_f32 v68, v82, v83
    v_mfma_f32_16x16x32_bf16 v[12:15], a[108:111], a[44:47], v[24:27]
    v_exp_f32 v84, v84
    v_mfma_f32_16x16x32_bf16 v[12:15], a[104:107], a[40:43], v[12:15]
    v_mfma_f32_16x16x32_bf16 v[12:15], a[100:103], a[36:39], v[12:15]
    v_exp_f32 v85, v85
    v_mfma_f32_16x16x32_bf16 v[12:15], a[96:99], a[32:35], v[12:15]
    buffer_load_dwordx4 v91, s[16:19], s30 offen offset:1024 nt lds
    v_cvt_pk_bf16_f32 v69, v84, v85
    v_mfma_f32_16x16x32_bf16 v[78:81], a[112:115], a[32:35], v[24:27]
    v_exp_f32 v8, v8
    v_mfma_f32_16x16x32_bf16 v[78:81], a[116:119], a[36:39], v[78:81]
    v_mfma_f32_16x16x32_bf16 v[78:81], a[120:123], a[40:43], v[78:81]
    v_exp_f32 v9, v9
    v_mfma_f32_16x16x32_bf16 v[78:81], a[124:127], a[44:47], v[78:81]
    buffer_load_dwordx4 v92, s[16:19], s30 offen offset:2048 nt lds
    v_cvt_pk_bf16_f32 v54, v8, v9
    v_mfma_f32_16x16x32_bf16 v[82:85], a[140:143], a[44:47], v[24:27]
    v_exp_f32 v10, v10
    v_mfma_f32_16x16x32_bf16 v[82:85], a[136:139], a[40:43], v[82:85]
    v_mfma_f32_16x16x32_bf16 v[82:85], a[132:135], a[36:39], v[82:85]
    v_exp_f32 v11, v11
    v_mfma_f32_16x16x32_bf16 v[82:85], a[128:131], a[32:35], v[82:85]
    buffer_load_dwordx4 v93, s[16:19], s30 offen offset:3072 nt lds
    v_cvt_pk_bf16_f32 v55, v10, v11
    v_smfmac_f32_16x16x64_bf16 a[68:71], a[208:211], v[62:69], v41
    v_mfma_f32_16x16x32_bf16 v[128:131], v[62:65], a[212:215], v[128:131]
    s_waitcnt vmcnt(23)
    v_exp_f32 v12, v12
    v_mfma_f32_16x16x32_bf16 v[128:131], v[66:69], a[216:219], v[128:131]
    s_bitset1_b32 m0, 16
    v_mfma_f32_16x16x32_bf16 v[132:135], v[62:65], a[220:223], v[132:135]
    v_exp_f32 v13, v13
    v_mfma_f32_16x16x32_bf16 v[132:135], v[66:69], a[224:227], v[132:135]
    buffer_load_dwordx4 v94, s[20:23], s30 offen offset:0 nt lds
    v_cvt_pk_bf16_f32 v56, v12, v13
    v_mfma_f32_16x16x32_bf16 v[136:139], v[62:65], a[152:155], v[136:139]
    v_exp_f32 v14, v14
    v_mfma_f32_16x16x32_bf16 v[136:139], v[66:69], a[184:187], v[136:139]
    v_mfma_f32_16x16x32_bf16 v[140:143], v[62:65], a[156:159], v[140:143]
    v_exp_f32 v15, v15
    v_mfma_f32_16x16x32_bf16 v[140:143], v[66:69], a[188:191], v[140:143]
    s_cmp_gt_u32 s47, 2
    s_cbranch_scc1 L_nw7
    s_waitcnt vmcnt(21)
    s_cmp_gt_u32 s47, 1
    s_cbranch_scc1 L_nw7
    s_waitcnt vmcnt(13)
    s_cmp_gt_u32 s47, 0
    s_cbranch_scc1 L_nw7
    s_waitcnt vmcnt(5)
L_nw7:
    buffer_load_dwordx4 v95, s[20:23], s30 offen offset:1024 nt lds
    v_cvt_pk_bf16_f32 v57, v14, v15
    v_mfma_f32_16x16x32_bf16 v[144:147], v[62:65], a[228:231], v[144:147]
    s_barrier
    v_exp_f32 v78, v78
    v_mfma_f32_16x16x32_bf16 v[144:147], v[66:69], a[232:235], v[144:147]
    ds_read_b64_tr_b16 a[144:145], v46 offset:0
    ds_read_b64_tr_b16 a[146:147], v46 offset:4096
    v_mfma_f32_16x16x32_bf16 v[148:151], v[62:65], a[236:239], v[148:151]
    v_exp_f32 v79, v79
    v_mfma_f32_16x16x32_bf16 v[148:151], v[66:69], a[240:243], v[148:151]
    buffer_load_dwordx4 v94, s[20:23], s30 offen offset:2048 nt lds
    v_cvt_pk_bf16_f32 v58, v78, v79
    v_mfma_f32_16x16x32_bf16 v[152:155], v[62:65], a[168:171], v[152:155]
    v_exp_f32 v80, v80
    v_mfma_f32_16x16x32_bf16 v[152:155], v[66:69], a[200:203], v[152:155]
    ds_read_b64_tr_b16 a[176:177], v46 offset:8192
    ds_read_b64_tr_b16 a[178:179], v46 offset:12288
    v_mfma_f32_16x16x32_bf16 v[156:159], v[62:65], a[172:175], v[156:159]
    v_exp_f32 v81, v81
    v_mfma_f32_16x16x32_bf16 v[156:159], v[66:69], a[204:207], v[156:159]
    buffer_load_dwordx4 v95, s[20:23], s30 offen offset:3072 nt lds
    v_cvt_pk_bf16_f32 v59, v80, v81
    v_mfma_f32_16x16x32_bf16 v[8:11], a[80:83], a[48:51], v[28:31]
    s_add_u32 s30, s30, 4096
    v_exp_f32 v82, v82
    v_mfma_f32_16x16x32_bf16 v[8:11], a[84:87], a[52:55], v[8:11]
    s_waitcnt vmcnt(23)
    ds_read_b128 a[80:83], v42 offset:0
    ds_read_b128 a[84:87], v43 offset:0
    v_mfma_f32_16x16x32_bf16 v[8:11], a[88:91], a[56:59], v[8:11]
    s_and_b32 m0, s30, 0xffff
    v_exp_f32 v83, v83
    v_mfma_f32_16x16x32_bf16 v[8:11], a[92:95], a[60:63], v[8:11]
    buffer_load_dwordx4 v90, s[16:19], s30 offen offset:0 nt lds
    v_cvt_pk_bf16_f32 v60, v82, v83
    v_mfma_f32_16x16x32_bf16 v[12:15], a[108:111], a[60:63], v[28:31]
    v_exp_f32 v84, v84
    v_mfma_f32_16x16x32_bf16 v[12:15], a[104:107], a[56:59], v[12:15]
    ds_read_b128 a[88:91], v44 offset:0
    ds_read_b128 a[92:95], v45 offset:0
    v_mfma_f32_16x16x32_bf16 v[12:15], a[100:103], a[52:55], v[12:15]
    v_exp_f32 v85, v85
    v_mfma_f32_16x16x32_bf16 v[12:15], a[96:99], a[48:51], v[12:15]
    buffer_load_dwordx4 v91, s[16:19], s30 offen offset:1024 nt lds
    v_cvt_pk_bf16_f32 v61, v84, v85
    v_mfma_f32_16x16x32_bf16 v[78:81], a[112:115], a[48:51], v[28:31]
    v_exp_f32 v8, v8
    v_mfma_f32_16x16x32_bf16 v[78:81], a[116:119], a[52:55], v[78:81]
    ds_read_b128 a[108:111], v45 offset:4096
    ds_read_b128 a[104:107], v44 offset:4096
    v_mfma_f32_16x16x32_bf16 v[78:81], a[120:123], a[56:59], v[78:81]
    v_exp_f32 v9, v9
    v_mfma_f32_16x16x32_bf16 v[78:81], a[124:127], a[60:63], v[78:81]
    buffer_load_dwordx4 v92, s[16:19], s30 offen offset:2048 nt lds
    v_cvt_pk_bf16_f32 v62, v8, v9
    v_mfma_f32_16x16x32_bf16 v[82:85], a[140:143], a[60:63], v[28:31]
    v_exp_f32 v10, v10
    v_mfma_f32_16x16x32_bf16 v[82:85], a[136:139], a[56:59], v[82:85]
    ds_read_b128 a[100:103], v43 offset:4096
    ds_read_b128 a[96:99], v42 offset:4096
    v_mfma_f32_16x16x32_bf16 v[82:85], a[132:135], a[52:55], v[82:85]
    v_exp_f32 v11, v11
    v_mfma_f32_16x16x32_bf16 v[82:85], a[128:131], a[48:51], v[82:85]
    buffer_load_dwordx4 v93, s[16:19], s30 offen offset:3072 nt lds
    v_cvt_pk_bf16_f32 v63, v10, v11
    v_smfmac_f32_16x16x64_bf16 a[72:75], a[208:211], v[54:61], v41
    v_mfma_f32_16x16x32_bf16 v[160:163], v[54:57], a[212:215], v[160:163]
    s_waitcnt vmcnt(23)
    v_exp_f32 v12, v12
    v_mfma_f32_16x16x32_bf16 v[160:163], v[58:61], a[216:219], v[160:163]
    s_bitset1_b32 m0, 16
    ds_read_b128 a[112:115], v42 offset:8192
    ds_read_b128 a[116:119], v43 offset:8192
    v_mfma_f32_16x16x32_bf16 v[164:167], v[54:57], a[220:223], v[164:167]
    v_exp_f32 v13, v13
    v_mfma_f32_16x16x32_bf16 v[164:167], v[58:61], a[224:227], v[164:167]
    buffer_load_dwordx4 v94, s[20:23], s30 offen offset:0 nt lds
    v_cvt_pk_bf16_f32 v64, v12, v13
    v_mfma_f32_16x16x32_bf16 v[168:171], v[54:57], a[152:155], v[168:171]
    v_exp_f32 v14, v14
    v_mfma_f32_16x16x32_bf16 v[168:171], v[58:61], a[184:187], v[168:171]
    ds_read_b128 a[120:123], v44 offset:8192
    ds_read_b128 a[124:127], v45 offset:8192
    v_mfma_f32_16x16x32_bf16 v[172:175], v[54:57], a[156:159], v[172:175]
    v_exp_f32 v15, v15
    v_mfma_f32_16x16x32_bf16 v[172:175], v[58:61], a[188:191], v[172:175]
    buffer_load_dwordx4 v95, s[20:23], s30 offen offset:1024 nt lds
    v_cvt_pk_bf16_f32 v65, v14, v15
    v_mfma_f32_16x16x32_bf16 v[176:179], v[54:57], a[228:231], v[176:179]
    v_exp_f32 v78, v78
    v_mfma_f32_16x16x32_bf16 v[176:179], v[58:61], a[232:235], v[176:179]
    ds_read_b128 a[140:143], v45 offset:12288
    ds_read_b128 a[136:139], v44 offset:12288
    v_mfma_f32_16x16x32_bf16 v[180:183], v[54:57], a[236:239], v[180:183]
    v_exp_f32 v79, v79
    v_mfma_f32_16x16x32_bf16 v[180:183], v[58:61], a[240:243], v[180:183]
    buffer_load_dwordx4 v94, s[20:23], s30 offen offset:2048 nt lds
    v_cvt_pk_bf16_f32 v66, v78, v79
    v_mfma_f32_16x16x32_bf16 v[184:187], v[54:57], a[168:171], v[184:187]
    v_exp_f32 v80, v80
    v_mfma_f32_16x16x32_bf16 v[184:187], v[58:61], a[200:203], v[184:187]
    ds_read_b128 a[132:135], v43 offset:12288
    ds_read_b128 a[128:131], v42 offset:12288
    v_mfma_f32_16x16x32_bf16 v[188:191], v[54:57], a[172:175], v[188:191]
    v_exp_f32 v81, v81
    v_mfma_f32_16x16x32_bf16 v[188:191], v[58:61], a[204:207], v[188:191]
    s_waitcnt lgkmcnt(6)
    buffer_load_dwordx4 v95, s[20:23], s30 offen offset:3072 nt lds
    v_cvt_pk_bf16_f32 v67, v80, v81
    s_branch L_loop_w4
L_exit_w4:
    s_waitcnt lgkmcnt(0)
    v_mfma_f32_16x16x32_bf16 v[8:11], a[80:83], a[0:3], v[16:19]
    v_exp_f32 v82, v82
    v_mfma_f32_16x16x32_bf16 v[8:11], a[84:87], a[4:7], v[8:11]
    ds_read_b64_tr_b16 a[220:221], v47 offset:49152
    ds_read_b64_tr_b16 a[222:223], v47 offset:53248
    v_mfma_f32_16x16x32_bf16 v[8:11], a[88:91], a[8:11], v[8:11]
    v_exp_f32 v83, v83
    v_mfma_f32_16x16x32_bf16 v[8:11], a[92:95], a[12:15], v[8:11]
    ds_read_b64_tr_b16 a[224:225], v47 offset:57344
    v_cvt_pk_bf16_f32 v68, v82, v83
    v_mfma_f32_16x16x32_bf16 v[12:15], a[108:111], a[12:15], v[16:19]
    v_exp_f32 v84, v84
    v_mfma_f32_16x16x32_bf16 v[12:15], a[104:107], a[8:11], v[12:15]
    ds_read_b64_tr_b16 a[226:227], v47 offset:61440
    ds_read_b64_tr_b16 a[228:229], v50 offset:49152
    v_mfma_f32_16x16x32_bf16 v[12:15], a[100:103], a[4:7], v[12:15]
    v_exp_f32 v85, v85
    v_mfma_f32_16x16x32_bf16 v[12:15], a[96:99], a[0:3], v[12:15]
    ds_read_b64_tr_b16 a[230:231], v50 offset:53248
    v_cvt_pk_bf16_f32 v69, v84, v85
    v_mfma_f32_16x16x32_bf16 v[78:81], a[112:115], a[0:3], v[16:19]
    v_exp_f32 v8, v8
    v_mfma_f32_16x16x32_bf16 v[78:81], a[116:119], a[4:7], v[78:81]
    ds_read_b64_tr_b16 a[232:233], v50 offset:57344
    ds_read_b64_tr_b16 a[234:235], v50 offset:61440
    v_mfma_f32_16x16x32_bf16 v[78:81], a[120:123], a[8:11], v[78:81]
    v_exp_f32 v9, v9
    v_mfma_f32_16x16x32_bf16 v[78:81], a[124:127], a[12:15], v[78:81]
    ds_read_b64_tr_b16 a[236:237], v51 offset:49152
    v_cvt_pk_bf16_f32 v54, v8, v9
    v_mfma_f32_16x16x32_bf16 v[82:85], a[140:143], a[12:15], v[16:19]
    v_exp_f32 v10, v10
    v_mfma_f32_16x16x32_bf16 v[82:85], a[136:139], a[8:11], v[82:85]
    ds_read_b64_tr_b16 a[238:239], v51 offset:53248
    ds_read_b64_tr_b16 a[240:241], v51 offset:57344
    v_mfma_f32_16x16x32_bf16 v[82:85], a[132:135], a[4:7], v[82:85]
    v_exp_f32 v11, v11
    v_mfma_f32_16x16x32_bf16 v[82:85], a[128:131], a[0:3], v[82:85]
    ds_read_b64_tr_b16 a[242:243], v51 offset:61440
    v_cvt_pk_bf16_f32 v55, v10, v11
    v_smfmac_f32_16x16x64_bf16 a[76:79], a[208:211], v[62:69], v41
    v_mfma_f32_16x16x32_bf16 v[192:195], v[62:65], a[144:147], v[192:195]
    v_exp_f32 v12, v12
    v_mfma_f32_16x16x32_bf16 v[192:195], v[66:69], a[176:179], v[192:195]
    v_mfma_f32_16x16x32_bf16 v[196:199], v[62:65], a[148:151], v[196:199]
    v_exp_f32 v13, v13
    v_mfma_f32_16x16x32_bf16 v[196:199], v[66:69], a[180:183], v[196:199]
    v_cvt_pk_bf16_f32 v56, v12, v13
    v_mfma_f32_16x16x32_bf16 v[200:203], v[62:65], a[152:155], v[200:203]
    v_exp_f32 v14, v14
    v_mfma_f32_16x16x32_bf16 v[200:203], v[66:69], a[184:187], v[200:203]
    ds_read_b64_tr_b16 a[152:153], v48 offset:49152
    ds_read_b64_tr_b16 a[154:155], v48 offset:53248
    v_mfma_f32_16x16x32_bf16 v[204:207], v[62:65], a[156:159], v[204:207]
    v_exp_f32 v15, v15
    v_mfma_f32_16x16x32_bf16 v[204:207], v[66:69], a[188:191], v[204:207]
    ds_read_b64_tr_b16 a[184:185], v48 offset:57344
    v_cvt_pk_bf16_f32 v57, v14, v15
    v_mfma_f32_16x16x32_bf16 v[208:211], v[62:65], a[160:163], v[208:211]
    v_exp_f32 v78, v78
    v_mfma_f32_16x16x32_bf16 v[208:211], v[66:69], a[192:195], v[208:211]
    ds_read_b64_tr_b16 a[186:187], v48 offset:61440
    ds_read_b64_tr_b16 a[156:157], v49 offset:49152
    v_mfma_f32_16x16x32_bf16 v[212:215], v[62:65], a[164:167], v[212:215]
    v_exp_f32 v79, v79
    v_mfma_f32_16x16x32_bf16 v[212:215], v[66:69], a[196:199], v[212:215]
    ds_read_b64_tr_b16 a[158:159], v49 offset:53248
    v_cvt_pk_bf16_f32 v58, v78, v79
    v_mfma_f32_16x16x32_bf16 v[216:219], v[62:65], a[168:171], v[216:219]
    v_exp_f32 v80, v80
    v_mfma_f32_16x16x32_bf16 v[216:219], v[66:69], a[200:203], v[216:219]
    ds_read_b64_tr_b16 a[188:189], v49 offset:57344
    ds_read_b64_tr_b16 a[190:191], v49 offset:61440
    v_mfma_f32_16x16x32_bf16 v[220:223], v[62:65], a[172:175], v[220:223]
    v_exp_f32 v81, v81
    v_mfma_f32_16x16x32_bf16 v[220:223], v[66:69], a[204:207], v[220:223]
    ds_read_b64_tr_b16 a[168:169], v52 offset:49152
    v_cvt_pk_bf16_f32 v59, v80, v81
    v_mfma_f32_16x16x32_bf16 v[8:11], a[80:83], a[16:19], v[20:23]
    v_exp_f32 v82, v82
    v_mfma_f32_16x16x32_bf16 v[8:11], a[84:87], a[20:23], v[8:11]
    ds_read_b64_tr_b16 a[170:171], v52 offset:53248
    ds_read_b64_tr_b16 a[200:201], v52 offset:57344
    v_mfma_f32_16x16x32_bf16 v[8:11], a[88:91], a[24:27], v[8:11]
    v_exp_f32 v83, v83
    v_mfma_f32_16x16x32_bf16 v[8:11], a[92:95], a[28:31], v[8:11]
    ds_read_b64_tr_b16 a[202:203], v52 offset:61440
    v_cvt_pk_bf16_f32 v60, v82, v83
    v_mfma_f32_16x16x32_bf16 v[12:15], a[108:111], a[28:31], v[20:23]
    v_exp_f32 v84, v84
    v_mfma_f32_16x16x32_bf16 v[12:15], a[104:107], a[24:27], v[12:15]
    ds_read_b64_tr_b16 a[172:173], v53 offset:49152
    ds_read_b64_tr_b16 a[174:175], v53 offset:53248
    v_mfma_f32_16x16x32_bf16 v[12:15], a[100:103], a[20:23], v[12:15]
    v_exp_f32 v85, v85
    v_mfma_f32_16x16x32_bf16 v[12:15], a[96:99], a[16:19], v[12:15]
    ds_read_b64_tr_b16 a[204:205], v53 offset:57344
    v_cvt_pk_bf16_f32 v61, v84, v85
    v_mfma_f32_16x16x32_bf16 v[78:81], a[112:115], a[16:19], v[20:23]
    v_exp_f32 v8, v8
    v_mfma_f32_16x16x32_bf16 v[78:81], a[116:119], a[20:23], v[78:81]
    ds_read_b64_tr_b16 a[206:207], v53 offset:61440
    v_mfma_f32_16x16x32_bf16 v[78:81], a[120:123], a[24:27], v[78:81]
    v_exp_f32 v9, v9
    v_mfma_f32_16x16x32_bf16 v[78:81], a[124:127], a[28:31], v[78:81]
    v_cvt_pk_bf16_f32 v62, v8, v9
    v_mfma_f32_16x16x32_bf16 v[82:85], a[140:143], a[28:31], v[20:23]
    v_exp_f32 v10, v10
    v_mfma_f32_16x16x32_bf16 v[82:85], a[136:139], a[24:27], v[82:85]
    v_mfma_f32_16x16x32_bf16 v[82:85], a[132:135], a[20:23], v[82:85]
    v_exp_f32 v11, v11
    v_mfma_f32_16x16x32_bf16 v[82:85], a[128:131], a[16:19], v[82:85]
    v_cvt_pk_bf16_f32 v63, v10, v11
    v_smfmac_f32_16x16x64_bf16 a[64:67], a[208:211], v[54:61], v41
    v_mfma_f32_16x16x32_bf16 v[96:99], v[54:57], a[212:215], v[96:99]
    v_exp_f32 v12, v12
    v_mfma_f32_16x16x32_bf16 v[96:99], v[58:61], a[216:219], v[96:99]
    s_waitcnt lgkmcnt(2)
    v_mfma_f32_16x16x32_bf16 v[100:103], v[54:57], a[220:223], v[100:103]
    v_exp_f32 v13, v13
    v_mfma_f32_16x16x32_bf16 v[100:103], v[58:61], a[224:227], v[100:103]
    v_cvt_pk_bf16_f32 v64, v12, v13
    v_mfma_f32_16x16x4_f32 v[16:19], a64, v75, 0
    v_mfma_f32_16x16x4_f32 v[16:19], a65, v75, v[16:19]
    v_mfma_f32_16x16x32_bf16 v[104:107], v[54:57], a[152:155], v[104:107]
    v_exp_f32 v14, v14
    v_mfma_f32_16x16x32_bf16 v[104:107], v[58:61], a[184:187], v[104:107]
    v_mfma_f32_16x16x32_bf16 v[108:111], v[54:57], a[156:159], v[108:111]
    v_exp_f32 v15, v15
    v_mfma_f32_16x16x32_bf16 v[108:111], v[58:61], a[188:191], v[108:111]
    v_cvt_pk_bf16_f32 v65, v14, v15
    v_mfma_f32_16x16x32_bf16 v[112:115], v[54:57], a[228:231], v[112:115]
    v_exp_f32 v78, v78
    s_nop 0
    v_max3_f32 v5, v16, v17, v18
    v_rcp_f32 v16, v16
    v_mfma_f32_16x16x32_bf16 v[112:115], v[58:61], a[232:235], v[112:115]
    v_max_f32 v5, v5, v19
    v_rcp_f32 v17, v17
    v_cmp_nlt_f32 vcc, v5, s46
    v_rcp_f32 v18, v18
    v_mfma_f32_16x16x32_bf16 v[116:119], v[54:57], a[236:239], v[116:119]
    v_exp_f32 v79, v79
    v_rcp_f32 v19, v19
    s_or_b64 s[44:45], s[44:45], vcc
    v_mfma_f32_16x16x32_bf16 v[116:119], v[58:61], a[240:243], v[116:119]
    v_cvt_pk_bf16_f32 v66, v78, v79
    v_pk_mul_f32 v[96:97], v[96:97], v[16:17]
    v_pk_mul_f32 v[98:99], v[98:99], v[18:19]
    v_pk_mul_f32 v[100:101], v[100:101], v[16:17]
    v_pk_mul_f32 v[102:103], v[102:103], v[18:19]
    v_pk_mul_f32 v[104:105], v[104:105], v[16:17]
    v_pk_mul_f32 v[106:107], v[106:107], v[18:19]
    v_pk_mul_f32 v[108:109], v[108:109], v[16:17]
    v_pk_mul_f32 v[110:111], v[110:111], v[18:19]
    v_mfma_f32_16x16x32_bf16 v[120:123], v[54:57], a[168:171], v[120:123]
    v_exp_f32 v80, v80
    v_cvt_pk_bf16_f32 v86, v96, v100
    v_cvt_pk_bf16_f32 v87, v104, v108
    v_mfma_f32_16x16x32_bf16 v[120:123], v[58:61], a[200:203], v[120:123]
    v_cvt_pk_bf16_f32 v88, v97, v101
    v_cvt_pk_bf16_f32 v89, v105, v109
    v_cvt_pk_bf16_f32 v96, v98, v102
    v_cvt_pk_bf16_f32 v97, v106, v110
    v_mfma_f32_16x16x32_bf16 v[124:127], v[54:57], a[172:175], v[124:127]
    v_exp_f32 v81, v81
    v_cvt_pk_bf16_f32 v100, v99, v103
    v_cvt_pk_bf16_f32 v101, v107, v111
    s_waitcnt lgkmcnt(0)
    v_mfma_f32_16x16x32_bf16 v[124:127], v[58:61], a[204:207], v[124:127]
    ds_write_b64 v70, v[86:87] offset:0
    ds_write_b64 v71, v[88:89] offset:0
    v_cvt_pk_bf16_f32 v67, v80, v81
    v_mfma_f32_16x16x32_bf16 v[8:11], a[80:83], a[32:35], v[24:27]
    v_exp_f32 v82, v82
    v_mfma_f32_16x16x32_bf16 v[8:11], a[84:87], a[36:39], v[8:11]
    ds_write_b64 v70, v[96:97] offset:512
    ds_write_b64 v71, v[100:101] offset:512
    v_mfma_f32_16x16x32_bf16 v[8:11], a[88:91], a[40:43], v[8:11]
    v_exp_f32 v83, v83
    v_pk_mul_f32 v[112:113], v[112:113], v[16:17]
    v_pk_mul_f32 v[114:115], v[114:115], v[18:19]
    v_pk_mul_f32 v[116:117], v[116:117], v[16:17]
    v_pk_mul_f32 v[118:119], v[118:119], v[18:19]
    v_pk_mul_f32 v[120:121], v[120:121], v[16:17]
    v_pk_mul_f32 v[122:123], v[122:123], v[18:19]
    v_pk_mul_f32 v[124:125], v[124:125], v[16:17]
    v_pk_mul_f32 v[126:127], v[126:127], v[18:19]
    v_mfma_f32_16x16x32_bf16 v[8:11], a[92:95], a[44:47], v[8:11]
    v_cvt_pk_bf16_f32 v68, v82, v83
    v_cvt_pk_bf16_f32 v86, v112, v116
    v_cvt_pk_bf16_f32 v87, v120, v124
    v_cvt_pk_bf16_f32 v88, v113, v117
    v_mfma_f32_16x16x32_bf16 v[12:15], a[108:111], a[44:47], v[24:27]
    v_exp_f32 v84, v84
    v_cvt_pk_bf16_f32 v89, v121, v125
    v_cvt_pk_bf16_f32 v112, v114, v118
    v_mfma_f32_16x16x32_bf16 v[12:15], a[104:107], a[40:43], v[12:15]
    v_cvt_pk_bf16_f32 v113, v122, v126
    v_cvt_pk_bf16_f32 v116, v115, v119
    v_cvt_pk_bf16_f32 v117, v123, v127
    v_mfma_f32_16x16x32_bf16 v[12:15], a[100:103], a[36:39], v[12:15]
    v_exp_f32 v85, v85
    v_mfma_f32_16x16x32_bf16 v[12:15], a[96:99], a[32:35], v[12:15]
    ds_write_b64 v70, v[86:87] offset:128
    ds_write_b64 v71, v[88:89] offset:128
    v_cvt_pk_bf16_f32 v69, v84, v85
    v_mfma_f32_16x16x32_bf16 v[78:81], a[112:115], a[32:35], v[24:27]
    v_exp_f32 v8, v8
    v_mfma_f32_16x16x32_bf16 v[78:81], a[116:119], a[36:39], v[78:81]
    ds_write_b64 v70, v[112:113] offset:640
    ds_write_b64 v71, v[116:117] offset:640
    v_mfma_f32_16x16x32_bf16 v[78:81], a[120:123], a[40:43], v[78:81]
    v_exp_f32 v9, v9
    v_mfma_f32_16x16x32_bf16 v[78:81], a[124:127], a[44:47], v[78:81]
    ds_read_b64_tr_b16 v[104:105], v72 offset:0
    ds_read_b64_tr_b16 v[106:107], v73 offset:0
    v_cvt_pk_bf16_f32 v54, v8, v9
    v_mfma_f32_16x16x32_bf16 v[82:85], a[140:143], a[44:47], v[24:27]
    v_exp_f32 v10, v10
    v_mfma_f32_16x16x32_bf16 v[82:85], a[136:139], a[40:43], v[82:85]
    ds_read_b64_tr_b16 v[108:109], v72 offset:1024
    ds_read_b64_tr_b16 v[110:111], v73 offset:1024
    v_mfma_f32_16x16x32_bf16 v[82:85], a[132:135], a[36:39], v[82:85]
    v_exp_f32 v11, v11
    v_mfma_f32_16x16x32_bf16 v[82:85], a[128:131], a[32:35], v[82:85]
    ds_read_b64_tr_b16 v[120:121], v72 offset:2048
    ds_read_b64_tr_b16 v[122:123], v73 offset:2048
    v_cvt_pk_bf16_f32 v55, v10, v11
    v_smfmac_f32_16x16x64_bf16 a[68:71], a[208:211], v[62:69], v41
    v_mfma_f32_16x16x32_bf16 v[128:131], v[62:65], a[212:215], v[128:131]
    v_exp_f32 v12, v12
    v_mfma_f32_16x16x32_bf16 v[128:131], v[66:69], a[216:219], v[128:131]
    ds_read_b64_tr_b16 v[124:125], v72 offset:3072
    ds_read_b64_tr_b16 v[126:127], v73 offset:3072
    v_mfma_f32_16x16x32_bf16 v[132:135], v[62:65], a[220:223], v[132:135]
    v_exp_f32 v13, v13
    v_mfma_f32_16x16x32_bf16 v[132:135], v[66:69], a[224:227], v[132:135]
    v_cvt_pk_bf16_f32 v56, v12, v13
    v_mfma_f32_16x16x4_f32 v[20:23], a68, v75, 0
    v_mfma_f32_16x16x4_f32 v[20:23], a69, v75, v[20:23]
    v_mfma_f32_16x16x32_bf16 v[136:139], v[62:65], a[152:155], v[136:139]
    v_exp_f32 v14, v14
    v_mfma_f32_16x16x32_bf16 v[136:139], v[66:69], a[184:187], v[136:139]
    v_mfma_f32_16x16x32_bf16 v[140:143], v[62:65], a[156:159], v[140:143]
    v_exp_f32 v15, v15
    v_mfma_f32_16x16x32_bf16 v[140:143], v[66:69], a[188:191], v[140:143]
    s_add_u32 s35, s36, 0
    s_waitcnt lgkmcnt(4)
    buffer_store_dwordx4 v[104:107], v6, s[24:27], s35 offen offset:0 sc1 nt
    v_cvt_pk_bf16_f32 v57, v14, v15
    v_mfma_f32_16x16x32_bf16 v[144:147], v[62:65], a[228:231], v[144:147]
    buffer_store_dwordx4 v[108:111], v6, s[24:27], s35 offen offset:1024 sc1 nt
    v_exp_f32 v78, v78
    v_max3_f32 v5, v20, v21, v22
    v_rcp_f32 v20, v20
    v_mfma_f32_16x16x32_bf16 v[144:147], v[66:69], a[232:235], v[144:147]
    s_waitcnt lgkmcnt(2)
    buffer_store_dwordx4 v[120:123], v6, s[24:27], s35 offen offset:2048 sc1 nt
    v_max_f32 v5, v5, v23
    v_rcp_f32 v21, v21
    v_cmp_nlt_f32 vcc, v5, s46
    v_rcp_f32 v22, v22
    v_mfma_f32_16x16x32_bf16 v[148:151], v[62:65], a[236:239], v[148:151]
    s_waitcnt lgkmcnt(0)
    buffer_store_dwordx4 v[124:127], v6, s[24:27], s35 offen offset:3072 sc1 nt
    v_exp_f32 v79, v79
    v_rcp_f32 v23, v23
    s_or_b64 s[44:45], s[44:45], vcc
    v_mfma_f32_16x16x32_bf16 v[148:151], v[66:69], a[240:243], v[148:151]
    v_cvt_pk_bf16_f32 v58, v78, v79
    v_pk_mul_f32 v[128:129], v[128:129], v[20:21]
    v_pk_mul_f32 v[130:131], v[130:131], v[22:23]
    v_pk_mul_f32 v[132:133], v[132:133], v[20:21]
    v_pk_mul_f32 v[134:135], v[134:135], v[22:23]
    v_pk_mul_f32 v[136:137], v[136:137], v[20:21]
    v_pk_mul_f32 v[138:139], v[138:139], v[22:23]
    v_pk_mul_f32 v[140:141], v[140:141], v[20:21]
    v_pk_mul_f32 v[142:143], v[142:143], v[22:23]
    v_mfma_f32_16x16x32_bf16 v[152:155], v[62:65], a[168:171], v[152:155]
    v_exp_f32 v80, v80
    v_cvt_pk_bf16_f32 v86, v128, v132
    v_cvt_pk_bf16_f32 v87, v136, v140
    v_mfma_f32_16x16x32_bf16 v[152:155], v[66:69], a[200:203], v[152:155]
    v_cvt_pk_bf16_f32 v88, v129, v133
    v_cvt_pk_bf16_f32 v89, v137, v141
    v_cvt_pk_bf16_f32 v128, v130, v134
    v_cvt_pk_bf16_f32 v129, v138, v142
    v_mfma_f32_16x16x32_bf16 v[156:159], v[62:65], a[172:175], v[156:159]
    v_exp_f32 v81, v81
    v_cvt_pk_bf16_f32 v132, v131, v135
    v_cvt_pk_bf16_f32 v133, v139, v143
    v_mfma_f32_16x16x32_bf16 v[156:159], v[66:69], a[204:207], v[156:159]
    ds_write_b64 v70, v[86:87] offset:4096
    ds_write_b64 v71, v[88:89] offset:4096
    v_cvt_pk_bf16_f32 v59, v80, v81
    v_mfma_f32_16x16x32_bf16 v[8:11], a[80:83], a[48:51], v[28:31]
    v_exp_f32 v82, v82
    v_mfma_f32_16x16x32_bf16 v[8:11], a[84:87], a[52:55], v[8:11]
    ds_write_b64 v70, v[128:129] offset:4608
    ds_write_b64 v71, v[132:133] offset:4608
    v_mfma_f32_16x16x32_bf16 v[8:11], a[88:91], a[56:59], v[8:11]
    v_exp_f32 v83, v83
    v_pk_mul_f32 v[144:145], v[144:145], v[20:21]
    v_pk_mul_f32 v[146:147], v[146:147], v[22:23]
    v_pk_mul_f32 v[148:149], v[148:149], v[20:21]
    v_pk_mul_f32 v[150:151], v[150:151], v[22:23]
    v_pk_mul_f32 v[152:153], v[152:153], v[20:21]
    v_pk_mul_f32 v[154:155], v[154:155], v[22:23]
    v_pk_mul_f32 v[156:157], v[156:157], v[20:21]
    v_pk_mul_f32 v[158:159], v[158:159], v[22:23]
    v_mfma_f32_16x16x32_bf16 v[8:11], a[92:95], a[60:63], v[8:11]
    v_cvt_pk_bf16_f32 v60, v82, v83
    v_cvt_pk_bf16_f32 v86, v144, v148
    v_cvt_pk_bf16_f32 v87, v152, v156
    v_cvt_pk_bf16_f32 v88, v145, v149
    v_mfma_f32_16x16x32_bf16 v[12:15], a[108:111], a[60:63], v[28:31]
    v_exp_f32 v84, v84
    v_cvt_pk_bf16_f32 v89, v153, v157
    v_cvt_pk_bf16_f32 v144, v146, v150
    v_mfma_f32_16x16x32_bf16 v[12:15], a[104:107], a[56:59], v[12:15]
    v_cvt_pk_bf16_f32 v145, v154, v158
    v_cvt_pk_bf16_f32 v148, v147, v151
    v_cvt_pk_bf16_f32 v149, v155, v159
    v_mfma_f32_16x16x32_bf16 v[12:15], a[100:103], a[52:55], v[12:15]
    v_exp_f32 v85, v85
    v_mfma_f32_16x16x32_bf16 v[12:15], a[96:99], a[48:51], v[12:15]
    ds_write_b64 v70, v[86:87] offset:4224
    ds_write_b64 v71, v[88:89] offset:4224
    v_cvt_pk_bf16_f32 v61, v84, v85
    v_mfma_f32_16x16x32_bf16 v[78:81], a[112:115], a[48:51], v[28:31]
    v_exp_f32 v8, v8
    v_mfma_f32_16x16x32_bf16 v[78:81], a[116:119], a[52:55], v[78:81]
    ds_write_b64 v70, v[144:145] offset:4736
    ds_write_b64 v71, v[148:149] offset:4736
    v_mfma_f32_16x16x32_bf16 v[78:81], a[120:123], a[56:59], v[78:81]
    v_exp_f32 v9, v9
    v_mfma_f32_16x16x32_bf16 v[78:81], a[124:127], a[60:63], v[78:81]
    ds_read_b64_tr_b16 v[136:137], v72 offset:4096
    ds_read_b64_tr_b16 v[138:139], v73 offset:4096
    v_cvt_pk_bf16_f32 v62, v8, v9
    v_mfma_f32_16x16x32_bf16 v[82:85], a[140:143], a[60:63], v[28:31]
    v_exp_f32 v10, v10
    v_mfma_f32_16x16x32_bf16 v[82:85], a[136:139], a[56:59], v[82:85]
    ds_read_b64_tr_b16 v[140:141], v72 offset:5120
    ds_read_b64_tr_b16 v[142:143], v73 offset:5120
    v_mfma_f32_16x16x32_bf16 v[82:85], a[132:135], a[52:55], v[82:85]
    v_exp_f32 v11, v11
    v_mfma_f32_16x16x32_bf16 v[82:85], a[128:131], a[48:51], v[82:85]
    ds_read_b64_tr_b16 v[152:153], v72 offset:6144
    ds_read_b64_tr_b16 v[154:155], v73 offset:6144
    v_cvt_pk_bf16_f32 v63, v10, v11
    v_smfmac_f32_16x16x64_bf16 a[72:75], a[208:211], v[54:61], v41
    v_mfma_f32_16x16x32_bf16 v[160:163], v[54:57], a[212:215], v[160:163]
    v_exp_f32 v12, v12
    v_mfma_f32_16x16x32_bf16 v[160:163], v[58:61], a[216:219], v[160:163]
    ds_read_b64_tr_b16 v[156:157], v72 offset:7168
    ds_read_b64_tr_b16 v[158:159], v73 offset:7168
    v_mfma_f32_16x16x32_bf16 v[164:167], v[54:57], a[220:223], v[164:167]
    v_exp_f32 v13, v13
    v_mfma_f32_16x16x32_bf16 v[164:167], v[58:61], a[224:227], v[164:167]
    v_cvt_pk_bf16_f32 v64, v12, v13
    v_mfma_f32_16x16x4_f32 v[24:27], a72, v75, 0
    v_mfma_f32_16x16x4_f32 v[24:27], a73, v75, v[24:27]
    v_mfma_f32_16x16x32_bf16 v[168:171], v[54:57], a[152:155], v[168:171]
    v_exp_f32 v14, v14
    v_mfma_f32_16x16x32_bf16 v[168:171], v[58:61], a[184:187], v[168:171]
    v_mfma_f32_16x16x32_bf16 v[172:175], v[54:57], a[156:159], v[172:175]
    v_exp_f32 v15, v15
    v_mfma_f32_16x16x32_bf16 v[172:175], v[58:61], a[188:191], v[172:175]
    s_add_u32 s35, s36, 4096
    s_waitcnt lgkmcnt(4)
    buffer_store_dwordx4 v[136:139], v6, s[24:27], s35 offen offset:0 sc1 nt
    v_cvt_pk_bf16_f32 v65, v14, v15
    v_mfma_f32_16x16x32_bf16 v[176:179], v[54:57], a[228:231], v[176:179]
    buffer_store_dwordx4 v[140:143], v6, s[24:27], s35 offen offset:1024 sc1 nt
    v_exp_f32 v78, v78
    v_max3_f32 v5, v24, v25, v26
    v_rcp_f32 v24, v24
    v_mfma_f32_16x16x32_bf16 v[176:179], v[58:61], a[232:235], v[176:179]
    s_waitcnt lgkmcnt(2)
    buffer_store_dwordx4 v[152:155], v6, s[24:27], s35 offen offset:2048 sc1 nt
    v_max_f32 v5, v5, v27
    v_rcp_f32 v25, v25
    v_cmp_nlt_f32 vcc, v5, s46
    v_rcp_f32 v26, v26
    v_mfma_f32_16x16x32_bf16 v[180:183], v[54:57], a[236:239], v[180:183]
    s_waitcnt lgkmcnt(0)
    buffer_store_dwordx4 v[156:159], v6, s[24:27], s35 offen offset:3072 sc1 nt
    v_exp_f32 v79, v79
    v_rcp_f32 v27, v27
    s_or_b64 s[44:45], s[44:45], vcc
    v_mfma_f32_16x16x32_bf16 v[180:183], v[58:61], a[240:243], v[180:183]
    v_cvt_pk_bf16_f32 v66, v78, v79
    v_pk_mul_f32 v[160:161], v[160:161], v[24:25]
    v_pk_mul_f32 v[162:163], v[162:163], v[26:27]
    v_pk_mul_f32 v[164:165], v[164:165], v[24:25]
    v_pk_mul_f32 v[166:167], v[166:167], v[26:27]
    v_pk_mul_f32 v[168:169], v[168:169], v[24:25]
    v_pk_mul_f32 v[170:171], v[170:171], v[26:27]
    v_pk_mul_f32 v[172:173], v[172:173], v[24:25]
    v_pk_mul_f32 v[174:175], v[174:175], v[26:27]
    v_mfma_f32_16x16x32_bf16 v[184:187], v[54:57], a[168:171], v[184:187]
    v_exp_f32 v80, v80
    v_cvt_pk_bf16_f32 v86, v160, v164
    v_cvt_pk_bf16_f32 v87, v168, v172
    v_mfma_f32_16x16x32_bf16 v[184:187], v[58:61], a[200:203], v[184:187]
    v_cvt_pk_bf16_f32 v88, v161, v165
    v_cvt_pk_bf16_f32 v89, v169, v173
    v_cvt_pk_bf16_f32 v160, v162, v166
    v_cvt_pk_bf16_f32 v161, v170, v174
    v_mfma_f32_16x16x32_bf16 v[188:191], v[54:57], a[172:175], v[188:191]
    v_exp_f32 v81, v81
    v_cvt_pk_bf16_f32 v164, v163, v167
    v_cvt_pk_bf16_f32 v165, v171, v175
    v_mfma_f32_16x16x32_bf16 v[188:191], v[58:61], a[204:207], v[188:191]
    ds_write_b64 v70, v[86:87] offset:0
    ds_write_b64 v71, v[88:89] offset:0
    v_cvt_pk_bf16_f32 v67, v80, v81
    v_exp_f32 v82, v82
    v_exp_f32 v83, v83
    s_nop 0
    v_cvt_pk_bf16_f32 v68, v82, v83
    v_exp_f32 v84, v84
    v_exp_f32 v85, v85
    s_nop 0
    v_cvt_pk_bf16_f32 v69, v84, v85
    s_nop 1
    v_smfmac_f32_16x16x64_bf16 a[76:79], a[208:211], v[62:69], v41
    v_mfma_f32_16x16x32_bf16 v[192:195], v[62:65], a[212:215], v[192:195]
    ds_write_b64 v70, v[160:161] offset:512
    ds_write_b64 v71, v[164:165] offset:512
    v_pk_mul_f32 v[176:177], v[176:177], v[24:25]
    v_pk_mul_f32 v[178:179], v[178:179], v[26:27]
    v_pk_mul_f32 v[180:181], v[180:181], v[24:25]
    v_pk_mul_f32 v[182:183], v[182:183], v[26:27]
    v_pk_mul_f32 v[184:185], v[184:185], v[24:25]
    v_pk_mul_f32 v[186:187], v[186:187], v[26:27]
    v_pk_mul_f32 v[188:189], v[188:189], v[24:25]
    v_pk_mul_f32 v[190:191], v[190:191], v[26:27]
    v_mfma_f32_16x16x32_bf16 v[192:195], v[66:69], a[216:219], v[192:195]
    v_cvt_pk_bf16_f32 v86, v176, v180
    v_cvt_pk_bf16_f32 v87, v184, v188
    v_cvt_pk_bf16_f32 v88, v177, v181
    v_cvt_pk_bf16_f32 v89, v185, v189
    v_mfma_f32_16x16x32_bf16 v[196:199], v[62:65], a[220:223], v[196:199]
    v_cvt_pk_bf16_f32 v176, v178, v182
    v_cvt_pk_bf16_f32 v177, v186, v190
    v_cvt_pk_bf16_f32 v180, v179, v183
    v_cvt_pk_bf16_f32 v181, v187, v191
    v_mfma_f32_16x16x32_bf16 v[196:199], v[66:69], a[224:227], v[196:199]
    ds_write_b64 v70, v[86:87] offset:128
    ds_write_b64 v71, v[88:89] offset:128
    v_mfma_f32_16x16x4_f32 v[28:31], a76, v75, 0
    v_mfma_f32_16x16x4_f32 v[28:31], a77, v75, v[28:31]
    v_mfma_f32_16x16x32_bf16 v[200:203], v[62:65], a[152:155], v[200:203]
    ds_write_b64 v70, v[176:177] offset:640
    ds_write_b64 v71, v[180:181] offset:640
    v_mfma_f32_16x16x32_bf16 v[200:203], v[66:69], a[184:187], v[200:203]
    ds_read_b64_tr_b16 v[168:169], v72 offset:0
    ds_read_b64_tr_b16 v[170:171], v73 offset:0
    v_mfma_f32_16x16x32_bf16 v[204:207], v[62:65], a[156:159], v[204:207]
    ds_read_b64_tr_b16 v[172:173], v72 offset:1024
    ds_read_b64_tr_b16 v[174:175], v73 offset:1024
    v_mfma_f32_16x16x32_bf16 v[204:207], v[66:69], a[188:191], v[204:207]
    ds_read_b64_tr_b16 v[184:185], v72 offset:2048
    ds_read_b64_tr_b16 v[186:187], v73 offset:2048
    v_mfma_f32_16x16x32_bf16 v[208:211], v[62:65], a[228:231], v[208:211]
    ds_read_b64_tr_b16 v[188:189], v72 offset:3072
    ds_read_b64_tr_b16 v[190:191], v73 offset:3072
    v_mfma_f32_16x16x32_bf16 v[208:211], v[66:69], a[232:235], v[208:211]
    v_max3_f32 v5, v28, v29, v30
    v_rcp_f32 v28, v28
    v_max_f32 v5, v5, v31
    v_rcp_f32 v29, v29
    v_mfma_f32_16x16x32_bf16 v[212:215], v[62:65], a[236:239], v[212:215]
    v_cmp_nlt_f32 vcc, v5, s46
    v_rcp_f32 v30, v30
    v_rcp_f32 v31, v31
    s_or_b64 s[44:45], s[44:45], vcc
    v_mfma_f32_16x16x32_bf16 v[212:215], v[66:69], a[240:243], v[212:215]
    v_pk_mul_f32 v[192:193], v[192:193], v[28:29]
    v_pk_mul_f32 v[194:195], v[194:195], v[30:31]
    v_pk_mul_f32 v[196:197], v[196:197], v[28:29]
    v_pk_mul_f32 v[198:199], v[198:199], v[30:31]
    v_pk_mul_f32 v[200:201], v[200:201], v[28:29]
    v_pk_mul_f32 v[202:203], v[202:203], v[30:31]
    v_pk_mul_f32 v[204:205], v[204:205], v[28:29]
    v_pk_mul_f32 v[206:207], v[206:207], v[30:31]
    v_mfma_f32_16x16x32_bf16 v[216:219], v[62:65], a[168:171], v[216:219]
    v_cvt_pk_bf16_f32 v86, v192, v196
    v_cvt_pk_bf16_f32 v87, v200, v204
    v_cvt_pk_bf16_f32 v88, v193, v197
    v_cvt_pk_bf16_f32 v89, v201, v205
    v_mfma_f32_16x16x32_bf16 v[216:219], v[66:69], a[200:203], v[216:219]
    v_cvt_pk_bf16_f32 v192, v194, v198
    v_cvt_pk_bf16_f32 v193, v202, v206
    v_cvt_pk_bf16_f32 v196, v195, v199
    v_cvt_pk_bf16_f32 v197, v203, v207
    v_mfma_f32_16x16x32_bf16 v[220:223], v[62:65], a[172:175], v[220:223]
    s_add_u32 s35, s36, 8192
    s_waitcnt lgkmcnt(0)
    buffer_store_dwordx4 v[168:171], v6, s[24:27], s35 offen offset:0 sc1 nt
    ds_write_b64 v70, v[86:87] offset:4096
    ds_write_b64 v71, v[88:89] offset:4096
    v_mfma_f32_16x16x32_bf16 v[220:223], v[66:69], a[204:207], v[220:223]
    buffer_store_dwordx4 v[172:175], v6, s[24:27], s35 offen offset:1024 sc1 nt
    ds_write_b64 v70, v[192:193] offset:4608
    ds_write_b64 v71, v[196:197] offset:4608
    buffer_store_dwordx4 v[184:187], v6, s[24:27], s35 offen offset:2048 sc1 nt
    buffer_store_dwordx4 v[188:191], v6, s[24:27], s35 offen offset:3072 sc1 nt
    v_pk_mul_f32 v[208:209], v[208:209], v[28:29]
    v_pk_mul_f32 v[210:211], v[210:211], v[30:31]
    v_pk_mul_f32 v[212:213], v[212:213], v[28:29]
    v_pk_mul_f32 v[214:215], v[214:215], v[30:31]
    v_pk_mul_f32 v[216:217], v[216:217], v[28:29]
    v_pk_mul_f32 v[218:219], v[218:219], v[30:31]
    v_pk_mul_f32 v[220:221], v[220:221], v[28:29]
    v_pk_mul_f32 v[222:223], v[222:223], v[30:31]
    v_cvt_pk_bf16_f32 v86, v208, v212
    v_cvt_pk_bf16_f32 v87, v216, v220
    v_cvt_pk_bf16_f32 v88, v209, v213
    v_cvt_pk_bf16_f32 v89, v217, v221
    v_cvt_pk_bf16_f32 v208, v210, v214
    v_cvt_pk_bf16_f32 v209, v218, v222
    v_cvt_pk_bf16_f32 v212, v211, v215
    v_cvt_pk_bf16_f32 v213, v219, v223
    ds_write_b64 v70, v[86:87] offset:4224
    ds_write_b64 v71, v[88:89] offset:4224
    ds_write_b64 v70, v[208:209] offset:4736
    ds_write_b64 v71, v[212:213] offset:4736
    ds_read_b64_tr_b16 v[200:201], v72 offset:4096
    ds_read_b64_tr_b16 v[202:203], v73 offset:4096
    ds_read_b64_tr_b16 v[204:205], v72 offset:5120
    ds_read_b64_tr_b16 v[206:207], v73 offset:5120
    ds_read_b64_tr_b16 v[216:217], v72 offset:6144
    ds_read_b64_tr_b16 v[218:219], v73 offset:6144
    ds_read_b64_tr_b16 v[220:221], v72 offset:7168
    ds_read_b64_tr_b16 v[222:223], v73 offset:7168
    s_add_u32 s35, s36, 12288
    s_waitcnt lgkmcnt(6)
    buffer_store_dwordx4 v[200:203], v6, s[24:27], s35 offen offset:0 sc1 nt
    s_waitcnt lgkmcnt(4)
    buffer_store_dwordx4 v[204:207], v6, s[24:27], s35 offen offset:1024 sc1 nt
    s_waitcnt lgkmcnt(2)
    buffer_store_dwordx4 v[216:219], v6, s[24:27], s35 offen offset:2048 sc1 nt
    s_waitcnt lgkmcnt(0)
    buffer_store_dwordx4 v[220:223], v6, s[24:27], s35 offen offset:3072 sc1 nt
    s_cmp_lg_u32 s31, 0
    s_cbranch_scc1 L_fin
    s_cmp_lg_u64 s[44:45], 0
    s_cselect_b32 s34, 1, 0
    v_mov_b32 v4, s34
    ds_write_b32 v7, v4
    s_waitcnt lgkmcnt(0)
    s_barrier
    v_and_b32 v4, 3, v1
    v_lshlrev_b32 v4, 13, v4
    v_add_u32 v4, 131072, v4
    ds_read_b32 v4, v4
    s_waitcnt lgkmcnt(0)
    v_cmp_ne_u32 vcc, 0, v4
    s_nop 3
    s_cmp_eq_u64 vcc, 0
    s_cbranch_scc1 L_fin
    s_branch L_slow_w4
L_fin:
L_end:
    s_endpgm
L_code_end:
L_slow_w5:
    s_waitcnt vmcnt(0)
    s_mov_b32 s31, 1
    s_mov_b32 s30, 0
    v_lshlrev_b32 v5, 8, v3
    v_lshl_add_u32 v5, v2, 4, v5
    v_mov_b32 v36, 0xff800000
    v_mov_b32 v37, 0xff800000
    v_mov_b32 v38, 0xff800000
    v_mov_b32 v39, 0xff800000
    v_mov_b32 v40, 0xff800000
L_slowloop_w5:
    buffer_load_dwordx4 a[80:83], v5, s[16:19], s30 offen offset:0
    buffer_load_dwordx4 a[84:87], v5, s[16:19], s30 offen offset:64
    buffer_load_dwordx4 a[88:91], v5, s[16:19], s30 offen offset:128
    buffer_load_dwordx4 a[92:95], v5, s[16:19], s30 offen offset:192
    s_waitcnt vmcnt(0)
    v_mfma_f32_16x16x32_bf16 v[16:19], a[80:83], a[0:3], 0
    v_mfma_f32_16x16x32_bf16 v[16:19], a[84:87], a[4:7], v[16:19]
    v_mfma_f32_16x16x32_bf16 v[16:19], a[88:91], a[8:11], v[16:19]
    v_mfma_f32_16x16x32_bf16 v[16:19], a[92:95], a[12:15], v[16:19]
    v_mfma_f32_16x16x32_bf16 v[20:23], a[80:83], a[16:19], 0
    v_mfma_f32_16x16x32_bf16 v[20:23], a[84:87], a[20:23], v[20:23]
    v_mfma_f32_16x16x32_bf16 v[20:23], a[88:91], a[24:27], v[20:23]
    v_mfma_f32_16x16x32_bf16 v[20:23], a[92:95], a[28:31], v[20:23]
    v_mfma_f32_16x16x32_bf16 v[24:27], a[80:83], a[32:35], 0
    v_mfma_f32_16x16x32_bf16 v[24:27], a[84:87], a[36:39], v[24:27]
    v_mfma_f32_16x16x32_bf16 v[24:27], a[88:91], a[40:43], v[24:27]
    v_mfma_f32_16x16x32_bf16 v[24:27], a[92:95], a[44:47], v[24:27]
    v_mfma_f32_16x16x32_bf16 v[28:31], a[80:83], a[48:51], 0
    v_mfma_f32_16x16x32_bf16 v[28:31], a[84:87], a[52:55], v[28:31]
    v_mfma_f32_16x16x32_bf16 v[28:31], a[88:91], a[56:59], v[28:31]
    v_mfma_f32_16x16x32_bf16 v[28:31], a[92:95], a[60:63], v[28:31]
    v_mfma_f32_16x16x32_bf16 v[32:35], a[80:83], a[64:67], 0
    v_mfma_f32_16x16x32_bf16 v[32:35], a[84:87], a[68:71], v[32:35]
    v_mfma_f32_16x16x32_bf16 v[32:35], a[88:91], a[72:75], v[32:35]
    v_mfma_f32_16x16x32_bf16 v[32:35], a[92:95], a[76:79], v[32:35]
    s_nop 7
    v_max3_f32 v36, v36, v16, v17
    v_max3_f32 v36, v36, v18, v19
    v_max3_f32 v37, v37, v20, v21
    v_max3_f32 v37, v37, v22, v23
    v_max3_f32 v38, v38, v24, v25
    v_max3_f32 v38, v38, v26, v27
    v_max3_f32 v39, v39, v28, v29
    v_max3_f32 v39, v39, v30, v31
    v_max3_f32 v40, v40, v32, v33
    v_max3_f32 v40, v40, v34, v35
    s_add_u32 s30, s30, 4096
    s_cmp_lt_u32 s30, 524288
    s_nop 3
    s_cbranch_scc1 L_slowloop_w5
    v_mov_b32 v16, v36
    s_nop 1
    v_permlane16_swap_b32 v36, v16
    v_max_f32 v36, v36, v16
    v_mov_b32 v16, v36
    s_nop 1
    v_permlane32_swap_b32 v36, v16
    v_max_f32 v36, v36, v16
    v_sub_f32 v16, 0xc1300000, v36
    v_sub_f32 v17, 0xc1300000, v36
    v_sub_f32 v18, 0xc1300000, v36
    v_sub_f32 v19, 0xc1300000, v36
    v_mov_b32 v20, v37
    s_nop 1
    v_permlane16_swap_b32 v37, v20
    v_max_f32 v37, v37, v20
    v_mov_b32 v20, v37
    s_nop 1
    v_permlane32_swap_b32 v37, v20
    v_max_f32 v37, v37, v20
    v_sub_f32 v20, 0xc1300000, v37
    v_sub_f32 v21, 0xc1300000, v37
    v_sub_f32 v22, 0xc1300000, v37
    v_sub_f32 v23, 0xc1300000, v37
    v_mov_b32 v24, v38
    s_nop 1
    v_permlane16_swap_b32 v38, v24
    v_max_f32 v38, v38, v24
    v_mov_b32 v24, v38
    s_nop 1
    v_permlane32_swap_b32 v38, v24
    v_max_f32 v38, v38, v24
    v_sub_f32 v24, 0xc1300000, v38
    v_sub_f32 v25, 0xc1300000, v38
    v_sub_f32 v26, 0xc1300000, v38
    v_sub_f32 v27, 0xc1300000, v38
    v_mov_b32 v28, v39
    s_nop 1
    v_permlane16_swap_b32 v39, v28
    v_max_f32 v39, v39, v28
    v_mov_b32 v28, v39
    s_nop 1
    v_permlane32_swap_b32 v39, v28
    v_max_f32 v39, v39, v28
    v_sub_f32 v28, 0xc1300000, v39
    v_sub_f32 v29, 0xc1300000, v39
    v_sub_f32 v30, 0xc1300000, v39
    v_sub_f32 v31, 0xc1300000, v39
    v_mov_b32 v32, v40
    s_nop 1
    v_permlane16_swap_b32 v40, v32
    v_max_f32 v40, v40, v32
    v_mov_b32 v32, v40
    s_nop 1
    v_permlane32_swap_b32 v40, v32
    v_max_f32 v40, v40, v32
    v_sub_f32 v32, 0xc1300000, v40
    v_sub_f32 v33, 0xc1300000, v40
    v_sub_f32 v34, 0xc1300000, v40
    v_sub_f32 v35, 0xc1300000, v40
    s_barrier
    s_branch L_restart
L_slow_w4:
    s_waitcnt vmcnt(0)
    s_mov_b32 s31, 1
    s_mov_b32 s30, 0
    v_lshlrev_b32 v5, 8, v3
    v_lshl_add_u32 v5, v2, 4, v5
    v_mov_b32 v36, 0xff800000
    v_mov_b32 v37, 0xff800000
    v_mov_b32 v38, 0xff800000
    v_mov_b32 v39, 0xff800000
L_slowloop_w4:
    buffer_load_dwordx4 a[80:83], v5, s[16:19], s30 offen offset:0
    buffer_load_dwordx4 a[84:87], v5, s[16:19], s30 offen offset:64
    buffer_load_dwordx4 a[88:91], v5, s[16:19], s30 offen offset:128
    buffer_load_dwordx4 a[92:95], v5, s[16:19], s30 offen offset:192
    s_waitcnt vmcnt(0)
    v_mfma_f32_16x16x32_bf16 v[16:19], a[80:83], a[0:3], 0
    v_mfma_f32_16x16x32_bf16 v[16:19], a[84:87], a[4:7], v[16:19]
    v_mfma_f32_16x16x32_bf16 v[16:19], a[88:91], a[8:11], v[16:19]
    v_mfma_f32_16x16x32_bf16 v[16:19], a[92:95], a[12:15], v[16:19]
    v_mfma_f32_16x16x32_bf16 v[20:23], a[80:83], a[16:19], 0
    v_mfma_f32_16x16x32_bf16 v[20:23], a[84:87], a[20:23], v[20:23]
    v_mfma_f32_16x16x32_bf16 v[20:23], a[88:91], a[24:27], v[20:23]
    v_mfma_f32_16x16x32_bf16 v[20:23], a[92:95], a[28:31], v[20:23]
    v_mfma_f32_16x16x32_bf16 v[24:27], a[80:83], a[32:35], 0
    v_mfma_f32_16x16x32_bf16 v[24:27], a[84:87], a[36:39], v[24:27]
    v_mfma_f32_16x16x32_bf16 v[24:27], a[88:91], a[40:43], v[24:27]
    v_mfma_f32_16x16x32_bf16 v[24:27], a[92:95], a[44:47], v[24:27]
    v_mfma_f32_16x16x32_bf16 v[28:31], a[80:83], a[48:51], 0
    v_mfma_f32_16x16x32_bf16 v[28:31], a[84:87], a[52:55], v[28:31]
    v_mfma_f32_16x16x32_bf16 v[28:31], a[88:91], a[56:59], v[28:31]
    v_mfma_f32_16x16x32_bf16 v[28:31], a[92:95], a[60:63], v[28:31]
    s_nop 7
    v_max3_f32 v36, v36, v16, v17
    v_max3_f32 v36, v36, v18, v19
    v_max3_f32 v37, v37, v20, v21
    v_max3_f32 v37, v37, v22, v23
    v_max3_f32 v38, v38, v24, v25
    v_max3_f32 v38, v38, v26, v27
    v_max3_f32 v39, v39, v28, v29
    v_max3_f32 v39, v39, v30, v31
    s_add_u32 s30, s30, 4096
    s_cmp_lt_u32 s30, 524288
    s_nop 3
    s_cbranch_scc1 L_slowloop_w4
    v_mov_b32 v16, v36
    s_nop 1
    v_permlane16_swap_b32 v36, v16
    v_max_f32 v36, v36, v16
    v_mov_b32 v16, v36
    s_nop 1
    v_permlane32_swap_b32 v36, v16
    v_max_f32 v36, v36, v16
    v_sub_f32 v16, 0xc1300000, v36
    v_sub_f32 v17, 0xc1300000, v36
    v_sub_f32 v18, 0xc1300000, v36
    v_sub_f32 v19, 0xc1300000, v36
    v_mov_b32 v20, v37
    s_nop 1
    v_permlane16_swap_b32 v37, v20
    v_max_f32 v37, v37, v20
    v_mov_b32 v20, v37
    s_nop 1
    v_permlane32_swap_b32 v37, v20
    v_max_f32 v37, v37, v20
    v_sub_f32 v20, 0xc1300000, v37
    v_sub_f32 v21, 0xc1300000, v37
    v_sub_f32 v22, 0xc1300000, v37
    v_sub_f32 v23, 0xc1300000, v37
    v_mov_b32 v24, v38
    s_nop 1
    v_permlane16_swap_b32 v38, v24
    v_max_f32 v38, v38, v24
    v_mov_b32 v24, v38
    s_nop 1
    v_permlane32_swap_b32 v38, v24
    v_max_f32 v38, v38, v24
    v_sub_f32 v24, 0xc1300000, v38
    v_sub_f32 v25, 0xc1300000, v38
    v_sub_f32 v26, 0xc1300000, v38
    v_sub_f32 v27, 0xc1300000, v38
    v_mov_b32 v28, v39
    s_nop 1
    v_permlane16_swap_b32 v39, v28
    v_max_f32 v39, v39, v28
    v_mov_b32 v28, v39
    s_nop 1
    v_permlane32_swap_b32 v39, v28
    v_max_f32 v39, v39, v28
    v_sub_f32 v28, 0xc1300000, v39
    v_sub_f32 v29, 0xc1300000, v39
    v_sub_f32 v30, 0xc1300000, v39
    v_sub_f32 v31, 0xc1300000, v39
    s_barrier
    s_branch L_restart
    s_endpgm
.section .rodata,"a"
.p2align 6
.amdhsa_kernel standalone__mha_softmax__near_ridge_kernel
  .amdhsa_next_free_vgpr 512
  .amdhsa_next_free_sgpr 102
  .amdhsa_accum_offset 256
  .amdhsa_group_segment_fixed_size 0
  .amdhsa_kernarg_size 48
  .amdhsa_user_sgpr_count 2
  .amdhsa_user_sgpr_kernarg_segment_ptr 1
  .amdhsa_system_sgpr_workgroup_id_x 1
  .amdhsa_float_denorm_mode_32 3
.end_amdhsa_kernel
```
